```python
import torch

def _softmax(x, axis=-1):
    return torch.softmax(x, dim=axis)

def _gelu(x):
    return torch.nn.functional.gelu(x, approximate='tanh')

def _silu(x):
    return torch.nn.functional.silu(x)

def _sigmoid(x):
    return torch.sigmoid(x)

def _layernorm(x, axis=-1, eps=1e-05):
    m = x.mean(dim=axis, keepdim=True)
    v = x.var(dim=axis, keepdim=True, unbiased=False)
    return (x - m) / torch.sqrt(v + eps)

def _scatter_add(tgt, idx, src, axis=0):
    return tgt.clone().index_add_(axis, idx, src)

def _segment_sum(src, seg, n):
    out = torch.zeros((n,) + src.shape[1:], dtype=src.dtype)
    return out.index_add_(0, seg, src)

def _pad(x, pw):
    flat = tuple((v for pair in reversed(pw) for v in pair))
    return torch.nn.functional.pad(x, flat)
kernel_name = 'gated_mix__memory_aug_recurrent_mem_tr__dense_activation_silu__prompt'

def setup_inputs():

    _w = lambda a: (lambda t: t.to(torch.bfloat16) if t.is_floating_point() else t)(torch.as_tensor(a))

    def _A_setup():
        B, S, Dm = (1, 2048, 512)
        H, Dh = (32, 128)
        M, seg = (8, 32)
        seg = min(seg, S)
        S = S // seg * seg
        return {'x': _w((lambda *s: torch.randn(*s, dtype=torch.bfloat16) * 0.05)(B, S, Dm)), 'mem0': _w((lambda *s: torch.randn(*s, dtype=torch.bfloat16) * 0.4)(B, M, Dm)), 'Wq': _w((lambda *s: torch.randn(*s, dtype=torch.bfloat16) * 6.4)(Dm, H, Dh) * Dm ** (-0.5)), 'Wk': _w((lambda *s: torch.randn(*s, dtype=torch.bfloat16) * 6.4)(Dm, H, Dh) * Dm ** (-0.5)), 'Wv': _w((lambda *s: torch.randn(*s, dtype=torch.bfloat16) * 0.4)(Dm, H, Dh) * Dm ** (-0.5)), 'Wo': _w((lambda *s: torch.randn(*s, dtype=torch.bfloat16) * 0.4)(H, Dh, Dm) * (H * Dh) ** (-0.5)), 'seg_len': seg}
    _A_in = _A_setup()

    def _B_setup():
        B, S, D, F = (1, 2048, 512, 1792)
        return {'x': _w((lambda *s: torch.randn(*s, dtype=torch.bfloat16) * 0.05)(B, S, D)), 'w1': _w((lambda *s: torch.randn(*s, dtype=torch.bfloat16) * 3.2)(D, F) * D ** (-0.5)), 'w2': _w((lambda *s: torch.randn(*s, dtype=torch.bfloat16) * 0.2)(F, D) * F ** (-0.5))}
    _B_in = _B_setup()
    return {'A_x': _A_in['x'], 'A_mem0': _A_in['mem0'], 'A_Wq': _A_in['Wq'], 'A_Wk': _A_in['Wk'], 'A_Wv': _A_in['Wv'], 'A_Wo': _A_in['Wo'], 'A_seg_len': _A_in['seg_len'], 'B_x': _B_in['x'], 'B_w1': _B_in['w1'], 'B_w2': _B_in['w2'], 'gate_w': _w((lambda *s: torch.randn(*s, dtype=torch.bfloat16) * 0.05)(512) * 16.0)}

def reference(A_x, A_mem0, A_Wq, A_Wk, A_Wv, A_Wo, A_seg_len, B_x, B_w1, B_w2, gate_w):

    def _A_ref(x, mem0, Wq, Wk, Wv, Wo, seg_len):
        B, S, Dm = x.shape
        H, Dh = (Wq.shape[1], Wq.shape[2])
        M = mem0.shape[1]
        scale = Dh ** (-0.5)
        n_seg = S // seg_len
        L = M + seg_len
        idx = torch.arange(L)
        mask = (idx[:, None] < M) | (idx[:, None] >= idx[None, :])
        mem = mem0
        outs = []
        for s in range(n_seg):
            xs = x[:, s * seg_len:(s + 1) * seg_len, :].clone()
            h = torch.concatenate([mem, xs], axis=1)
            q = torch.einsum('btd,dhe->bhte', h, Wq)
            k = torch.einsum('btd,dhe->bhte', h, Wk)
            v = torch.einsum('btd,dhe->bhte', h, Wv)
            scores = torch.einsum('bhqe,bhke->bhqk', q, k) * scale
            scores = torch.where(mask[None, None], scores, -1000000000.0)
            p = _softmax(scores, axis=-1)
            o = torch.einsum('bhqk,bhke->bhqe', p, v)
            o = torch.einsum('bhte,hed->btd', o, Wo)
            mem = o[:, :M, :].clone()
            outs.append(o[:, M:, :])
        return torch.concatenate(outs, axis=1)

    def _B_ref(x, w1, w2):
        h = torch.einsum('bsd,df->bsf', x, w1)
        h = _silu(h)
        out = torch.einsum('bsf,fd->bsd', h, w2)
        return out
    x = A_x
    g = _sigmoid((x * gate_w).sum(-1, keepdims=True))
    a = _A_ref(x, A_mem0, A_Wq, A_Wk, A_Wv, A_Wo, A_seg_len)
    b = _B_ref(x, B_w1, B_w2)
    return g * a + (1 - g) * b
```

```asm
; @launch grid=(256,1,1) block=(256,1,1) lds=163840
.amdgcn_target "amdgcn-amd-amdhsa--gfx950"
.text
.globl gated_mix__memory_aug_recurrent_mem_tr__dense_activation_silu__prompt_kernel
.p2align 8
.type gated_mix__memory_aug_recurrent_mem_tr__dense_activation_silu__prompt_kernel,@function
gated_mix__memory_aug_recurrent_mem_tr__dense_activation_silu__prompt_kernel:
    s_cmp_ge_u32 s2, 256
    s_cbranch_scc1 L_end
    s_load_dwordx16 s[8:23], s[0:1], 0
    s_load_dwordx8 s[24:31], s[0:1], 64
    s_load_dwordx4 s[32:35], s[0:1], 96
    s_getpc_b64 s[4:5]
L_pc0:
    s_lshr_b32 s3, s2, 3
    s_lshl_b32 s3, s3, 12
    v_lshlrev_b32 v2, 4, v0
    v_add_u32 v2, s3, v2
    s_mov_b32 s6, L_end - L_pc0 - 16
    v_cmp_gt_u32 vcc, s6, v2
    v_mov_b32 v5, s5
    v_add_co_u32 v4, s[6:7], s4, v2
    s_nop 1
    v_addc_co_u32 v5, s[6:7], 0, v5, s[6:7]
    s_and_saveexec_b64 s[6:7], vcc
    s_cbranch_execz L_cw0
    global_load_dwordx4 v[8:11], v[4:5], off
    s_nop 1
L_cw0:
    s_mov_b64 exec, -1
    v_add_u32 v2, 0x20000, v2
    v_lshrrev_b32 v1, 6, v0
    v_and_b32 v0, 63, v0
    v_readfirstlane_b32 s3, v1
    s_getreg_b32 s4, hwreg(HW_REG_XCC_ID)
    s_and_b32 s4, s4, 15
    s_waitcnt lgkmcnt(0)
    s_mov_b32 s36, s8
    s_and_b32 s37, s9, 0xffff
    s_mov_b32 s38, 2097152
    s_mov_b32 s39, 0x20000
    s_mov_b32 s76, s10
    s_and_b32 s77, s11, 0xffff
    s_mov_b32 s78, 8192
    s_mov_b32 s79, 0x20000
    s_mov_b32 s40, s12
    s_and_b32 s41, s13, 0xffff
    s_mov_b32 s42, 4194304
    s_mov_b32 s43, 0x20000
    s_mov_b32 s44, s14
    s_and_b32 s45, s15, 0xffff
    s_mov_b32 s46, 4194304
    s_mov_b32 s47, 0x20000
    s_mov_b32 s48, s16
    s_and_b32 s49, s17, 0xffff
    s_mov_b32 s50, 4194304
    s_mov_b32 s51, 0x20000
    s_mov_b32 s52, s18
    s_and_b32 s53, s19, 0xffff
    s_mov_b32 s54, 4194304
    s_mov_b32 s55, 0x20000
    s_mov_b32 s56, s24
    s_and_b32 s57, s25, 0xffff
    s_mov_b32 s58, 1835008
    s_mov_b32 s59, 0x20000
    s_mov_b32 s60, s26
    s_and_b32 s61, s27, 0xffff
    s_mov_b32 s62, 1835008
    s_mov_b32 s63, 0x20000
    s_mov_b32 s80, s28
    s_and_b32 s81, s29, 0xffff
    s_mov_b32 s82, 1024
    s_mov_b32 s83, 0x20000
    s_mov_b32 s64, s30
    s_and_b32 s65, s31, 0xffff
    s_mov_b32 s66, 2097152
    s_mov_b32 s67, 0x20000
    s_mov_b32 s72, s32
    s_and_b32 s73, s33, 0xffff
    s_mov_b32 s74, 256
    s_mov_b32 s75, 0x20000
    s_mov_b32 s68, s34
    s_and_b32 s69, s35, 0xffff
    s_mov_b32 s70, 268435456
    s_mov_b32 s71, 0x20000
    s_lshl_b32 s16, s3, 11
    v_lshlrev_b32 v1, 4, v0
    s_cmp_eq_u32 s3, 0
    s_cbranch_scc0 L_w1_1
    v_mov_b32 v2, 1
    s_min_u32 s7, s4, 7
    s_lshl_b32 s7, s7, 5
    v_mov_b32 v3, 64
    s_mov_b64 exec, 1
    s_cmp_ge_u32 s4, 8
    s_cbranch_scc1 L_noat_3
    buffer_atomic_add v2, off, s[72:75], s7 sc0
    s_waitcnt vmcnt(0)
    v_mov_b32 v3, v2
    s_nop 1
L_noat_3:
    v_mov_b32 v4, 163824
    ds_write_b32 v4, v3
    s_mov_b64 exec, -1
    s_branch L_pj_2
L_w1_1:
    s_cmp_eq_u32 s3, 1
    s_cbranch_scc0 L_pj_2
    v_mov_b32 v2, 0
    v_lshlrev_b32 v3, 2, v0
    s_lshl_b32 s7, s2, 7
    s_add_u32 s7, s7, 48234496
    s_mov_b64 exec, 0xffffffff
    buffer_store_dword v2, v3, s[68:71], s7 offen sc1
    s_mov_b64 exec, -1
L_pj_2:
    s_waitcnt vmcnt(0) lgkmcnt(0)
    s_barrier
    v_mov_b32 v4, 163824
    ds_read_b32 v3, v4
    s_cmp_eq_u32 s3, 0
    s_cbranch_scc0 L_nid_4
    v_mov_b32 v2, 1
    s_mov_b64 exec, 1
    buffer_atomic_add v2, off, s[72:75], 0 offset:8
    s_mov_b64 exec, -1
L_nid_4:
    s_waitcnt lgkmcnt(0)
    v_readfirstlane_b32 s5, v3
    s_barrier
    s_cmp_lt_u32 s5, 32
    s_cbranch_scc1 L_rankok_5
    s_cmp_eq_u32 s3, 0
    s_cbranch_scc0 L_ov1_6
    v_mov_b32 v2, 1
    s_mov_b64 exec, 1
    buffer_atomic_add v2, off, s[72:75], 0 offset:4 sc0
    s_waitcnt vmcnt(0)
    ds_write_b32 v4, v2
    s_mov_b64 exec, -1
L_ov1_6:
    s_waitcnt vmcnt(0) lgkmcnt(0)
    s_barrier
    ds_read_b32 v3, v4
    s_waitcnt lgkmcnt(0)
    v_readfirstlane_b32 s10, v3
    s_barrier
    s_mov_b32 s15, 1048576
    s_nop 2
L_poll_7:
    buffer_load_dword v2, off, s[72:75], 0 offset:8 sc1
    s_waitcnt vmcnt(0)
    v_readfirstlane_b32 s7, v2
    s_nop 0
    s_cmp_eq_u32 s7, 256
    s_cbranch_scc1 L_polld_8
    s_sub_u32 s15, s15, 1
    s_cmp_eq_u32 s15, 0
    s_cbranch_scc1 L_err_2
    s_branch L_poll_7
L_polld_8:
    v_lshlrev_b32 v3, 5, v0
    buffer_load_dword v2, v3, s[72:75], 0 offen sc1
    s_waitcnt vmcnt(0)
    v_readlane_b32 s7, v2, 0
    s_nop 0
    s_min_u32 s7, s7, 32
    s_sub_u32 s8, 32, s7
    s_cmp_lt_u32 s10, s8
    s_cbranch_scc0 L_ovn_9
    s_mov_b32 s4, 0
    s_add_u32 s5, s7, s10
    s_branch L_rankok_5
L_ovn_9:
    s_sub_u32 s10, s10, s8
    v_readlane_b32 s7, v2, 1
    s_nop 0
    s_min_u32 s7, s7, 32
    s_sub_u32 s8, 32, s7
    s_cmp_lt_u32 s10, s8
    s_cbranch_scc0 L_ovn_10
    s_mov_b32 s4, 1
    s_add_u32 s5, s7, s10
    s_branch L_rankok_5
L_ovn_10:
    s_sub_u32 s10, s10, s8
    v_readlane_b32 s7, v2, 2
    s_nop 0
    s_min_u32 s7, s7, 32
    s_sub_u32 s8, 32, s7
    s_cmp_lt_u32 s10, s8
    s_cbranch_scc0 L_ovn_11
    s_mov_b32 s4, 2
    s_add_u32 s5, s7, s10
    s_branch L_rankok_5
L_ovn_11:
    s_sub_u32 s10, s10, s8
    v_readlane_b32 s7, v2, 3
    s_nop 0
    s_min_u32 s7, s7, 32
    s_sub_u32 s8, 32, s7
    s_cmp_lt_u32 s10, s8
    s_cbranch_scc0 L_ovn_12
    s_mov_b32 s4, 3
    s_add_u32 s5, s7, s10
    s_branch L_rankok_5
L_ovn_12:
    s_sub_u32 s10, s10, s8
    v_readlane_b32 s7, v2, 4
    s_nop 0
    s_min_u32 s7, s7, 32
    s_sub_u32 s8, 32, s7
    s_cmp_lt_u32 s10, s8
    s_cbranch_scc0 L_ovn_13
    s_mov_b32 s4, 4
    s_add_u32 s5, s7, s10
    s_branch L_rankok_5
L_ovn_13:
    s_sub_u32 s10, s10, s8
    v_readlane_b32 s7, v2, 5
    s_nop 0
    s_min_u32 s7, s7, 32
    s_sub_u32 s8, 32, s7
    s_cmp_lt_u32 s10, s8
    s_cbranch_scc0 L_ovn_14
    s_mov_b32 s4, 5
    s_add_u32 s5, s7, s10
    s_branch L_rankok_5
L_ovn_14:
    s_sub_u32 s10, s10, s8
    v_readlane_b32 s7, v2, 6
    s_nop 0
    s_min_u32 s7, s7, 32
    s_sub_u32 s8, 32, s7
    s_cmp_lt_u32 s10, s8
    s_cbranch_scc0 L_ovn_15
    s_mov_b32 s4, 6
    s_add_u32 s5, s7, s10
    s_branch L_rankok_5
L_ovn_15:
    s_sub_u32 s10, s10, s8
    v_readlane_b32 s7, v2, 7
    s_nop 0
    s_min_u32 s7, s7, 32
    s_sub_u32 s8, 32, s7
    s_cmp_lt_u32 s10, s8
    s_cbranch_scc0 L_ovn_16
    s_mov_b32 s4, 7
    s_add_u32 s5, s7, s10
    s_branch L_rankok_5
L_ovn_16:
    s_sub_u32 s10, s10, s8
    s_branch L_err_3
L_rankok_5:
    s_and_b32 s5, s5, 31
    s_and_b32 s4, s4, 7
    s_cmp_eq_u32 s4, 0
    s_cbranch_scc1 L_chain
    s_sub_u32 s17, s4, 1
    s_and_b32 s7, s3, 1
    s_lshl_b32 s7, s7, 2
    v_lshrrev_b32 v7, 4, v0
    v_add_u32 v8, s7, v7
    v_lshlrev_b32 v8, 1, v8
    v_and_b32 v2, 15, v0
    v_xor_b32 v2, v2, v8
    v_lshlrev_b32 v2, 4, v2
    v_bfe_u32 v7, v0, 4, 1
    s_mov_b32 s7, 8192
    v_mad_u32_u24 v2, v7, s7, v2
    v_bfe_u32 v7, v0, 5, 1
    s_mov_b32 s7, 16384
    v_mad_u32_u24 v2, v7, s7, v2
    v_lshrrev_b32 v7, 4, v0
    v_and_b32 v8, 7, v0
    v_xor_b32 v80, v7, v8
    v_lshlrev_b32 v80, 4, v80
    v_lshrrev_b32 v7, 3, v0
    v_lshl_add_u32 v80, v7, 10, v80
    v_xor_b32 v81, 64, v80
    v_bfe_u32 v7, v0, 1, 3
    v_lshrrev_b32 v8, 4, v0
    v_xor_b32 v3, v7, v8
    v_lshlrev_b32 v3, 4, v3
    v_and_b32 v7, 15, v0
    v_lshl_add_u32 v3, v7, 7, v3
    s_lshl_b32 s9, s3, 1
    v_bfe_u32 v7, v0, 2, 2
    v_bfe_u32 v8, v0, 4, 1
    v_lshl_add_u32 v4, v8, 2, v7
    v_xor_b32 v4, s9, v4
    v_lshlrev_b32 v4, 5, v4
    v_lshl_add_u32 v4, v7, 8, v4
    v_lshrrev_b32 v7, 4, v0
    v_lshl_add_u32 v4, v7, 11, v4
    v_and_b32 v7, 3, v0
    v_lshl_add_u32 v4, v7, 3, v4
    v_xor_b32 v5, 32, v4
    s_lshl_b32 s7, s17, 5
    s_add_u32 s7, s7, s5
    s_lshl_b32 s7, s7, 2
    s_add_u32 s7, s7, s3
    s_lshl_b32 s7, s7, 10
    s_lshl_b32 s18, s5, 8
    s_lshl_b32 s7, s3, 16
    s_add_u32 s18, s18, s7
    s_cmp_ge_u32 s17, 3
    s_cbranch_scc1 L_phase3
    s_cmp_lt_u32 s17, 3
    s_cbranch_scc1 L_early_17
L_early_17:
    s_mov_b32 s23, 131072
    s_mov_b32 s24, 0
    s_mov_b32 s31, 32768
    s_lshl_b32 s32, s5, 7
    s_add_u32 s32, s32, 48263168
    s_mov_b32 s14, s17
    s_add_u32 s29, s17, 3
    s_add_u32 s30, s17, 6
    s_lshl_b32 s25, s14, 15
    s_lshr_b32 s26, s3, 1
    s_lshl_b32 s26, s26, 14
    s_add_u32 s25, s25, s26
    s_and_b32 s26, s3, 1
    s_lshl_b32 s26, s26, 9
    s_add_u32 s25, s25, s26
    s_lshl_b32 s26, s3, 13
    s_add_u32 s26, s26, s23
    s_add_u32 m0, s26, 0
    s_add_u32 s27, s25, 0
    buffer_load_dwordx4 v80, s[36:39], s27 offen lds
    s_add_u32 m0, s26, 1024
    s_add_u32 s27, s25, 8192
    buffer_load_dwordx4 v81, s[36:39], s27 offen lds
    s_add_u32 m0, s26, 2048
    s_add_u32 s27, s25, 128
    buffer_load_dwordx4 v80, s[36:39], s27 offen lds
    s_add_u32 m0, s26, 3072
    s_add_u32 s27, s25, 8320
    buffer_load_dwordx4 v81, s[36:39], s27 offen lds
    s_add_u32 m0, s26, 4096
    s_add_u32 s27, s25, 256
    buffer_load_dwordx4 v80, s[36:39], s27 offen lds
    s_add_u32 m0, s26, 5120
    s_add_u32 s27, s25, 8448
    buffer_load_dwordx4 v81, s[36:39], s27 offen lds
    s_add_u32 m0, s26, 6144
    s_add_u32 s27, s25, 384
    buffer_load_dwordx4 v80, s[36:39], s27 offen lds
    s_add_u32 m0, s26, 7168
    s_add_u32 s27, s25, 8576
    buffer_load_dwordx4 v81, s[36:39], s27 offen lds
    s_lshl_b32 s18, s5, 8
    s_lshl_b32 s7, s3, 16
    s_add_u32 s18, s18, s7
    s_add_u32 m0, s16, 0
    s_add_u32 s8, s18, 0
    buffer_load_dwordx4 v2, s[44:47], s8 offen lds
    s_add_u32 m0, s16, 1024
    s_add_u32 s8, s18, 32768
    buffer_load_dwordx4 v2, s[44:47], s8 offen lds
    s_add_u32 m0, s16, 8192
    s_add_u32 s8, s18, 262144
    buffer_load_dwordx4 v2, s[44:47], s8 offen lds
    s_add_u32 m0, s16, 9216
    s_add_u32 s8, s18, 294912
    buffer_load_dwordx4 v2, s[44:47], s8 offen lds
    s_add_u32 m0, s16, 16384
    s_add_u32 s8, s18, 524288
    buffer_load_dwordx4 v2, s[44:47], s8 offen lds
    s_add_u32 m0, s16, 17408
    s_add_u32 s8, s18, 557056
    buffer_load_dwordx4 v2, s[44:47], s8 offen lds
    s_add_u32 m0, s16, 24576
    s_add_u32 s8, s18, 786432
    buffer_load_dwordx4 v2, s[44:47], s8 offen lds
    s_add_u32 m0, s16, 25600
    s_add_u32 s8, s18, 819200
    buffer_load_dwordx4 v2, s[44:47], s8 offen lds
    s_add_u32 m0, s16, 32768
    s_add_u32 s8, s18, 1048576
    buffer_load_dwordx4 v2, s[44:47], s8 offen lds
    s_add_u32 m0, s16, 33792
    s_add_u32 s8, s18, 1081344
    buffer_load_dwordx4 v2, s[44:47], s8 offen lds
    s_add_u32 m0, s16, 40960
    s_add_u32 s8, s18, 1310720
    buffer_load_dwordx4 v2, s[44:47], s8 offen lds
    s_add_u32 m0, s16, 41984
    s_add_u32 s8, s18, 1343488
    buffer_load_dwordx4 v2, s[44:47], s8 offen lds
    s_add_u32 m0, s16, 49152
    s_add_u32 s8, s18, 1572864
    buffer_load_dwordx4 v2, s[44:47], s8 offen lds
    s_add_u32 m0, s16, 50176
    s_add_u32 s8, s18, 1605632
    buffer_load_dwordx4 v2, s[44:47], s8 offen lds
    s_add_u32 m0, s16, 57344
    s_add_u32 s8, s18, 1835008
    buffer_load_dwordx4 v2, s[44:47], s8 offen lds
    s_add_u32 m0, s16, 58368
    s_add_u32 s8, s18, 1867776
    buffer_load_dwordx4 v2, s[44:47], s8 offen lds
    s_add_u32 m0, s16, 65536
    s_add_u32 s8, s18, 2097152
    buffer_load_dwordx4 v2, s[44:47], s8 offen lds
    s_add_u32 m0, s16, 66560
    s_add_u32 s8, s18, 2129920
    buffer_load_dwordx4 v2, s[44:47], s8 offen lds
    s_add_u32 m0, s16, 73728
    s_add_u32 s8, s18, 2359296
    buffer_load_dwordx4 v2, s[44:47], s8 offen lds
    s_add_u32 m0, s16, 74752
    s_add_u32 s8, s18, 2392064
    buffer_load_dwordx4 v2, s[44:47], s8 offen lds
    s_add_u32 m0, s16, 81920
    s_add_u32 s8, s18, 2621440
    buffer_load_dwordx4 v2, s[44:47], s8 offen lds
    s_add_u32 m0, s16, 82944
    s_add_u32 s8, s18, 2654208
    buffer_load_dwordx4 v2, s[44:47], s8 offen lds
    s_add_u32 m0, s16, 90112
    s_add_u32 s8, s18, 2883584
    buffer_load_dwordx4 v2, s[44:47], s8 offen lds
    s_add_u32 m0, s16, 91136
    s_add_u32 s8, s18, 2916352
    buffer_load_dwordx4 v2, s[44:47], s8 offen lds
    s_add_u32 m0, s16, 98304
    s_add_u32 s8, s18, 3145728
    buffer_load_dwordx4 v2, s[44:47], s8 offen lds
    s_add_u32 m0, s16, 99328
    s_add_u32 s8, s18, 3178496
    buffer_load_dwordx4 v2, s[44:47], s8 offen lds
    s_add_u32 m0, s16, 106496
    s_add_u32 s8, s18, 3407872
    buffer_load_dwordx4 v2, s[44:47], s8 offen lds
    s_add_u32 m0, s16, 107520
    s_add_u32 s8, s18, 3440640
    buffer_load_dwordx4 v2, s[44:47], s8 offen lds
    s_add_u32 m0, s16, 114688
    s_add_u32 s8, s18, 3670016
    buffer_load_dwordx4 v2, s[44:47], s8 offen lds
    s_add_u32 m0, s16, 115712
    s_add_u32 s8, s18, 3702784
    buffer_load_dwordx4 v2, s[44:47], s8 offen lds
    s_add_u32 m0, s16, 122880
    s_add_u32 s8, s18, 3932160
    buffer_load_dwordx4 v2, s[44:47], s8 offen lds
    s_add_u32 m0, s16, 123904
    s_add_u32 s8, s18, 3964928
    buffer_load_dwordx4 v2, s[44:47], s8 offen lds
    s_waitcnt vmcnt(24)
    s_barrier
    v_add_u32 v6, 0, v4
    ds_read_b64_tr_b16 a[0:1], v6 offset:0
    ds_read_b64_tr_b16 a[2:3], v6 offset:1024
    ds_read_b64_tr_b16 a[4:5], v6 offset:8192
    ds_read_b64_tr_b16 a[6:7], v6 offset:9216
    ds_read_b64_tr_b16 a[8:9], v6 offset:16384
    ds_read_b64_tr_b16 a[10:11], v6 offset:17408
    ds_read_b64_tr_b16 a[12:13], v6 offset:24576
    ds_read_b64_tr_b16 a[14:15], v6 offset:25600
    v_add_u32 v6, 0, v5
    ds_read_b64_tr_b16 a[64:65], v6 offset:0
    ds_read_b64_tr_b16 a[66:67], v6 offset:1024
    ds_read_b64_tr_b16 a[68:69], v6 offset:8192
    ds_read_b64_tr_b16 a[70:71], v6 offset:9216
    ds_read_b64_tr_b16 a[72:73], v6 offset:16384
    ds_read_b64_tr_b16 a[74:75], v6 offset:17408
    ds_read_b64_tr_b16 a[76:77], v6 offset:24576
    ds_read_b64_tr_b16 a[78:79], v6 offset:25600
    s_waitcnt lgkmcnt(0)
    s_waitcnt vmcnt(16)
    s_barrier
    buffer_load_dword v13, off, s[72:75], 0 offset:8 sc1
    s_add_u32 m0, s16, 0
    s_add_u32 s8, s18, 0
    buffer_load_dwordx4 v2, s[48:51], s8 offen lds
    s_add_u32 m0, s16, 1024
    s_add_u32 s8, s18, 32768
    buffer_load_dwordx4 v2, s[48:51], s8 offen lds
    s_add_u32 m0, s16, 8192
    s_add_u32 s8, s18, 262144
    buffer_load_dwordx4 v2, s[48:51], s8 offen lds
    s_add_u32 m0, s16, 9216
    s_add_u32 s8, s18, 294912
    buffer_load_dwordx4 v2, s[48:51], s8 offen lds
    s_add_u32 m0, s16, 16384
    s_add_u32 s8, s18, 524288
    buffer_load_dwordx4 v2, s[48:51], s8 offen lds
    s_add_u32 m0, s16, 17408
    s_add_u32 s8, s18, 557056
    buffer_load_dwordx4 v2, s[48:51], s8 offen lds
    s_add_u32 m0, s16, 24576
    s_add_u32 s8, s18, 786432
    buffer_load_dwordx4 v2, s[48:51], s8 offen lds
    s_add_u32 m0, s16, 25600
    s_add_u32 s8, s18, 819200
    buffer_load_dwordx4 v2, s[48:51], s8 offen lds
    v_add_u32 v6, 32768, v4
    ds_read_b64_tr_b16 a[16:17], v6 offset:0
    ds_read_b64_tr_b16 a[18:19], v6 offset:1024
    ds_read_b64_tr_b16 a[20:21], v6 offset:8192
    ds_read_b64_tr_b16 a[22:23], v6 offset:9216
    ds_read_b64_tr_b16 a[24:25], v6 offset:16384
    ds_read_b64_tr_b16 a[26:27], v6 offset:17408
    ds_read_b64_tr_b16 a[28:29], v6 offset:24576
    ds_read_b64_tr_b16 a[30:31], v6 offset:25600
    v_add_u32 v6, 32768, v5
    ds_read_b64_tr_b16 a[80:81], v6 offset:0
    ds_read_b64_tr_b16 a[82:83], v6 offset:1024
    ds_read_b64_tr_b16 a[84:85], v6 offset:8192
    ds_read_b64_tr_b16 a[86:87], v6 offset:9216
    ds_read_b64_tr_b16 a[88:89], v6 offset:16384
    ds_read_b64_tr_b16 a[90:91], v6 offset:17408
    ds_read_b64_tr_b16 a[92:93], v6 offset:24576
    ds_read_b64_tr_b16 a[94:95], v6 offset:25600
    s_waitcnt lgkmcnt(0)
    s_waitcnt vmcnt(17)
    s_barrier
    s_add_u32 m0, s16, 32768
    s_add_u32 s8, s18, 1048576
    buffer_load_dwordx4 v2, s[48:51], s8 offen lds
    s_add_u32 m0, s16, 33792
    s_add_u32 s8, s18, 1081344
    buffer_load_dwordx4 v2, s[48:51], s8 offen lds
    s_add_u32 m0, s16, 40960
    s_add_u32 s8, s18, 1310720
    buffer_load_dwordx4 v2, s[48:51], s8 offen lds
    s_add_u32 m0, s16, 41984
    s_add_u32 s8, s18, 1343488
    buffer_load_dwordx4 v2, s[48:51], s8 offen lds
    s_add_u32 m0, s16, 49152
    s_add_u32 s8, s18, 1572864
    buffer_load_dwordx4 v2, s[48:51], s8 offen lds
    s_add_u32 m0, s16, 50176
    s_add_u32 s8, s18, 1605632
    buffer_load_dwordx4 v2, s[48:51], s8 offen lds
    s_add_u32 m0, s16, 57344
    s_add_u32 s8, s18, 1835008
    buffer_load_dwordx4 v2, s[48:51], s8 offen lds
    s_add_u32 m0, s16, 58368
    s_add_u32 s8, s18, 1867776
    buffer_load_dwordx4 v2, s[48:51], s8 offen lds
    v_add_u32 v6, 65536, v4
    ds_read_b64_tr_b16 a[32:33], v6 offset:0
    ds_read_b64_tr_b16 a[34:35], v6 offset:1024
    ds_read_b64_tr_b16 a[36:37], v6 offset:8192
    ds_read_b64_tr_b16 a[38:39], v6 offset:9216
    ds_read_b64_tr_b16 a[40:41], v6 offset:16384
    ds_read_b64_tr_b16 a[42:43], v6 offset:17408
    ds_read_b64_tr_b16 a[44:45], v6 offset:24576
    ds_read_b64_tr_b16 a[46:47], v6 offset:25600
    v_add_u32 v6, 65536, v5
    ds_read_b64_tr_b16 a[96:97], v6 offset:0
    ds_read_b64_tr_b16 a[98:99], v6 offset:1024
    ds_read_b64_tr_b16 a[100:101], v6 offset:8192
    ds_read_b64_tr_b16 a[102:103], v6 offset:9216
    ds_read_b64_tr_b16 a[104:105], v6 offset:16384
    ds_read_b64_tr_b16 a[106:107], v6 offset:17408
    ds_read_b64_tr_b16 a[108:109], v6 offset:24576
    ds_read_b64_tr_b16 a[110:111], v6 offset:25600
    s_waitcnt lgkmcnt(0)
    s_waitcnt vmcnt(17)
    s_barrier
    s_add_u32 m0, s16, 65536
    s_add_u32 s8, s18, 2097152
    buffer_load_dwordx4 v2, s[48:51], s8 offen lds
    s_add_u32 m0, s16, 66560
    s_add_u32 s8, s18, 2129920
    buffer_load_dwordx4 v2, s[48:51], s8 offen lds
    s_add_u32 m0, s16, 73728
    s_add_u32 s8, s18, 2359296
    buffer_load_dwordx4 v2, s[48:51], s8 offen lds
    s_add_u32 m0, s16, 74752
    s_add_u32 s8, s18, 2392064
    buffer_load_dwordx4 v2, s[48:51], s8 offen lds
    s_add_u32 m0, s16, 81920
    s_add_u32 s8, s18, 2621440
    buffer_load_dwordx4 v2, s[48:51], s8 offen lds
    s_add_u32 m0, s16, 82944
    s_add_u32 s8, s18, 2654208
    buffer_load_dwordx4 v2, s[48:51], s8 offen lds
    s_add_u32 m0, s16, 90112
    s_add_u32 s8, s18, 2883584
    buffer_load_dwordx4 v2, s[48:51], s8 offen lds
    s_add_u32 m0, s16, 91136
    s_add_u32 s8, s18, 2916352
    buffer_load_dwordx4 v2, s[48:51], s8 offen lds
    v_add_u32 v6, 98304, v4
    ds_read_b64_tr_b16 a[48:49], v6 offset:0
    ds_read_b64_tr_b16 a[50:51], v6 offset:1024
    ds_read_b64_tr_b16 a[52:53], v6 offset:8192
    ds_read_b64_tr_b16 a[54:55], v6 offset:9216
    ds_read_b64_tr_b16 a[56:57], v6 offset:16384
    ds_read_b64_tr_b16 a[58:59], v6 offset:17408
    ds_read_b64_tr_b16 a[60:61], v6 offset:24576
    ds_read_b64_tr_b16 a[62:63], v6 offset:25600
    v_add_u32 v6, 98304, v5
    ds_read_b64_tr_b16 a[112:113], v6 offset:0
    ds_read_b64_tr_b16 a[114:115], v6 offset:1024
    ds_read_b64_tr_b16 a[116:117], v6 offset:8192
    ds_read_b64_tr_b16 a[118:119], v6 offset:9216
    ds_read_b64_tr_b16 a[120:121], v6 offset:16384
    ds_read_b64_tr_b16 a[122:123], v6 offset:17408
    ds_read_b64_tr_b16 a[124:125], v6 offset:24576
    ds_read_b64_tr_b16 a[126:127], v6 offset:25600
    s_waitcnt lgkmcnt(0)
    s_waitcnt vmcnt(16)
    s_barrier
    s_add_u32 m0, s16, 98304
    s_add_u32 s8, s18, 3145728
    buffer_load_dwordx4 v2, s[48:51], s8 offen lds
    s_add_u32 m0, s16, 99328
    s_add_u32 s8, s18, 3178496
    buffer_load_dwordx4 v2, s[48:51], s8 offen lds
    s_add_u32 m0, s16, 106496
    s_add_u32 s8, s18, 3407872
    buffer_load_dwordx4 v2, s[48:51], s8 offen lds
    s_add_u32 m0, s16, 107520
    s_add_u32 s8, s18, 3440640
    buffer_load_dwordx4 v2, s[48:51], s8 offen lds
    s_add_u32 m0, s16, 114688
    s_add_u32 s8, s18, 3670016
    buffer_load_dwordx4 v2, s[48:51], s8 offen lds
    s_add_u32 m0, s16, 115712
    s_add_u32 s8, s18, 3702784
    buffer_load_dwordx4 v2, s[48:51], s8 offen lds
    s_add_u32 m0, s16, 122880
    s_add_u32 s8, s18, 3932160
    buffer_load_dwordx4 v2, s[48:51], s8 offen lds
    s_add_u32 m0, s16, 123904
    s_add_u32 s8, s18, 3964928
    buffer_load_dwordx4 v2, s[48:51], s8 offen lds
    v_add_u32 v6, 0, v4
    ds_read_b64_tr_b16 a[128:129], v6 offset:0
    ds_read_b64_tr_b16 a[130:131], v6 offset:1024
    ds_read_b64_tr_b16 a[132:133], v6 offset:8192
    ds_read_b64_tr_b16 a[134:135], v6 offset:9216
    ds_read_b64_tr_b16 a[136:137], v6 offset:16384
    ds_read_b64_tr_b16 a[138:139], v6 offset:17408
    ds_read_b64_tr_b16 a[140:141], v6 offset:24576
    ds_read_b64_tr_b16 a[142:143], v6 offset:25600
    v_add_u32 v6, 0, v5
    ds_read_b64_tr_b16 a[192:193], v6 offset:0
    ds_read_b64_tr_b16 a[194:195], v6 offset:1024
    ds_read_b64_tr_b16 a[196:197], v6 offset:8192
    ds_read_b64_tr_b16 a[198:199], v6 offset:9216
    ds_read_b64_tr_b16 a[200:201], v6 offset:16384
    ds_read_b64_tr_b16 a[202:203], v6 offset:17408
    ds_read_b64_tr_b16 a[204:205], v6 offset:24576
    ds_read_b64_tr_b16 a[206:207], v6 offset:25600
    s_waitcnt lgkmcnt(0)
    s_waitcnt vmcnt(16)
    s_barrier
    s_lshl_b32 s25, s29, 15
    s_lshr_b32 s26, s3, 1
    s_lshl_b32 s26, s26, 14
    s_add_u32 s25, s25, s26
    s_and_b32 s26, s3, 1
    s_lshl_b32 s26, s26, 9
    s_add_u32 s25, s25, s26
    s_lshl_b32 s26, s3, 13
    s_add_u32 s26, s26, s24
    s_add_u32 m0, s26, 0
    s_add_u32 s27, s25, 0
    buffer_load_dwordx4 v80, s[36:39], s27 offen lds
    s_add_u32 m0, s26, 1024
    s_add_u32 s27, s25, 8192
    buffer_load_dwordx4 v81, s[36:39], s27 offen lds
    s_add_u32 m0, s26, 2048
    s_add_u32 s27, s25, 128
    buffer_load_dwordx4 v80, s[36:39], s27 offen lds
    s_add_u32 m0, s26, 3072
    s_add_u32 s27, s25, 8320
    buffer_load_dwordx4 v81, s[36:39], s27 offen lds
    s_add_u32 m0, s26, 4096
    s_add_u32 s27, s25, 256
    buffer_load_dwordx4 v80, s[36:39], s27 offen lds
    s_add_u32 m0, s26, 5120
    s_add_u32 s27, s25, 8448
    buffer_load_dwordx4 v81, s[36:39], s27 offen lds
    s_add_u32 m0, s26, 6144
    s_add_u32 s27, s25, 384
    buffer_load_dwordx4 v80, s[36:39], s27 offen lds
    s_add_u32 m0, s26, 7168
    s_add_u32 s27, s25, 8576
    buffer_load_dwordx4 v81, s[36:39], s27 offen lds
    v_add_u32 v6, 32768, v4
    ds_read_b64_tr_b16 a[144:145], v6 offset:0
    ds_read_b64_tr_b16 a[146:147], v6 offset:1024
    ds_read_b64_tr_b16 a[148:149], v6 offset:8192
    ds_read_b64_tr_b16 a[150:151], v6 offset:9216
    ds_read_b64_tr_b16 a[152:153], v6 offset:16384
    ds_read_b64_tr_b16 a[154:155], v6 offset:17408
    ds_read_b64_tr_b16 a[156:157], v6 offset:24576
    ds_read_b64_tr_b16 a[158:159], v6 offset:25600
    v_add_u32 v6, 32768, v5
    ds_read_b64_tr_b16 a[208:209], v6 offset:0
    ds_read_b64_tr_b16 a[210:211], v6 offset:1024
    ds_read_b64_tr_b16 a[212:213], v6 offset:8192
    ds_read_b64_tr_b16 a[214:215], v6 offset:9216
    ds_read_b64_tr_b16 a[216:217], v6 offset:16384
    ds_read_b64_tr_b16 a[218:219], v6 offset:17408
    ds_read_b64_tr_b16 a[220:221], v6 offset:24576
    ds_read_b64_tr_b16 a[222:223], v6 offset:25600
    s_waitcnt lgkmcnt(0)
    s_waitcnt vmcnt(16)
    s_barrier
    v_add_u32 v6, 65536, v4
    ds_read_b64_tr_b16 a[160:161], v6 offset:0
    ds_read_b64_tr_b16 a[162:163], v6 offset:1024
    ds_read_b64_tr_b16 a[164:165], v6 offset:8192
    ds_read_b64_tr_b16 a[166:167], v6 offset:9216
    ds_read_b64_tr_b16 a[168:169], v6 offset:16384
    ds_read_b64_tr_b16 a[170:171], v6 offset:17408
    ds_read_b64_tr_b16 a[172:173], v6 offset:24576
    ds_read_b64_tr_b16 a[174:175], v6 offset:25600
    v_add_u32 v6, 65536, v5
    ds_read_b64_tr_b16 a[224:225], v6 offset:0
    ds_read_b64_tr_b16 a[226:227], v6 offset:1024
    ds_read_b64_tr_b16 a[228:229], v6 offset:8192
    ds_read_b64_tr_b16 a[230:231], v6 offset:9216
    ds_read_b64_tr_b16 a[232:233], v6 offset:16384
    ds_read_b64_tr_b16 a[234:235], v6 offset:17408
    ds_read_b64_tr_b16 a[236:237], v6 offset:24576
    ds_read_b64_tr_b16 a[238:239], v6 offset:25600
    s_waitcnt lgkmcnt(0)
    s_waitcnt vmcnt(8)
    s_barrier
    v_add_u32 v6, 98304, v4
    ds_read_b64_tr_b16 a[176:177], v6 offset:0
    ds_read_b64_tr_b16 a[178:179], v6 offset:1024
    ds_read_b64_tr_b16 a[180:181], v6 offset:8192
    ds_read_b64_tr_b16 a[182:183], v6 offset:9216
    ds_read_b64_tr_b16 a[184:185], v6 offset:16384
    ds_read_b64_tr_b16 a[186:187], v6 offset:17408
    ds_read_b64_tr_b16 a[188:189], v6 offset:24576
    ds_read_b64_tr_b16 a[190:191], v6 offset:25600
    v_add_u32 v6, 98304, v5
    ds_read_b64_tr_b16 a[240:241], v6 offset:0
    ds_read_b64_tr_b16 a[242:243], v6 offset:1024
    ds_read_b64_tr_b16 a[244:245], v6 offset:8192
    ds_read_b64_tr_b16 a[246:247], v6 offset:9216
    ds_read_b64_tr_b16 a[248:249], v6 offset:16384
    ds_read_b64_tr_b16 a[250:251], v6 offset:17408
    ds_read_b64_tr_b16 a[252:253], v6 offset:24576
    ds_read_b64_tr_b16 a[254:255], v6 offset:25600
    s_waitcnt lgkmcnt(0)
    v_readfirstlane_b32 s7, v13
    s_nop 0
    s_cmp_eq_u32 s7, 256
    s_cbranch_scc1 L_ini_18
    s_mov_b32 s15, 1048576
    s_nop 0
L_poll_19:
    buffer_load_dword v7, off, s[72:75], 0 offset:8 sc1
    s_waitcnt vmcnt(0)
    v_readfirstlane_b32 s7, v7
    s_nop 0
    s_cmp_eq_u32 s7, 256
    s_cbranch_scc1 L_polld_20
    s_sub_u32 s15, s15, 1
    s_cmp_eq_u32 s15, 0
    s_cbranch_scc1 L_err_1
    s_branch L_poll_19
L_polld_20:
L_ini_18:
    v_mov_b32 v10, 1
    v_mov_b32 v12, 65536
    s_cmp_lt_u32 s17, 3
    s_cbranch_scc1 L_early2_21
    s_cmp_eq_u32 s3, 0
    s_cbranch_scc0 L_tk_22
    v_mov_b32 v11, 3
    s_mov_b64 exec, 1
    buffer_atomic_add v11, off, s[68:71], s32 sc0
    s_waitcnt vmcnt(0)
    ds_write_b32 v12, v11
    s_mov_b64 exec, -1
L_tk_22:
    s_waitcnt lgkmcnt(0)
    s_barrier
    ds_read_b32 v11, v12
    s_waitcnt lgkmcnt(0)
    v_readfirstlane_b32 s14, v11
    s_nop 0
    s_add_u32 s14, s14, 9
    s_add_u32 s29, s14, 1
    s_add_u32 s30, s14, 2
    s_lshl_b32 s25, s14, 15
    s_lshr_b32 s26, s3, 1
    s_lshl_b32 s26, s26, 14
    s_add_u32 s25, s25, s26
    s_and_b32 s26, s3, 1
    s_lshl_b32 s26, s26, 9
    s_add_u32 s25, s25, s26
    s_lshl_b32 s26, s3, 13
    s_add_u32 s26, s26, s23
    s_add_u32 m0, s26, 0
    s_add_u32 s27, s25, 0
    buffer_load_dwordx4 v80, s[36:39], s27 offen lds
    s_add_u32 m0, s26, 1024
    s_add_u32 s27, s25, 8192
    buffer_load_dwordx4 v81, s[36:39], s27 offen lds
    s_add_u32 m0, s26, 2048
    s_add_u32 s27, s25, 128
    buffer_load_dwordx4 v80, s[36:39], s27 offen lds
    s_add_u32 m0, s26, 3072
    s_add_u32 s27, s25, 8320
    buffer_load_dwordx4 v81, s[36:39], s27 offen lds
    s_add_u32 m0, s26, 4096
    s_add_u32 s27, s25, 256
    buffer_load_dwordx4 v80, s[36:39], s27 offen lds
    s_add_u32 m0, s26, 5120
    s_add_u32 s27, s25, 8448
    buffer_load_dwordx4 v81, s[36:39], s27 offen lds
    s_add_u32 m0, s26, 6144
    s_add_u32 s27, s25, 384
    buffer_load_dwordx4 v80, s[36:39], s27 offen lds
    s_add_u32 m0, s26, 7168
    s_add_u32 s27, s25, 8576
    buffer_load_dwordx4 v81, s[36:39], s27 offen lds
    s_lshl_b32 s25, s29, 15
    s_lshr_b32 s26, s3, 1
    s_lshl_b32 s26, s26, 14
    s_add_u32 s25, s25, s26
    s_and_b32 s26, s3, 1
    s_lshl_b32 s26, s26, 9
    s_add_u32 s25, s25, s26
    s_lshl_b32 s26, s3, 13
    s_add_u32 s26, s26, s24
    s_add_u32 m0, s26, 0
    s_add_u32 s27, s25, 0
    buffer_load_dwordx4 v80, s[36:39], s27 offen lds
    s_add_u32 m0, s26, 1024
    s_add_u32 s27, s25, 8192
    buffer_load_dwordx4 v81, s[36:39], s27 offen lds
    s_add_u32 m0, s26, 2048
    s_add_u32 s27, s25, 128
    buffer_load_dwordx4 v80, s[36:39], s27 offen lds
    s_add_u32 m0, s26, 3072
    s_add_u32 s27, s25, 8320
    buffer_load_dwordx4 v81, s[36:39], s27 offen lds
    s_add_u32 m0, s26, 4096
    s_add_u32 s27, s25, 256
    buffer_load_dwordx4 v80, s[36:39], s27 offen lds
    s_add_u32 m0, s26, 5120
    s_add_u32 s27, s25, 8448
    buffer_load_dwordx4 v81, s[36:39], s27 offen lds
    s_add_u32 m0, s26, 6144
    s_add_u32 s27, s25, 384
    buffer_load_dwordx4 v80, s[36:39], s27 offen lds
    s_add_u32 m0, s26, 7168
    s_add_u32 s27, s25, 8576
    buffer_load_dwordx4 v81, s[36:39], s27 offen lds
    s_waitcnt vmcnt(0)
L_early2_21:
    s_mov_b32 s22, 48259072
    s_cmp_eq_u32 s3, 0
    s_cselect_b32 s84, 1, 0
    s_mov_b32 s85, 0
    s_waitcnt vmcnt(8)
    s_barrier
L_p1:
    s_cmp_ge_u32 s14, 64
    s_cbranch_scc1 L_p1end_23
    s_lshl_b32 s25, s30, 15
    s_lshr_b32 s26, s3, 1
    s_lshl_b32 s26, s26, 14
    s_add_u32 s25, s25, s26
    s_and_b32 s26, s3, 1
    s_lshl_b32 s26, s26, 9
    s_add_u32 s25, s25, s26
    s_lshl_b32 s26, s3, 13
    s_add_u32 s26, s26, s31
    s_add_u32 m0, s26, 0
    s_add_u32 s27, s25, 0
    buffer_load_dwordx4 v80, s[36:39], s27 offen lds
    s_add_u32 m0, s26, 1024
    s_add_u32 s27, s25, 8192
    buffer_load_dwordx4 v81, s[36:39], s27 offen lds
    s_add_u32 m0, s26, 2048
    s_add_u32 s27, s25, 128
    buffer_load_dwordx4 v80, s[36:39], s27 offen lds
    s_add_u32 m0, s26, 3072
    s_add_u32 s27, s25, 8320
    buffer_load_dwordx4 v81, s[36:39], s27 offen lds
    s_add_u32 m0, s26, 4096
    s_add_u32 s27, s25, 256
    buffer_load_dwordx4 v80, s[36:39], s27 offen lds
    s_add_u32 m0, s26, 5120
    s_add_u32 s27, s25, 8448
    buffer_load_dwordx4 v81, s[36:39], s27 offen lds
    s_add_u32 m0, s26, 6144
    s_add_u32 s27, s25, 384
    buffer_load_dwordx4 v80, s[36:39], s27 offen lds
    s_add_u32 m0, s26, 7168
    s_add_u32 s27, s25, 8576
    buffer_load_dwordx4 v81, s[36:39], s27 offen lds
    v_add_u32 v9, s23, v3
    v_xor_b32 v14, 64, v9
    ds_read_b128 v[16:19], v9 offset:0
    ds_read_b128 v[20:23], v9 offset:16384
    ds_read_b128 v[24:27], v14 offset:0
    s_waitcnt lgkmcnt(2)
    v_mfma_f32_16x16x32_bf16 v[32:35], a[0:3], v[16:19], 0
    ds_read_b128 v[28:31], v14 offset:16384
    v_mfma_f32_16x16x32_bf16 v[48:51], v[16:19], a[128:131], 0
    v_mfma_f32_16x16x32_bf16 v[40:43], a[64:67], v[16:19], 0
    v_mfma_f32_16x16x32_bf16 v[56:59], v[16:19], a[192:195], 0
    s_waitcnt lgkmcnt(2)
    v_mfma_f32_16x16x32_bf16 v[36:39], a[0:3], v[20:23], 0
    ds_read_b128 v[16:19], v9 offset:2048
    v_mfma_f32_16x16x32_bf16 v[52:55], v[20:23], a[128:131], 0
    v_mfma_f32_16x16x32_bf16 v[44:47], a[64:67], v[20:23], 0
    v_mfma_f32_16x16x32_bf16 v[60:63], v[20:23], a[192:195], 0
    s_waitcnt lgkmcnt(2)
    v_mfma_f32_16x16x32_bf16 v[32:35], a[4:7], v[24:27], v[32:35]
    ds_read_b128 v[20:23], v9 offset:18432
    v_mfma_f32_16x16x32_bf16 v[48:51], v[24:27], a[132:135], v[48:51]
    v_mfma_f32_16x16x32_bf16 v[40:43], a[68:71], v[24:27], v[40:43]
    v_mfma_f32_16x16x32_bf16 v[56:59], v[24:27], a[196:199], v[56:59]
    s_waitcnt lgkmcnt(2)
    v_mfma_f32_16x16x32_bf16 v[36:39], a[4:7], v[28:31], v[36:39]
    ds_read_b128 v[24:27], v14 offset:2048
    v_mfma_f32_16x16x32_bf16 v[52:55], v[28:31], a[132:135], v[52:55]
    v_mfma_f32_16x16x32_bf16 v[44:47], a[68:71], v[28:31], v[44:47]
    v_mfma_f32_16x16x32_bf16 v[60:63], v[28:31], a[196:199], v[60:63]
    s_waitcnt lgkmcnt(2)
    v_mfma_f32_16x16x32_bf16 v[32:35], a[8:11], v[16:19], v[32:35]
    ds_read_b128 v[28:31], v14 offset:18432
    v_mfma_f32_16x16x32_bf16 v[48:51], v[16:19], a[136:139], v[48:51]
    v_mfma_f32_16x16x32_bf16 v[40:43], a[72:75], v[16:19], v[40:43]
    v_mfma_f32_16x16x32_bf16 v[56:59], v[16:19], a[200:203], v[56:59]
    s_waitcnt lgkmcnt(2)
    v_mfma_f32_16x16x32_bf16 v[36:39], a[8:11], v[20:23], v[36:39]
    ds_read_b128 v[16:19], v9 offset:4096
    v_mfma_f32_16x16x32_bf16 v[52:55], v[20:23], a[136:139], v[52:55]
    v_mfma_f32_16x16x32_bf16 v[44:47], a[72:75], v[20:23], v[44:47]
    v_mfma_f32_16x16x32_bf16 v[60:63], v[20:23], a[200:203], v[60:63]
    s_waitcnt lgkmcnt(2)
    v_mfma_f32_16x16x32_bf16 v[32:35], a[12:15], v[24:27], v[32:35]
    ds_read_b128 v[20:23], v9 offset:20480
    v_mfma_f32_16x16x32_bf16 v[48:51], v[24:27], a[140:143], v[48:51]
    v_mfma_f32_16x16x32_bf16 v[40:43], a[76:79], v[24:27], v[40:43]
    v_mfma_f32_16x16x32_bf16 v[56:59], v[24:27], a[204:207], v[56:59]
    s_waitcnt lgkmcnt(2)
    v_mfma_f32_16x16x32_bf16 v[36:39], a[12:15], v[28:31], v[36:39]
    ds_read_b128 v[24:27], v14 offset:4096
    v_mfma_f32_16x16x32_bf16 v[52:55], v[28:31], a[140:143], v[52:55]
    v_mfma_f32_16x16x32_bf16 v[44:47], a[76:79], v[28:31], v[44:47]
    v_mfma_f32_16x16x32_bf16 v[60:63], v[28:31], a[204:207], v[60:63]
    s_waitcnt lgkmcnt(2)
    v_mfma_f32_16x16x32_bf16 v[32:35], a[16:19], v[16:19], v[32:35]
    ds_read_b128 v[28:31], v14 offset:20480
    v_mfma_f32_16x16x32_bf16 v[48:51], v[16:19], a[144:147], v[48:51]
    v_mfma_f32_16x16x32_bf16 v[40:43], a[80:83], v[16:19], v[40:43]
    v_mfma_f32_16x16x32_bf16 v[56:59], v[16:19], a[208:211], v[56:59]
    s_waitcnt lgkmcnt(2)
    v_mfma_f32_16x16x32_bf16 v[36:39], a[16:19], v[20:23], v[36:39]
    ds_read_b128 v[16:19], v9 offset:6144
    v_mfma_f32_16x16x32_bf16 v[52:55], v[20:23], a[144:147], v[52:55]
    v_mfma_f32_16x16x32_bf16 v[44:47], a[80:83], v[20:23], v[44:47]
    v_mfma_f32_16x16x32_bf16 v[60:63], v[20:23], a[208:211], v[60:63]
    s_waitcnt lgkmcnt(2)
    v_mfma_f32_16x16x32_bf16 v[32:35], a[20:23], v[24:27], v[32:35]
    ds_read_b128 v[20:23], v9 offset:22528
    v_mfma_f32_16x16x32_bf16 v[48:51], v[24:27], a[148:151], v[48:51]
    v_mfma_f32_16x16x32_bf16 v[40:43], a[84:87], v[24:27], v[40:43]
    v_mfma_f32_16x16x32_bf16 v[56:59], v[24:27], a[212:215], v[56:59]
    s_waitcnt lgkmcnt(2)
    v_mfma_f32_16x16x32_bf16 v[36:39], a[20:23], v[28:31], v[36:39]
    ds_read_b128 v[24:27], v14 offset:6144
    v_mfma_f32_16x16x32_bf16 v[52:55], v[28:31], a[148:151], v[52:55]
    v_mfma_f32_16x16x32_bf16 v[44:47], a[84:87], v[28:31], v[44:47]
    v_mfma_f32_16x16x32_bf16 v[60:63], v[28:31], a[212:215], v[60:63]
    s_waitcnt lgkmcnt(2)
    v_mfma_f32_16x16x32_bf16 v[32:35], a[24:27], v[16:19], v[32:35]
    ds_read_b128 v[28:31], v14 offset:22528
    v_mfma_f32_16x16x32_bf16 v[48:51], v[16:19], a[152:155], v[48:51]
    v_mfma_f32_16x16x32_bf16 v[40:43], a[88:91], v[16:19], v[40:43]
    v_mfma_f32_16x16x32_bf16 v[56:59], v[16:19], a[216:219], v[56:59]
    s_waitcnt lgkmcnt(2)
    v_mfma_f32_16x16x32_bf16 v[36:39], a[24:27], v[20:23], v[36:39]
    ds_read_b128 v[16:19], v9 offset:8192
    v_mfma_f32_16x16x32_bf16 v[52:55], v[20:23], a[152:155], v[52:55]
    v_mfma_f32_16x16x32_bf16 v[44:47], a[88:91], v[20:23], v[44:47]
    v_mfma_f32_16x16x32_bf16 v[60:63], v[20:23], a[216:219], v[60:63]
    s_waitcnt lgkmcnt(2)
    v_mfma_f32_16x16x32_bf16 v[32:35], a[28:31], v[24:27], v[32:35]
    ds_read_b128 v[20:23], v9 offset:24576
    v_mfma_f32_16x16x32_bf16 v[48:51], v[24:27], a[156:159], v[48:51]
    v_mfma_f32_16x16x32_bf16 v[40:43], a[92:95], v[24:27], v[40:43]
    v_mfma_f32_16x16x32_bf16 v[56:59], v[24:27], a[220:223], v[56:59]
    s_waitcnt lgkmcnt(2)
    v_mfma_f32_16x16x32_bf16 v[36:39], a[28:31], v[28:31], v[36:39]
    ds_read_b128 v[24:27], v14 offset:8192
    v_mfma_f32_16x16x32_bf16 v[52:55], v[28:31], a[156:159], v[52:55]
    v_mfma_f32_16x16x32_bf16 v[44:47], a[92:95], v[28:31], v[44:47]
    v_mfma_f32_16x16x32_bf16 v[60:63], v[28:31], a[220:223], v[60:63]
    s_waitcnt vmcnt(8)
    s_barrier
    s_mov_b64 exec, s[84:85]
    buffer_store_dword v10, off, s[68:71], s22 sc1
    s_mov_b64 exec, -1
    s_waitcnt lgkmcnt(2)
    v_mfma_f32_16x16x32_bf16 v[32:35], a[32:35], v[16:19], v[32:35]
    ds_read_b128 v[28:31], v14 offset:24576
    v_mfma_f32_16x16x32_bf16 v[48:51], v[16:19], a[160:163], v[48:51]
    v_mfma_f32_16x16x32_bf16 v[40:43], a[96:99], v[16:19], v[40:43]
    v_mfma_f32_16x16x32_bf16 v[56:59], v[16:19], a[224:227], v[56:59]
    s_waitcnt lgkmcnt(2)
    v_mfma_f32_16x16x32_bf16 v[36:39], a[32:35], v[20:23], v[36:39]
    ds_read_b128 v[16:19], v9 offset:10240
    v_mfma_f32_16x16x32_bf16 v[52:55], v[20:23], a[160:163], v[52:55]
    v_mfma_f32_16x16x32_bf16 v[44:47], a[96:99], v[20:23], v[44:47]
    v_mfma_f32_16x16x32_bf16 v[60:63], v[20:23], a[224:227], v[60:63]
    s_waitcnt lgkmcnt(2)
    v_mfma_f32_16x16x32_bf16 v[32:35], a[36:39], v[24:27], v[32:35]
    ds_read_b128 v[20:23], v9 offset:26624
    v_mfma_f32_16x16x32_bf16 v[48:51], v[24:27], a[164:167], v[48:51]
    v_mfma_f32_16x16x32_bf16 v[40:43], a[100:103], v[24:27], v[40:43]
    v_mfma_f32_16x16x32_bf16 v[56:59], v[24:27], a[228:231], v[56:59]
    s_waitcnt lgkmcnt(2)
    v_mfma_f32_16x16x32_bf16 v[36:39], a[36:39], v[28:31], v[36:39]
    ds_read_b128 v[24:27], v14 offset:10240
    v_mfma_f32_16x16x32_bf16 v[52:55], v[28:31], a[164:167], v[52:55]
    v_mfma_f32_16x16x32_bf16 v[44:47], a[100:103], v[28:31], v[44:47]
    v_mfma_f32_16x16x32_bf16 v[60:63], v[28:31], a[228:231], v[60:63]
    s_waitcnt lgkmcnt(2)
    v_mfma_f32_16x16x32_bf16 v[32:35], a[40:43], v[16:19], v[32:35]
    ds_read_b128 v[28:31], v14 offset:26624
    v_mfma_f32_16x16x32_bf16 v[48:51], v[16:19], a[168:171], v[48:51]
    v_mfma_f32_16x16x32_bf16 v[40:43], a[104:107], v[16:19], v[40:43]
    v_mfma_f32_16x16x32_bf16 v[56:59], v[16:19], a[232:235], v[56:59]
    s_waitcnt lgkmcnt(2)
    v_mfma_f32_16x16x32_bf16 v[36:39], a[40:43], v[20:23], v[36:39]
    ds_read_b128 v[16:19], v9 offset:12288
    v_mfma_f32_16x16x32_bf16 v[52:55], v[20:23], a[168:171], v[52:55]
    v_mfma_f32_16x16x32_bf16 v[44:47], a[104:107], v[20:23], v[44:47]
    v_mfma_f32_16x16x32_bf16 v[60:63], v[20:23], a[232:235], v[60:63]
    s_waitcnt lgkmcnt(2)
    v_mfma_f32_16x16x32_bf16 v[32:35], a[44:47], v[24:27], v[32:35]
    ds_read_b128 v[20:23], v9 offset:28672
    v_mfma_f32_16x16x32_bf16 v[48:51], v[24:27], a[172:175], v[48:51]
    v_mfma_f32_16x16x32_bf16 v[40:43], a[108:111], v[24:27], v[40:43]
    v_mfma_f32_16x16x32_bf16 v[56:59], v[24:27], a[236:239], v[56:59]
    s_waitcnt lgkmcnt(2)
    v_mfma_f32_16x16x32_bf16 v[36:39], a[44:47], v[28:31], v[36:39]
    ds_read_b128 v[24:27], v14 offset:12288
    v_mfma_f32_16x16x32_bf16 v[52:55], v[28:31], a[172:175], v[52:55]
    v_mfma_f32_16x16x32_bf16 v[44:47], a[108:111], v[28:31], v[44:47]
    v_mfma_f32_16x16x32_bf16 v[60:63], v[28:31], a[236:239], v[60:63]
    s_waitcnt lgkmcnt(2)
    v_mfma_f32_16x16x32_bf16 v[32:35], a[48:51], v[16:19], v[32:35]
    ds_read_b128 v[28:31], v14 offset:28672
    v_mfma_f32_16x16x32_bf16 v[48:51], v[16:19], a[176:179], v[48:51]
    v_mfma_f32_16x16x32_bf16 v[40:43], a[112:115], v[16:19], v[40:43]
    v_mfma_f32_16x16x32_bf16 v[56:59], v[16:19], a[240:243], v[56:59]
    s_waitcnt lgkmcnt(2)
    v_mfma_f32_16x16x32_bf16 v[36:39], a[48:51], v[20:23], v[36:39]
    ds_read_b128 v[16:19], v9 offset:14336
    v_mfma_f32_16x16x32_bf16 v[52:55], v[20:23], a[176:179], v[52:55]
    v_mfma_f32_16x16x32_bf16 v[44:47], a[112:115], v[20:23], v[44:47]
    v_mfma_f32_16x16x32_bf16 v[60:63], v[20:23], a[240:243], v[60:63]
    s_waitcnt lgkmcnt(2)
    v_mfma_f32_16x16x32_bf16 v[32:35], a[52:55], v[24:27], v[32:35]
    ds_read_b128 v[20:23], v9 offset:30720
    v_mfma_f32_16x16x32_bf16 v[48:51], v[24:27], a[180:183], v[48:51]
    v_mfma_f32_16x16x32_bf16 v[40:43], a[116:119], v[24:27], v[40:43]
    v_mfma_f32_16x16x32_bf16 v[56:59], v[24:27], a[244:247], v[56:59]
    s_waitcnt lgkmcnt(2)
    v_mfma_f32_16x16x32_bf16 v[36:39], a[52:55], v[28:31], v[36:39]
    ds_read_b128 v[24:27], v14 offset:14336
    v_mfma_f32_16x16x32_bf16 v[52:55], v[28:31], a[180:183], v[52:55]
    v_mfma_f32_16x16x32_bf16 v[44:47], a[116:119], v[28:31], v[44:47]
    v_mfma_f32_16x16x32_bf16 v[60:63], v[28:31], a[244:247], v[60:63]
    s_waitcnt lgkmcnt(2)
    v_mfma_f32_16x16x32_bf16 v[32:35], a[56:59], v[16:19], v[32:35]
    ds_read_b128 v[28:31], v14 offset:30720
    v_mfma_f32_16x16x32_bf16 v[48:51], v[16:19], a[184:187], v[48:51]
    v_mfma_f32_16x16x32_bf16 v[40:43], a[120:123], v[16:19], v[40:43]
    v_mfma_f32_16x16x32_bf16 v[56:59], v[16:19], a[248:251], v[56:59]
    s_waitcnt lgkmcnt(2)
    v_mfma_f32_16x16x32_bf16 v[36:39], a[56:59], v[20:23], v[36:39]
    v_mfma_f32_16x16x32_bf16 v[52:55], v[20:23], a[184:187], v[52:55]
    v_mfma_f32_16x16x32_bf16 v[44:47], a[120:123], v[20:23], v[44:47]
    v_mfma_f32_16x16x32_bf16 v[60:63], v[20:23], a[248:251], v[60:63]
    s_waitcnt lgkmcnt(1)
    v_mfma_f32_16x16x32_bf16 v[32:35], a[60:63], v[24:27], v[32:35]
    v_mfma_f32_16x16x32_bf16 v[48:51], v[24:27], a[188:191], v[48:51]
    v_mfma_f32_16x16x32_bf16 v[40:43], a[124:127], v[24:27], v[40:43]
    v_mfma_f32_16x16x32_bf16 v[56:59], v[24:27], a[252:255], v[56:59]
    s_waitcnt lgkmcnt(0)
    v_mfma_f32_16x16x32_bf16 v[36:39], a[60:63], v[28:31], v[36:39]
    v_mfma_f32_16x16x32_bf16 v[52:55], v[28:31], a[188:191], v[52:55]
    v_mfma_f32_16x16x32_bf16 v[44:47], a[124:127], v[28:31], v[44:47]
    v_mfma_f32_16x16x32_bf16 v[60:63], v[28:31], a[252:255], v[60:63]
    s_lshl_b32 s20, s14, 18
    s_lshl_b32 s7, s5, 13
    s_add_u32 s20, s20, s7
    s_lshl_b32 s7, s3, 10
    s_add_u32 s8, s20, s7
    s_add_u32 s9, s8, 4096
    s_add_u32 s10, s20, s16
    s_add_u32 s10, s10, 16777216
    s_lshl_b32 s22, s14, 7
    s_lshl_b32 s7, s5, 2
    s_add_u32 s22, s22, s7
    s_add_u32 s22, s22, 48234496
    v_cvt_pk_bf16_f32 v64, v32, v40
    v_cvt_pk_bf16_f32 v65, v33, v41
    v_cvt_pk_bf16_f32 v66, v34, v42
    v_cvt_pk_bf16_f32 v67, v35, v43
    buffer_store_dwordx4 v[64:67], v1, s[68:71], s8 offen sc1
    v_cvt_pk_bf16_f32 v68, v36, v44
    v_cvt_pk_bf16_f32 v69, v37, v45
    v_cvt_pk_bf16_f32 v70, v38, v46
    v_cvt_pk_bf16_f32 v71, v39, v47
    buffer_store_dwordx4 v[68:71], v1, s[68:71], s9 offen sc1
    v_cvt_pk_bf16_f32 v72, v48, v49
    v_cvt_pk_bf16_f32 v73, v50, v51
    v_cvt_pk_bf16_f32 v74, v52, v53
    v_cvt_pk_bf16_f32 v75, v54, v55
    buffer_store_dwordx4 v[72:75], v1, s[68:71], s10 offen offset:0 sc1
    v_cvt_pk_bf16_f32 v76, v56, v57
    v_cvt_pk_bf16_f32 v77, v58, v59
    v_cvt_pk_bf16_f32 v78, v60, v61
    v_cvt_pk_bf16_f32 v79, v62, v63
    buffer_store_dwordx4 v[76:79], v1, s[68:71], s10 offen offset:1024 sc1
    s_waitcnt vmcnt(13)
    s_barrier
    s_mov_b32 s14, s29
    s_mov_b32 s29, s30
    s_mov_b32 s7, s23
    s_mov_b32 s23, s24
    s_mov_b32 s24, s31
    s_mov_b32 s31, s7
    s_add_u32 s30, s30, 3
    s_branch L_p1
L_p1end_23:
    s_waitcnt vmcnt(0)
    s_barrier
    s_cmp_eq_u32 s3, 0
    s_cbranch_scc0 L_nf_24
    s_mov_b64 exec, 1
    buffer_store_dword v10, off, s[68:71], s22 sc1
    s_mov_b64 exec, -1
L_nf_24:
    s_endpgm
L_phase3:
    s_sub_u32 s17, s17, 3
    s_barrier
    s_add_u32 m0, s16, 0
    s_add_u32 s8, s18, 0
    buffer_load_dwordx4 v2, s[40:43], s8 offen lds
    s_add_u32 m0, s16, 1024
    s_add_u32 s8, s18, 32768
    buffer_load_dwordx4 v2, s[40:43], s8 offen lds
    s_add_u32 m0, s16, 8192
    s_add_u32 s8, s18, 262144
    buffer_load_dwordx4 v2, s[40:43], s8 offen lds
    s_add_u32 m0, s16, 9216
    s_add_u32 s8, s18, 294912
    buffer_load_dwordx4 v2, s[40:43], s8 offen lds
    s_add_u32 m0, s16, 16384
    s_add_u32 s8, s18, 524288
    buffer_load_dwordx4 v2, s[40:43], s8 offen lds
    s_add_u32 m0, s16, 17408
    s_add_u32 s8, s18, 557056
    buffer_load_dwordx4 v2, s[40:43], s8 offen lds
    s_add_u32 m0, s16, 24576
    s_add_u32 s8, s18, 786432
    buffer_load_dwordx4 v2, s[40:43], s8 offen lds
    s_add_u32 m0, s16, 25600
    s_add_u32 s8, s18, 819200
    buffer_load_dwordx4 v2, s[40:43], s8 offen lds
    s_add_u32 m0, s16, 32768
    s_add_u32 s8, s18, 1048576
    buffer_load_dwordx4 v2, s[40:43], s8 offen lds
    s_add_u32 m0, s16, 33792
    s_add_u32 s8, s18, 1081344
    buffer_load_dwordx4 v2, s[40:43], s8 offen lds
    s_add_u32 m0, s16, 40960
    s_add_u32 s8, s18, 1310720
    buffer_load_dwordx4 v2, s[40:43], s8 offen lds
    s_add_u32 m0, s16, 41984
    s_add_u32 s8, s18, 1343488
    buffer_load_dwordx4 v2, s[40:43], s8 offen lds
    s_add_u32 m0, s16, 49152
    s_add_u32 s8, s18, 1572864
    buffer_load_dwordx4 v2, s[40:43], s8 offen lds
    s_add_u32 m0, s16, 50176
    s_add_u32 s8, s18, 1605632
    buffer_load_dwordx4 v2, s[40:43], s8 offen lds
    s_add_u32 m0, s16, 57344
    s_add_u32 s8, s18, 1835008
    buffer_load_dwordx4 v2, s[40:43], s8 offen lds
    s_add_u32 m0, s16, 58368
    s_add_u32 s8, s18, 1867776
    buffer_load_dwordx4 v2, s[40:43], s8 offen lds
    s_add_u32 m0, s16, 65536
    s_add_u32 s8, s18, 2097152
    buffer_load_dwordx4 v2, s[40:43], s8 offen lds
    s_add_u32 m0, s16, 66560
    s_add_u32 s8, s18, 2129920
    buffer_load_dwordx4 v2, s[40:43], s8 offen lds
    s_add_u32 m0, s16, 73728
    s_add_u32 s8, s18, 2359296
    buffer_load_dwordx4 v2, s[40:43], s8 offen lds
    s_add_u32 m0, s16, 74752
    s_add_u32 s8, s18, 2392064
    buffer_load_dwordx4 v2, s[40:43], s8 offen lds
    s_add_u32 m0, s16, 81920
    s_add_u32 s8, s18, 2621440
    buffer_load_dwordx4 v2, s[40:43], s8 offen lds
    s_add_u32 m0, s16, 82944
    s_add_u32 s8, s18, 2654208
    buffer_load_dwordx4 v2, s[40:43], s8 offen lds
    s_add_u32 m0, s16, 90112
    s_add_u32 s8, s18, 2883584
    buffer_load_dwordx4 v2, s[40:43], s8 offen lds
    s_add_u32 m0, s16, 91136
    s_add_u32 s8, s18, 2916352
    buffer_load_dwordx4 v2, s[40:43], s8 offen lds
    s_add_u32 m0, s16, 98304
    s_add_u32 s8, s18, 3145728
    buffer_load_dwordx4 v2, s[40:43], s8 offen lds
    s_add_u32 m0, s16, 99328
    s_add_u32 s8, s18, 3178496
    buffer_load_dwordx4 v2, s[40:43], s8 offen lds
    s_add_u32 m0, s16, 106496
    s_add_u32 s8, s18, 3407872
    buffer_load_dwordx4 v2, s[40:43], s8 offen lds
    s_add_u32 m0, s16, 107520
    s_add_u32 s8, s18, 3440640
    buffer_load_dwordx4 v2, s[40:43], s8 offen lds
    s_add_u32 m0, s16, 114688
    s_add_u32 s8, s18, 3670016
    buffer_load_dwordx4 v2, s[40:43], s8 offen lds
    s_add_u32 m0, s16, 115712
    s_add_u32 s8, s18, 3702784
    buffer_load_dwordx4 v2, s[40:43], s8 offen lds
    s_add_u32 m0, s16, 122880
    s_add_u32 s8, s18, 3932160
    buffer_load_dwordx4 v2, s[40:43], s8 offen lds
    s_add_u32 m0, s16, 123904
    s_add_u32 s8, s18, 3964928
    buffer_load_dwordx4 v2, s[40:43], s8 offen lds
    s_and_b32 s7, s3, 1
    s_lshl_b32 s7, s7, 1
    v_bfe_u32 v7, v0, 4, 1
    v_add_u32 v7, s7, v7
    v_lshlrev_b32 v7, 1, v7
    v_and_b32 v9, 7, v0
    v_xor_b32 v9, v9, v7
    v_lshlrev_b32 v9, 4, v9
    v_lshrrev_b32 v7, 3, v0
    s_mov_b32 s7, 3584
    v_mad_u32_u24 v9, v7, s7, v9
    s_mul_i32 s29, s3, 28672
    s_lshl_b32 s7, s5, 7
    s_add_u32 s29, s29, s7
    s_lshl_b32 s30, s3, 10
    v_bfe_u32 v7, v0, 3, 2
    v_xor_b32 v10, s3, v7
    v_lshlrev_b32 v10, 5, v10
    v_bfe_u32 v7, v0, 2, 2
    v_lshl_add_u32 v10, v7, 7, v10
    v_lshrrev_b32 v7, 4, v0
    v_lshl_add_u32 v10, v7, 10, v10
    v_and_b32 v7, 3, v0
    v_lshl_add_u32 v10, v7, 3, v10
    v_mov_b32 v128, 0
    v_mov_b32 v129, 0
    v_mov_b32 v130, 0
    v_mov_b32 v131, 0
    v_mov_b32 v132, 0
    v_mov_b32 v133, 0
    v_mov_b32 v134, 0
    v_mov_b32 v135, 0
    v_mov_b32 v136, 0
    v_mov_b32 v137, 0
    v_mov_b32 v138, 0
    v_mov_b32 v139, 0
    v_mov_b32 v140, 0
    v_mov_b32 v141, 0
    v_mov_b32 v142, 0
    v_mov_b32 v143, 0
    v_mov_b32 v144, 0
    v_mov_b32 v145, 0
    v_mov_b32 v146, 0
    v_mov_b32 v147, 0
    v_mov_b32 v148, 0
    v_mov_b32 v149, 0
    v_mov_b32 v150, 0
    v_mov_b32 v151, 0
    v_mov_b32 v152, 0
    v_mov_b32 v153, 0
    v_mov_b32 v154, 0
    v_mov_b32 v155, 0
    v_mov_b32 v156, 0
    v_mov_b32 v157, 0
    v_mov_b32 v158, 0
    v_mov_b32 v159, 0
    v_mov_b32 v160, 0
    v_mov_b32 v161, 0
    v_mov_b32 v162, 0
    v_mov_b32 v163, 0
    v_mov_b32 v164, 0
    v_mov_b32 v165, 0
    v_mov_b32 v166, 0
    v_mov_b32 v167, 0
    v_mov_b32 v168, 0
    v_mov_b32 v169, 0
    v_mov_b32 v170, 0
    v_mov_b32 v171, 0
    v_mov_b32 v172, 0
    v_mov_b32 v173, 0
    v_mov_b32 v174, 0
    v_mov_b32 v175, 0
    v_mov_b32 v176, 0
    v_mov_b32 v177, 0
    v_mov_b32 v178, 0
    v_mov_b32 v179, 0
    v_mov_b32 v180, 0
    v_mov_b32 v181, 0
    v_mov_b32 v182, 0
    v_mov_b32 v183, 0
    v_mov_b32 v184, 0
    v_mov_b32 v185, 0
    v_mov_b32 v186, 0
    v_mov_b32 v187, 0
    v_mov_b32 v188, 0
    v_mov_b32 v189, 0
    v_mov_b32 v190, 0
    v_mov_b32 v191, 0
    v_mov_b32 v192, 0
    v_mov_b32 v193, 0
    v_mov_b32 v194, 0
    v_mov_b32 v195, 0
    v_mov_b32 v196, 0
    v_mov_b32 v197, 0
    v_mov_b32 v198, 0
    v_mov_b32 v199, 0
    v_mov_b32 v200, 0
    v_mov_b32 v201, 0
    v_mov_b32 v202, 0
    v_mov_b32 v203, 0
    v_mov_b32 v204, 0
    v_mov_b32 v205, 0
    v_mov_b32 v206, 0
    v_mov_b32 v207, 0
    v_mov_b32 v208, 0
    v_mov_b32 v209, 0
    v_mov_b32 v210, 0
    v_mov_b32 v211, 0
    v_mov_b32 v212, 0
    v_mov_b32 v213, 0
    v_mov_b32 v214, 0
    v_mov_b32 v215, 0
    v_mov_b32 v216, 0
    v_mov_b32 v217, 0
    v_mov_b32 v218, 0
    v_mov_b32 v219, 0
    v_mov_b32 v220, 0
    v_mov_b32 v221, 0
    v_mov_b32 v222, 0
    v_mov_b32 v223, 0
    v_mov_b32 v224, 0
    v_mov_b32 v225, 0
    v_mov_b32 v226, 0
    v_mov_b32 v227, 0
    v_mov_b32 v228, 0
    v_mov_b32 v229, 0
    v_mov_b32 v230, 0
    v_mov_b32 v231, 0
    v_mov_b32 v232, 0
    v_mov_b32 v233, 0
    v_mov_b32 v234, 0
    v_mov_b32 v235, 0
    v_mov_b32 v236, 0
    v_mov_b32 v237, 0
    v_mov_b32 v238, 0
    v_mov_b32 v239, 0
    v_mov_b32 v240, 0
    v_mov_b32 v241, 0
    v_mov_b32 v242, 0
    v_mov_b32 v243, 0
    v_mov_b32 v244, 0
    v_mov_b32 v245, 0
    v_mov_b32 v246, 0
    v_mov_b32 v247, 0
    v_mov_b32 v248, 0
    v_mov_b32 v249, 0
    v_mov_b32 v250, 0
    v_mov_b32 v251, 0
    v_mov_b32 v252, 0
    v_mov_b32 v253, 0
    v_mov_b32 v254, 0
    v_mov_b32 v255, 0
    s_waitcnt vmcnt(24)
    s_barrier
    v_add_u32 v6, 0, v4
    ds_read_b64_tr_b16 a[0:1], v6 offset:0
    ds_read_b64_tr_b16 a[2:3], v6 offset:1024
    ds_read_b64_tr_b16 a[4:5], v6 offset:8192
    ds_read_b64_tr_b16 a[6:7], v6 offset:9216
    ds_read_b64_tr_b16 a[8:9], v6 offset:16384
    ds_read_b64_tr_b16 a[10:11], v6 offset:17408
    ds_read_b64_tr_b16 a[12:13], v6 offset:24576
    ds_read_b64_tr_b16 a[14:15], v6 offset:25600
    v_add_u32 v6, 0, v5
    ds_read_b64_tr_b16 a[64:65], v6 offset:0
    ds_read_b64_tr_b16 a[66:67], v6 offset:1024
    ds_read_b64_tr_b16 a[68:69], v6 offset:8192
    ds_read_b64_tr_b16 a[70:71], v6 offset:9216
    ds_read_b64_tr_b16 a[72:73], v6 offset:16384
    ds_read_b64_tr_b16 a[74:75], v6 offset:17408
    ds_read_b64_tr_b16 a[76:77], v6 offset:24576
    ds_read_b64_tr_b16 a[78:79], v6 offset:25600
    s_waitcnt lgkmcnt(0)
    s_waitcnt vmcnt(16)
    s_barrier
    v_add_u32 v6, 32768, v4
    ds_read_b64_tr_b16 a[16:17], v6 offset:0
    ds_read_b64_tr_b16 a[18:19], v6 offset:1024
    ds_read_b64_tr_b16 a[20:21], v6 offset:8192
    ds_read_b64_tr_b16 a[22:23], v6 offset:9216
    ds_read_b64_tr_b16 a[24:25], v6 offset:16384
    ds_read_b64_tr_b16 a[26:27], v6 offset:17408
    ds_read_b64_tr_b16 a[28:29], v6 offset:24576
    ds_read_b64_tr_b16 a[30:31], v6 offset:25600
    v_add_u32 v6, 32768, v5
    ds_read_b64_tr_b16 a[80:81], v6 offset:0
    ds_read_b64_tr_b16 a[82:83], v6 offset:1024
    ds_read_b64_tr_b16 a[84:85], v6 offset:8192
    ds_read_b64_tr_b16 a[86:87], v6 offset:9216
    ds_read_b64_tr_b16 a[88:89], v6 offset:16384
    ds_read_b64_tr_b16 a[90:91], v6 offset:17408
    ds_read_b64_tr_b16 a[92:93], v6 offset:24576
    ds_read_b64_tr_b16 a[94:95], v6 offset:25600
    s_waitcnt lgkmcnt(0)
    s_waitcnt vmcnt(8)
    s_barrier
    v_add_u32 v6, 65536, v4
    ds_read_b64_tr_b16 a[32:33], v6 offset:0
    ds_read_b64_tr_b16 a[34:35], v6 offset:1024
    ds_read_b64_tr_b16 a[36:37], v6 offset:8192
    ds_read_b64_tr_b16 a[38:39], v6 offset:9216
    ds_read_b64_tr_b16 a[40:41], v6 offset:16384
    ds_read_b64_tr_b16 a[42:43], v6 offset:17408
    ds_read_b64_tr_b16 a[44:45], v6 offset:24576
    ds_read_b64_tr_b16 a[46:47], v6 offset:25600
    v_add_u32 v6, 65536, v5
    ds_read_b64_tr_b16 a[96:97], v6 offset:0
    ds_read_b64_tr_b16 a[98:99], v6 offset:1024
    ds_read_b64_tr_b16 a[100:101], v6 offset:8192
    ds_read_b64_tr_b16 a[102:103], v6 offset:9216
    ds_read_b64_tr_b16 a[104:105], v6 offset:16384
    ds_read_b64_tr_b16 a[106:107], v6 offset:17408
    ds_read_b64_tr_b16 a[108:109], v6 offset:24576
    ds_read_b64_tr_b16 a[110:111], v6 offset:25600
    s_waitcnt lgkmcnt(0)
    s_waitcnt vmcnt(0)
    s_barrier
    v_add_u32 v6, 98304, v4
    ds_read_b64_tr_b16 a[48:49], v6 offset:0
    ds_read_b64_tr_b16 a[50:51], v6 offset:1024
    ds_read_b64_tr_b16 a[52:53], v6 offset:8192
    ds_read_b64_tr_b16 a[54:55], v6 offset:9216
    ds_read_b64_tr_b16 a[56:57], v6 offset:16384
    ds_read_b64_tr_b16 a[58:59], v6 offset:17408
    ds_read_b64_tr_b16 a[60:61], v6 offset:24576
    ds_read_b64_tr_b16 a[62:63], v6 offset:25600
    v_add_u32 v6, 98304, v5
    ds_read_b64_tr_b16 a[112:113], v6 offset:0
    ds_read_b64_tr_b16 a[114:115], v6 offset:1024
    ds_read_b64_tr_b16 a[116:117], v6 offset:8192
    ds_read_b64_tr_b16 a[118:119], v6 offset:9216
    ds_read_b64_tr_b16 a[120:121], v6 offset:16384
    ds_read_b64_tr_b16 a[122:123], v6 offset:17408
    ds_read_b64_tr_b16 a[124:125], v6 offset:24576
    ds_read_b64_tr_b16 a[126:127], v6 offset:25600
    s_waitcnt lgkmcnt(0)
    s_barrier
    s_and_b32 s7, s3, 1
    s_lshl_b32 s7, s7, 2
    v_lshrrev_b32 v7, 4, v0
    v_add_u32 v8, s7, v7
    v_lshlrev_b32 v8, 1, v8
    v_and_b32 v11, 15, v0
    v_xor_b32 v11, v11, v8
    v_lshlrev_b32 v11, 4, v11
    v_bfe_u32 v7, v0, 4, 1
    s_mov_b32 s7, 1024
    v_mad_u32_u24 v11, v7, s7, v11
    v_bfe_u32 v7, v0, 5, 1
    s_mov_b32 s7, 2048
    v_mad_u32_u24 v11, v7, s7, v11
    s_lshl_b32 s31, s5, 17
    s_lshl_b32 s7, s3, 12
    s_add_u32 s31, s31, s7
    s_add_u32 m0, s16, 0
    s_add_u32 s8, s31, 0
    buffer_load_dwordx4 v11, s[52:55], s8 offen lds
    s_add_u32 m0, s16, 1024
    s_add_u32 s8, s31, 16384
    buffer_load_dwordx4 v11, s[52:55], s8 offen lds
    s_add_u32 m0, s16, 8192
    s_add_u32 s8, s31, 32768
    buffer_load_dwordx4 v11, s[52:55], s8 offen lds
    s_add_u32 m0, s16, 9216
    s_add_u32 s8, s31, 49152
    buffer_load_dwordx4 v11, s[52:55], s8 offen lds
    s_add_u32 m0, s16, 16384
    s_add_u32 s8, s31, 65536
    buffer_load_dwordx4 v11, s[52:55], s8 offen lds
    s_add_u32 m0, s16, 17408
    s_add_u32 s8, s31, 81920
    buffer_load_dwordx4 v11, s[52:55], s8 offen lds
    s_add_u32 m0, s16, 24576
    s_add_u32 s8, s31, 98304
    buffer_load_dwordx4 v11, s[52:55], s8 offen lds
    s_add_u32 m0, s16, 25600
    s_add_u32 s8, s31, 114688
    buffer_load_dwordx4 v11, s[52:55], s8 offen lds
    s_add_u32 m0, s16, 32768
    s_add_u32 s8, s31, 256
    buffer_load_dwordx4 v11, s[52:55], s8 offen lds
    s_add_u32 m0, s16, 33792
    s_add_u32 s8, s31, 16640
    buffer_load_dwordx4 v11, s[52:55], s8 offen lds
    s_add_u32 m0, s16, 40960
    s_add_u32 s8, s31, 33024
    buffer_load_dwordx4 v11, s[52:55], s8 offen lds
    s_add_u32 m0, s16, 41984
    s_add_u32 s8, s31, 49408
    buffer_load_dwordx4 v11, s[52:55], s8 offen lds
    s_add_u32 m0, s16, 49152
    s_add_u32 s8, s31, 65792
    buffer_load_dwordx4 v11, s[52:55], s8 offen lds
    s_add_u32 m0, s16, 50176
    s_add_u32 s8, s31, 82176
    buffer_load_dwordx4 v11, s[52:55], s8 offen lds
    s_add_u32 m0, s16, 57344
    s_add_u32 s8, s31, 98560
    buffer_load_dwordx4 v11, s[52:55], s8 offen lds
    s_add_u32 m0, s16, 58368
    s_add_u32 s8, s31, 114944
    buffer_load_dwordx4 v11, s[52:55], s8 offen lds
    s_add_u32 m0, s16, 65536
    s_add_u32 s8, s31, 512
    buffer_load_dwordx4 v11, s[52:55], s8 offen lds
    s_add_u32 m0, s16, 66560
    s_add_u32 s8, s31, 16896
    buffer_load_dwordx4 v11, s[52:55], s8 offen lds
    s_add_u32 m0, s16, 73728
    s_add_u32 s8, s31, 33280
    buffer_load_dwordx4 v11, s[52:55], s8 offen lds
    s_add_u32 m0, s16, 74752
    s_add_u32 s8, s31, 49664
    buffer_load_dwordx4 v11, s[52:55], s8 offen lds
    s_add_u32 m0, s16, 81920
    s_add_u32 s8, s31, 66048
    buffer_load_dwordx4 v11, s[52:55], s8 offen lds
    s_add_u32 m0, s16, 82944
    s_add_u32 s8, s31, 82432
    buffer_load_dwordx4 v11, s[52:55], s8 offen lds
    s_add_u32 m0, s16, 90112
    s_add_u32 s8, s31, 98816
    buffer_load_dwordx4 v11, s[52:55], s8 offen lds
    s_add_u32 m0, s16, 91136
    s_add_u32 s8, s31, 115200
    buffer_load_dwordx4 v11, s[52:55], s8 offen lds
    s_add_u32 m0, s16, 98304
    s_add_u32 s8, s31, 768
    buffer_load_dwordx4 v11, s[52:55], s8 offen lds
    s_add_u32 m0, s16, 99328
    s_add_u32 s8, s31, 17152
    buffer_load_dwordx4 v11, s[52:55], s8 offen lds
    s_add_u32 m0, s16, 106496
    s_add_u32 s8, s31, 33536
    buffer_load_dwordx4 v11, s[52:55], s8 offen lds
    s_add_u32 m0, s16, 107520
    s_add_u32 s8, s31, 49920
    buffer_load_dwordx4 v11, s[52:55], s8 offen lds
    s_add_u32 m0, s16, 114688
    s_add_u32 s8, s31, 66304
    buffer_load_dwordx4 v11, s[52:55], s8 offen lds
    s_add_u32 m0, s16, 115712
    s_add_u32 s8, s31, 82688
    buffer_load_dwordx4 v11, s[52:55], s8 offen lds
    s_add_u32 m0, s16, 122880
    s_add_u32 s8, s31, 99072
    buffer_load_dwordx4 v11, s[52:55], s8 offen lds
    s_add_u32 m0, s16, 123904
    s_add_u32 s8, s31, 115456
    buffer_load_dwordx4 v11, s[52:55], s8 offen lds
    s_cmp_ge_u32 s5, 28
    s_cbranch_scc1 L_noffn_25
    s_add_u32 m0, s30, 131072
    s_add_u32 s8, s29, 0
    buffer_load_dwordx4 v9, s[56:59], s8 offen lds
    s_add_u32 m0, s30, 135168
    s_add_u32 s8, s29, 114688
    buffer_load_dwordx4 v9, s[56:59], s8 offen lds
    s_add_u32 m0, s30, 139264
    s_add_u32 s8, s29, 229376
    buffer_load_dwordx4 v9, s[56:59], s8 offen lds
    s_add_u32 m0, s30, 143360
    s_add_u32 s8, s29, 344064
    buffer_load_dwordx4 v9, s[56:59], s8 offen lds
    s_add_u32 m0, s30, 147456
    s_add_u32 s8, s29, 458752
    buffer_load_dwordx4 v9, s[56:59], s8 offen lds
    s_add_u32 m0, s30, 151552
    s_add_u32 s8, s29, 573440
    buffer_load_dwordx4 v9, s[56:59], s8 offen lds
    s_add_u32 m0, s30, 155648
    s_add_u32 s8, s29, 688128
    buffer_load_dwordx4 v9, s[56:59], s8 offen lds
    s_add_u32 m0, s30, 159744
    s_add_u32 s8, s29, 802816
    buffer_load_dwordx4 v9, s[56:59], s8 offen lds
L_noffn_25:
    v_bfe_u32 v7, v0, 2, 2
    v_bfe_u32 v8, v0, 4, 1
    v_lshl_add_u32 v12, v8, 2, v7
    v_xor_b32 v12, 0, v12
    v_lshlrev_b32 v12, 5, v12
    v_lshl_add_u32 v12, v7, 8, v12
    v_lshrrev_b32 v7, 4, v0
    v_lshl_add_u32 v12, v7, 11, v12
    v_and_b32 v7, 3, v0
    v_lshl_add_u32 v12, v7, 3, v12
    s_lshl_b32 s9, s3, 15
    v_add_u32 v12, s9, v12
    s_waitcnt vmcnt(0)
    s_barrier
    v_xor_b32 v14, 0, v12
    ds_read_b64_tr_b16 a[128:129], v14 offset:0
    ds_read_b64_tr_b16 a[130:131], v14 offset:1024
    ds_read_b64_tr_b16 a[132:133], v14 offset:8192
    ds_read_b64_tr_b16 a[134:135], v14 offset:9216
    ds_read_b64_tr_b16 a[136:137], v14 offset:16384
    ds_read_b64_tr_b16 a[138:139], v14 offset:17408
    ds_read_b64_tr_b16 a[140:141], v14 offset:24576
    ds_read_b64_tr_b16 a[142:143], v14 offset:25600
    v_xor_b32 v15, 32, v12
    ds_read_b64_tr_b16 a[144:145], v15 offset:0
    ds_read_b64_tr_b16 a[146:147], v15 offset:1024
    ds_read_b64_tr_b16 a[148:149], v15 offset:8192
    ds_read_b64_tr_b16 a[150:151], v15 offset:9216
    ds_read_b64_tr_b16 a[152:153], v15 offset:16384
    ds_read_b64_tr_b16 a[154:155], v15 offset:17408
    ds_read_b64_tr_b16 a[156:157], v15 offset:24576
    ds_read_b64_tr_b16 a[158:159], v15 offset:25600
    v_xor_b32 v14, 64, v12
    ds_read_b64_tr_b16 a[160:161], v14 offset:0
    ds_read_b64_tr_b16 a[162:163], v14 offset:1024
    ds_read_b64_tr_b16 a[164:165], v14 offset:8192
    ds_read_b64_tr_b16 a[166:167], v14 offset:9216
    ds_read_b64_tr_b16 a[168:169], v14 offset:16384
    ds_read_b64_tr_b16 a[170:171], v14 offset:17408
    ds_read_b64_tr_b16 a[172:173], v14 offset:24576
    ds_read_b64_tr_b16 a[174:175], v14 offset:25600
    v_xor_b32 v15, 96, v12
    ds_read_b64_tr_b16 a[176:177], v15 offset:0
    ds_read_b64_tr_b16 a[178:179], v15 offset:1024
    ds_read_b64_tr_b16 a[180:181], v15 offset:8192
    ds_read_b64_tr_b16 a[182:183], v15 offset:9216
    ds_read_b64_tr_b16 a[184:185], v15 offset:16384
    ds_read_b64_tr_b16 a[186:187], v15 offset:17408
    ds_read_b64_tr_b16 a[188:189], v15 offset:24576
    ds_read_b64_tr_b16 a[190:191], v15 offset:25600
    v_xor_b32 v14, 128, v12
    ds_read_b64_tr_b16 a[192:193], v14 offset:0
    ds_read_b64_tr_b16 a[194:195], v14 offset:1024
    ds_read_b64_tr_b16 a[196:197], v14 offset:8192
    ds_read_b64_tr_b16 a[198:199], v14 offset:9216
    ds_read_b64_tr_b16 a[200:201], v14 offset:16384
    ds_read_b64_tr_b16 a[202:203], v14 offset:17408
    ds_read_b64_tr_b16 a[204:205], v14 offset:24576
    ds_read_b64_tr_b16 a[206:207], v14 offset:25600
    v_xor_b32 v15, 160, v12
    ds_read_b64_tr_b16 a[208:209], v15 offset:0
    ds_read_b64_tr_b16 a[210:211], v15 offset:1024
    ds_read_b64_tr_b16 a[212:213], v15 offset:8192
    ds_read_b64_tr_b16 a[214:215], v15 offset:9216
    ds_read_b64_tr_b16 a[216:217], v15 offset:16384
    ds_read_b64_tr_b16 a[218:219], v15 offset:17408
    ds_read_b64_tr_b16 a[220:221], v15 offset:24576
    ds_read_b64_tr_b16 a[222:223], v15 offset:25600
    v_xor_b32 v14, 192, v12
    ds_read_b64_tr_b16 a[224:225], v14 offset:0
    ds_read_b64_tr_b16 a[226:227], v14 offset:1024
    ds_read_b64_tr_b16 a[228:229], v14 offset:8192
    ds_read_b64_tr_b16 a[230:231], v14 offset:9216
    ds_read_b64_tr_b16 a[232:233], v14 offset:16384
    ds_read_b64_tr_b16 a[234:235], v14 offset:17408
    ds_read_b64_tr_b16 a[236:237], v14 offset:24576
    ds_read_b64_tr_b16 a[238:239], v14 offset:25600
    v_xor_b32 v15, 224, v12
    ds_read_b64_tr_b16 a[240:241], v15 offset:0
    ds_read_b64_tr_b16 a[242:243], v15 offset:1024
    ds_read_b64_tr_b16 a[244:245], v15 offset:8192
    ds_read_b64_tr_b16 a[246:247], v15 offset:9216
    ds_read_b64_tr_b16 a[248:249], v15 offset:16384
    ds_read_b64_tr_b16 a[250:251], v15 offset:17408
    ds_read_b64_tr_b16 a[252:253], v15 offset:24576
    ds_read_b64_tr_b16 a[254:255], v15 offset:25600
    s_cmp_ge_u32 s5, 28
    s_cbranch_scc1 L_noffn_26
    v_add_u32 v6, 131072, v10
    ds_read_b64_tr_b16 v[128:129], v6 offset:0
    ds_read_b64_tr_b16 v[130:131], v6 offset:512
    ds_read_b64_tr_b16 v[132:133], v6 offset:4096
    ds_read_b64_tr_b16 v[134:135], v6 offset:4608
    ds_read_b64_tr_b16 v[136:137], v6 offset:8192
    ds_read_b64_tr_b16 v[138:139], v6 offset:8704
    ds_read_b64_tr_b16 v[140:141], v6 offset:12288
    ds_read_b64_tr_b16 v[142:143], v6 offset:12800
    ds_read_b64_tr_b16 v[144:145], v6 offset:16384
    ds_read_b64_tr_b16 v[146:147], v6 offset:16896
    ds_read_b64_tr_b16 v[148:149], v6 offset:20480
    ds_read_b64_tr_b16 v[150:151], v6 offset:20992
    ds_read_b64_tr_b16 v[152:153], v6 offset:24576
    ds_read_b64_tr_b16 v[154:155], v6 offset:25088
    ds_read_b64_tr_b16 v[156:157], v6 offset:28672
    ds_read_b64_tr_b16 v[158:159], v6 offset:29184
L_noffn_26:
    s_waitcnt lgkmcnt(0)
    s_barrier
    s_lshl_b32 s32, s5, 16
    s_lshl_b32 s7, s3, 12
    s_add_u32 s32, s32, s7
    s_cmp_ge_u32 s5, 28
    s_cbranch_scc1 L_noffn_27
    s_add_u32 m0, s16, 0
    s_add_u32 s8, s32, 0
    buffer_load_dwordx4 v11, s[60:63], s8 offen lds
    s_add_u32 m0, s16, 1024
    s_add_u32 s8, s32, 16384
    buffer_load_dwordx4 v11, s[60:63], s8 offen lds
    s_add_u32 m0, s16, 8192
    s_add_u32 s8, s32, 32768
    buffer_load_dwordx4 v11, s[60:63], s8 offen lds
    s_add_u32 m0, s16, 9216
    s_add_u32 s8, s32, 49152
    buffer_load_dwordx4 v11, s[60:63], s8 offen lds
    s_add_u32 m0, s16, 16384
    s_add_u32 s8, s32, 256
    buffer_load_dwordx4 v11, s[60:63], s8 offen lds
    s_add_u32 m0, s16, 17408
    s_add_u32 s8, s32, 16640
    buffer_load_dwordx4 v11, s[60:63], s8 offen lds
    s_add_u32 m0, s16, 24576
    s_add_u32 s8, s32, 33024
    buffer_load_dwordx4 v11, s[60:63], s8 offen lds
    s_add_u32 m0, s16, 25600
    s_add_u32 s8, s32, 49408
    buffer_load_dwordx4 v11, s[60:63], s8 offen lds
    s_add_u32 m0, s16, 32768
    s_add_u32 s8, s32, 512
    buffer_load_dwordx4 v11, s[60:63], s8 offen lds
    s_add_u32 m0, s16, 33792
    s_add_u32 s8, s32, 16896
    buffer_load_dwordx4 v11, s[60:63], s8 offen lds
    s_add_u32 m0, s16, 40960
    s_add_u32 s8, s32, 33280
    buffer_load_dwordx4 v11, s[60:63], s8 offen lds
    s_add_u32 m0, s16, 41984
    s_add_u32 s8, s32, 49664
    buffer_load_dwordx4 v11, s[60:63], s8 offen lds
    s_add_u32 m0, s16, 49152
    s_add_u32 s8, s32, 768
    buffer_load_dwordx4 v11, s[60:63], s8 offen lds
    s_add_u32 m0, s16, 50176
    s_add_u32 s8, s32, 17152
    buffer_load_dwordx4 v11, s[60:63], s8 offen lds
    s_add_u32 m0, s16, 57344
    s_add_u32 s8, s32, 33536
    buffer_load_dwordx4 v11, s[60:63], s8 offen lds
    s_add_u32 m0, s16, 58368
    s_add_u32 s8, s32, 49920
    buffer_load_dwordx4 v11, s[60:63], s8 offen lds
    s_add_u32 m0, s30, 65536
    s_add_u32 s8, s29, 917504
    buffer_load_dwordx4 v9, s[56:59], s8 offen lds
    s_add_u32 m0, s30, 69632
    s_add_u32 s8, s29, 1032192
    buffer_load_dwordx4 v9, s[56:59], s8 offen lds
    s_add_u32 m0, s30, 73728
    s_add_u32 s8, s29, 1146880
    buffer_load_dwordx4 v9, s[56:59], s8 offen lds
    s_add_u32 m0, s30, 77824
    s_add_u32 s8, s29, 1261568
    buffer_load_dwordx4 v9, s[56:59], s8 offen lds
    s_add_u32 m0, s30, 81920
    s_add_u32 s8, s29, 1376256
    buffer_load_dwordx4 v9, s[56:59], s8 offen lds
    s_add_u32 m0, s30, 86016
    s_add_u32 s8, s29, 1490944
    buffer_load_dwordx4 v9, s[56:59], s8 offen lds
    s_add_u32 m0, s30, 90112
    s_add_u32 s8, s29, 1605632
    buffer_load_dwordx4 v9, s[56:59], s8 offen lds
    s_add_u32 m0, s30, 94208
    s_add_u32 s8, s29, 1720320
    buffer_load_dwordx4 v9, s[56:59], s8 offen lds
L_noffn_27:
    s_lshl_b32 s9, s3, 14
    v_subrev_u32 v12, s9, v12
    s_waitcnt vmcnt(0)
    s_barrier
    s_cmp_ge_u32 s5, 28
    s_cbranch_scc1 L_noffn_28
    v_xor_b32 v14, 0, v12
    ds_read_b64_tr_b16 v[192:193], v14 offset:0
    ds_read_b64_tr_b16 v[194:195], v14 offset:1024
    ds_read_b64_tr_b16 v[196:197], v14 offset:8192
    ds_read_b64_tr_b16 v[198:199], v14 offset:9216
    v_xor_b32 v15, 32, v12
    ds_read_b64_tr_b16 v[200:201], v15 offset:0
    ds_read_b64_tr_b16 v[202:203], v15 offset:1024
    ds_read_b64_tr_b16 v[204:205], v15 offset:8192
    ds_read_b64_tr_b16 v[206:207], v15 offset:9216
    v_xor_b32 v14, 64, v12
    ds_read_b64_tr_b16 v[208:209], v14 offset:0
    ds_read_b64_tr_b16 v[210:211], v14 offset:1024
    ds_read_b64_tr_b16 v[212:213], v14 offset:8192
    ds_read_b64_tr_b16 v[214:215], v14 offset:9216
    v_xor_b32 v15, 96, v12
    ds_read_b64_tr_b16 v[216:217], v15 offset:0
    ds_read_b64_tr_b16 v[218:219], v15 offset:1024
    ds_read_b64_tr_b16 v[220:221], v15 offset:8192
    ds_read_b64_tr_b16 v[222:223], v15 offset:9216
    v_xor_b32 v14, 128, v12
    ds_read_b64_tr_b16 v[224:225], v14 offset:0
    ds_read_b64_tr_b16 v[226:227], v14 offset:1024
    ds_read_b64_tr_b16 v[228:229], v14 offset:8192
    ds_read_b64_tr_b16 v[230:231], v14 offset:9216
    v_xor_b32 v15, 160, v12
    ds_read_b64_tr_b16 v[232:233], v15 offset:0
    ds_read_b64_tr_b16 v[234:235], v15 offset:1024
    ds_read_b64_tr_b16 v[236:237], v15 offset:8192
    ds_read_b64_tr_b16 v[238:239], v15 offset:9216
    v_xor_b32 v14, 192, v12
    ds_read_b64_tr_b16 v[240:241], v14 offset:0
    ds_read_b64_tr_b16 v[242:243], v14 offset:1024
    ds_read_b64_tr_b16 v[244:245], v14 offset:8192
    ds_read_b64_tr_b16 v[246:247], v14 offset:9216
    v_xor_b32 v15, 224, v12
    ds_read_b64_tr_b16 v[248:249], v15 offset:0
    ds_read_b64_tr_b16 v[250:251], v15 offset:1024
    ds_read_b64_tr_b16 v[252:253], v15 offset:8192
    ds_read_b64_tr_b16 v[254:255], v15 offset:9216
    v_add_u32 v6, 65536, v10
    ds_read_b64_tr_b16 v[160:161], v6 offset:0
    ds_read_b64_tr_b16 v[162:163], v6 offset:512
    ds_read_b64_tr_b16 v[164:165], v6 offset:4096
    ds_read_b64_tr_b16 v[166:167], v6 offset:4608
    ds_read_b64_tr_b16 v[168:169], v6 offset:8192
    ds_read_b64_tr_b16 v[170:171], v6 offset:8704
    ds_read_b64_tr_b16 v[172:173], v6 offset:12288
    ds_read_b64_tr_b16 v[174:175], v6 offset:12800
    ds_read_b64_tr_b16 v[176:177], v6 offset:16384
    ds_read_b64_tr_b16 v[178:179], v6 offset:16896
    ds_read_b64_tr_b16 v[180:181], v6 offset:20480
    ds_read_b64_tr_b16 v[182:183], v6 offset:20992
    ds_read_b64_tr_b16 v[184:185], v6 offset:24576
    ds_read_b64_tr_b16 v[186:187], v6 offset:25088
    ds_read_b64_tr_b16 v[188:189], v6 offset:28672
    ds_read_b64_tr_b16 v[190:191], v6 offset:29184
L_noffn_28:
    s_waitcnt lgkmcnt(0)
    s_barrier
    s_mov_b32 s15, 1048576
L_poll_29:
    buffer_load_dword v7, off, s[72:75], 0 offset:8 sc1
    s_waitcnt vmcnt(0)
    v_readfirstlane_b32 s7, v7
    s_nop 0
    s_cmp_eq_u32 s7, 256
    s_cbranch_scc1 L_polld_30
    s_sub_u32 s15, s15, 1
    s_cmp_eq_u32 s15, 0
    s_cbranch_scc1 L_err_1
    s_branch L_poll_29
L_polld_30:
    s_lshl_b32 s9, s4, 5
    buffer_load_dword v7, off, s[72:75], s9 sc1
    s_waitcnt vmcnt(0)
    v_readfirstlane_b32 s7, v7
    s_nop 0
    s_cmp_lt_u32 s7, 32
    s_cselect_b32 s6, 1, 0
    v_lshrrev_b32 v7, 4, v0
    v_lshlrev_b32 v2, 4, v7
    s_lshl_b32 s7, s3, 8
    buffer_load_dwordx4 v[112:115], v2, s[80:83], s7 offen offset:0
    buffer_load_dwordx4 v[116:119], v2, s[80:83], s7 offen offset:64
    buffer_load_dwordx4 v[120:123], v2, s[80:83], s7 offen offset:128
    buffer_load_dwordx4 v[124:127], v2, s[80:83], s7 offen offset:192
    s_mov_b32 s14, s17
    s_mov_b32 s23, 0
    s_mov_b32 s24, 32768
    s_lshl_b32 s25, s14, 15
    s_lshr_b32 s26, s3, 1
    s_lshl_b32 s26, s26, 14
    s_add_u32 s25, s25, s26
    s_and_b32 s26, s3, 1
    s_lshl_b32 s26, s26, 9
    s_add_u32 s25, s25, s26
    s_lshl_b32 s26, s3, 13
    s_add_u32 s26, s26, s23
    s_add_u32 m0, s26, 0
    s_add_u32 s27, s25, 0
    buffer_load_dwordx4 v80, s[36:39], s27 offen lds
    s_add_u32 m0, s26, 1024
    s_add_u32 s27, s25, 8192
    buffer_load_dwordx4 v81, s[36:39], s27 offen lds
    s_add_u32 m0, s26, 2048
    s_add_u32 s27, s25, 128
    buffer_load_dwordx4 v80, s[36:39], s27 offen lds
    s_add_u32 m0, s26, 3072
    s_add_u32 s27, s25, 8320
    buffer_load_dwordx4 v81, s[36:39], s27 offen lds
    s_add_u32 m0, s26, 4096
    s_add_u32 s27, s25, 256
    buffer_load_dwordx4 v80, s[36:39], s27 offen lds
    s_add_u32 m0, s26, 5120
    s_add_u32 s27, s25, 8448
    buffer_load_dwordx4 v81, s[36:39], s27 offen lds
    s_add_u32 m0, s26, 6144
    s_add_u32 s27, s25, 384
    buffer_load_dwordx4 v80, s[36:39], s27 offen lds
    s_add_u32 m0, s26, 7168
    s_add_u32 s27, s25, 8576
    buffer_load_dwordx4 v81, s[36:39], s27 offen lds
    s_and_b32 s7, s3, 1
    s_lshl_b32 s7, s7, 4
    v_and_b32 v4, 15, v0
    v_add_u32 v4, s7, v4
    v_lshlrev_b32 v8, 2, v7
    v_sub_u32 v4, v4, v8
    v_cmp_le_i32 s[84:85], 0, v4
    v_cmp_le_i32 s[86:87], 1, v4
    v_cmp_le_i32 s[88:89], 2, v4
    v_cmp_le_i32 s[90:91], 3, v4
    v_cmp_le_i32 s[92:93], 16, v4
    v_cmp_le_i32 s[94:95], 17, v4
    v_cmp_le_i32 s[96:97], 18, v4
    v_cmp_le_i32 s[98:99], 19, v4
    s_mov_b32 s100, 0x3e0293ee
    v_and_b32 v8, 15, v0
    v_lshlrev_b32 v5, 4, v8
    v_add_u32 v5, 86016, v5
    s_lshl_b32 s7, s3, 2
    v_add_u32 v4, s7, v5
    s_lshr_b32 s7, s3, 1
    s_lshl_b32 s7, s7, 10
    s_and_b32 s8, s3, 1
    s_lshl_b32 s9, s8, 3
    s_add_u32 s7, s7, s9
    s_add_u32 s7, s7, 81920
    v_add_u32 v9, s7, v1
    s_lshl_b32 s9, s8, 12
    s_add_u32 s7, s9, 65536
    v_add_u32 v10, s7, v1
    s_lshr_b32 s7, s3, 1
    s_lshl_b32 s7, s7, 11
    s_add_u32 s7, s7, s9
    s_add_u32 s7, s7, 73728
    v_add_u32 v11, s7, v1
    v_lshlrev_b32 v12, 15, v8
    v_lshl_add_u32 v12, v7, 4, v12
    s_lshl_b32 s7, s3, 13
    s_lshl_b32 s8, s5, 8
    s_add_u32 s8, s8, s7
    v_add_u32 v12, s8, v12
    s_lshl_b32 s8, s5, 15
    s_add_u32 s8, s8, s7
    v_add_u32 v13, s8, v1
    v_bfe_u32 v14, v0, 2, 2
    v_lshlrev_b32 v14, 6, v14
    v_and_b32 v8, 3, v0
    v_lshl_add_u32 v14, v8, 3, v14
    v_bfe_u32 v8, v0, 4, 1
    v_lshl_add_u32 v14, v8, 5, v14
    s_lshl_b32 s8, s5, 10
    s_lshl_b32 s7, s3, 8
    s_add_u32 s8, s8, s7
    v_add_u32 v14, s8, v14
    v_lshlrev_b32 v15, 3, v0
    s_mul_i32 s21, s17, 2097152
    s_add_u32 s21, s21, 50331648
    v_and_b32 v7, 7, v0
    v_and_b32 v8, 1, v7
    v_lshlrev_b32 v8, 4, v8
    v_mov_b32 v16, 0x3f80
    v_lshlrev_b32 v8, v8, v16
    v_lshrrev_b32 v7, 1, v7
    v_cmp_eq_u32 vcc, 0, v7
    s_nop 1
    v_cndmask_b32 v20, 0, v8, vcc
    v_cmp_eq_u32 vcc, 1, v7
    s_nop 1
    v_cndmask_b32 v21, 0, v8, vcc
    v_cmp_eq_u32 vcc, 2, v7
    s_nop 1
    v_cndmask_b32 v22, 0, v8, vcc
    v_cmp_eq_u32 vcc, 3, v7
    s_nop 1
    v_cndmask_b32 v23, 0, v8, vcc
    v_add_u32 v16, 88064, v1
    ds_write_b128 v16, v[20:23]
    v_mov_b32 v24, 0x3f803f80
    v_mov_b32 v25, 0x3f803f80
    v_mov_b32 v26, 0x3f803f80
    v_mov_b32 v27, 0x3f803f80
    ds_write_b128 v16, v[24:27] offset:1024
    v_mov_b32 v24, 0xffbfffbf
    v_mov_b32 v25, 0xffbfffbf
    v_mov_b32 v26, 0xffbfffbf
    v_mov_b32 v27, 0xffbfffbf
    ds_write_b128 v16, v[24:27] offset:2048
    s_cmp_eq_u32 s6, 1
    s_cbranch_scc1 L_asafe_31
    s_add_u32 s8, s21, 0
    buffer_store_dwordx4 v[24:27], v13, s[68:71], s8 offen offset:0
    buffer_store_dwordx4 v[24:27], v13, s[68:71], s8 offen offset:1024
    buffer_store_dwordx4 v[24:27], v13, s[68:71], s8 offen offset:2048
    buffer_store_dwordx4 v[24:27], v13, s[68:71], s8 offen offset:3072
    s_add_u32 s8, s21, 4096
    buffer_store_dwordx4 v[24:27], v13, s[68:71], s8 offen offset:0
    buffer_store_dwordx4 v[24:27], v13, s[68:71], s8 offen offset:1024
    buffer_store_dwordx4 v[24:27], v13, s[68:71], s8 offen offset:2048
    buffer_store_dwordx4 v[24:27], v13, s[68:71], s8 offen offset:3072
    s_add_u32 s8, s21, 1048576
    buffer_store_dwordx4 v[24:27], v13, s[68:71], s8 offen offset:0
    buffer_store_dwordx4 v[24:27], v13, s[68:71], s8 offen offset:1024
    buffer_store_dwordx4 v[24:27], v13, s[68:71], s8 offen offset:2048
    buffer_store_dwordx4 v[24:27], v13, s[68:71], s8 offen offset:3072
    s_add_u32 s8, s21, 1052672
    buffer_store_dwordx4 v[24:27], v13, s[68:71], s8 offen offset:0
    buffer_store_dwordx4 v[24:27], v13, s[68:71], s8 offen offset:1024
    buffer_store_dwordx4 v[24:27], v13, s[68:71], s8 offen offset:2048
    buffer_store_dwordx4 v[24:27], v13, s[68:71], s8 offen offset:3072
    s_branch L_aj_32
    s_nop 0
L_asafe_31:
    s_add_u32 s8, s21, 0
    buffer_store_dwordx4 v[24:27], v13, s[68:71], s8 offen offset:0 sc1
    buffer_store_dwordx4 v[24:27], v13, s[68:71], s8 offen offset:1024 sc1
    buffer_store_dwordx4 v[24:27], v13, s[68:71], s8 offen offset:2048 sc1
    buffer_store_dwordx4 v[24:27], v13, s[68:71], s8 offen offset:3072 sc1
    s_add_u32 s8, s21, 4096
    buffer_store_dwordx4 v[24:27], v13, s[68:71], s8 offen offset:0 sc1
    buffer_store_dwordx4 v[24:27], v13, s[68:71], s8 offen offset:1024 sc1
    buffer_store_dwordx4 v[24:27], v13, s[68:71], s8 offen offset:2048 sc1
    buffer_store_dwordx4 v[24:27], v13, s[68:71], s8 offen offset:3072 sc1
    s_add_u32 s8, s21, 1048576
    buffer_store_dwordx4 v[24:27], v13, s[68:71], s8 offen offset:0 sc1
    buffer_store_dwordx4 v[24:27], v13, s[68:71], s8 offen offset:1024 sc1
    buffer_store_dwordx4 v[24:27], v13, s[68:71], s8 offen offset:2048 sc1
    buffer_store_dwordx4 v[24:27], v13, s[68:71], s8 offen offset:3072 sc1
    s_add_u32 s8, s21, 1052672
    buffer_store_dwordx4 v[24:27], v13, s[68:71], s8 offen offset:0 sc1
    buffer_store_dwordx4 v[24:27], v13, s[68:71], s8 offen offset:1024 sc1
    buffer_store_dwordx4 v[24:27], v13, s[68:71], s8 offen offset:2048 sc1
    buffer_store_dwordx4 v[24:27], v13, s[68:71], s8 offen offset:3072 sc1
    s_nop 1
L_aj_32:
    s_waitcnt vmcnt(0) lgkmcnt(0)
    s_barrier
    s_lshl_b32 s22, s4, 5
    s_cmp_eq_u32 s3, 0
    s_cbranch_scc0 L_ga_33
    v_mov_b32 v16, 1
    s_mov_b64 exec, 1
    buffer_atomic_add v16, off, s[72:75], s22 offset:24
    s_mov_b64 exec, -1
L_ga_33:
    s_mov_b32 s34, 0x5d800000
    s_mov_b32 s35, 1
    s_add_u32 s7, s30, 65536
    v_add_u32 v6, s7, v1
    v_lshlrev_b32 v2, 2, v0
    v_mov_b32 v0, v80
    s_mov_b32 s33, s14
    s_mov_b32 s101, 0
    s_waitcnt vmcnt(0)
    s_barrier
    s_add_u32 s28, s33, 4
    v_xor_b32 v68, 64, v0
    s_lshl_b32 s25, s28, 15
    s_lshr_b32 s26, s3, 1
    s_lshl_b32 s26, s26, 14
    s_add_u32 s25, s25, s26
    s_and_b32 s26, s3, 1
    s_lshl_b32 s26, s26, 9
    s_add_u32 s25, s25, s26
    s_lshl_b32 s26, s3, 13
    s_add_u32 s26, s26, s24
    s_add_u32 m0, s26, 0
    s_add_u32 s27, s25, 0
    buffer_load_dwordx4 v0, s[36:39], s27 offen lds
    s_add_u32 m0, s26, 1024
    s_add_u32 s27, s25, 8192
    buffer_load_dwordx4 v68, s[36:39], s27 offen lds
    s_add_u32 m0, s26, 2048
    s_add_u32 s27, s25, 128
    buffer_load_dwordx4 v0, s[36:39], s27 offen lds
    s_add_u32 m0, s26, 3072
    s_add_u32 s27, s25, 8320
    buffer_load_dwordx4 v68, s[36:39], s27 offen lds
    s_add_u32 m0, s26, 4096
    s_add_u32 s27, s25, 256
    buffer_load_dwordx4 v0, s[36:39], s27 offen lds
    s_add_u32 m0, s26, 5120
    s_add_u32 s27, s25, 8448
    buffer_load_dwordx4 v68, s[36:39], s27 offen lds
    s_add_u32 m0, s26, 6144
    s_add_u32 s27, s25, 384
    buffer_load_dwordx4 v0, s[36:39], s27 offen lds
    s_add_u32 m0, s26, 7168
    s_add_u32 s27, s25, 8576
    buffer_load_dwordx4 v68, s[36:39], s27 offen lds
    v_add_u32 v7, s23, v3
    v_xor_b32 v67, 64, v7
    s_lshl_b32 s7, s3, 12
    v_add_u32 v8, s7, v7
    v_xor_b32 v76, 64, v8
    ds_read_b128 v[16:19], v7 offset:0
    ds_read_b128 v[20:23], v7 offset:16384
    ds_read_b128 v[24:27], v67 offset:0
    s_waitcnt lgkmcnt(2)
    v_mfma_f32_16x16x32_bf16 v[32:35], a[0:3], v[16:19], 0
    ds_read_b128 v[28:31], v67 offset:16384
    v_mfma_f32_16x16x32_bf16 v[40:43], a[64:67], v[16:19], 0
    v_mfma_f32_16x16x32_bf16 v[48:51], v[128:131], v[16:19], 0
    s_waitcnt lgkmcnt(2)
    v_mfma_f32_16x16x32_bf16 v[36:39], a[0:3], v[20:23], 0
    ds_read_b128 v[16:19], v7 offset:2048
    v_mfma_f32_16x16x32_bf16 v[44:47], a[64:67], v[20:23], 0
    v_mfma_f32_16x16x32_bf16 v[52:55], v[128:131], v[20:23], 0
    s_waitcnt lgkmcnt(2)
    v_mfma_f32_16x16x32_bf16 v[32:35], a[4:7], v[24:27], v[32:35]
    ds_read_b128 v[20:23], v7 offset:18432
    v_mfma_f32_16x16x32_bf16 v[40:43], a[68:71], v[24:27], v[40:43]
    v_mfma_f32_16x16x32_bf16 v[48:51], v[132:135], v[24:27], v[48:51]
    s_waitcnt lgkmcnt(2)
    v_mfma_f32_16x16x32_bf16 v[36:39], a[4:7], v[28:31], v[36:39]
    ds_read_b128 v[24:27], v67 offset:2048
    v_mfma_f32_16x16x32_bf16 v[44:47], a[68:71], v[28:31], v[44:47]
    v_mfma_f32_16x16x32_bf16 v[52:55], v[132:135], v[28:31], v[52:55]
    s_waitcnt lgkmcnt(2)
    v_mfma_f32_16x16x32_bf16 v[32:35], a[8:11], v[16:19], v[32:35]
    ds_read_b128 v[28:31], v67 offset:18432
    v_mfma_f32_16x16x32_bf16 v[40:43], a[72:75], v[16:19], v[40:43]
    v_mfma_f32_16x16x32_bf16 v[48:51], v[136:139], v[16:19], v[48:51]
    s_waitcnt lgkmcnt(2)
    v_mfma_f32_16x16x32_bf16 v[36:39], a[8:11], v[20:23], v[36:39]
    ds_read_b128 v[16:19], v7 offset:4096
    v_mfma_f32_16x16x32_bf16 v[44:47], a[72:75], v[20:23], v[44:47]
    v_mfma_f32_16x16x32_bf16 v[52:55], v[136:139], v[20:23], v[52:55]
    s_waitcnt lgkmcnt(2)
    v_mfma_f32_16x16x32_bf16 v[32:35], a[12:15], v[24:27], v[32:35]
    ds_read_b128 v[20:23], v7 offset:20480
    v_mfma_f32_16x16x32_bf16 v[40:43], a[76:79], v[24:27], v[40:43]
    v_mfma_f32_16x16x32_bf16 v[48:51], v[140:143], v[24:27], v[48:51]
    s_waitcnt lgkmcnt(2)
    v_mfma_f32_16x16x32_bf16 v[36:39], a[12:15], v[28:31], v[36:39]
    ds_read_b128 v[24:27], v67 offset:4096
    v_mfma_f32_16x16x32_bf16 v[44:47], a[76:79], v[28:31], v[44:47]
    v_mfma_f32_16x16x32_bf16 v[52:55], v[140:143], v[28:31], v[52:55]
    s_waitcnt lgkmcnt(2)
    v_mfma_f32_16x16x32_bf16 v[32:35], a[16:19], v[16:19], v[32:35]
    ds_read_b128 v[28:31], v67 offset:20480
    v_mfma_f32_16x16x32_bf16 v[40:43], a[80:83], v[16:19], v[40:43]
    v_mfma_f32_16x16x32_bf16 v[48:51], v[144:147], v[16:19], v[48:51]
    s_waitcnt lgkmcnt(2)
    v_mfma_f32_16x16x32_bf16 v[36:39], a[16:19], v[20:23], v[36:39]
    ds_read_b128 v[16:19], v7 offset:6144
    v_mfma_f32_16x16x32_bf16 v[44:47], a[80:83], v[20:23], v[44:47]
    v_mfma_f32_16x16x32_bf16 v[52:55], v[144:147], v[20:23], v[52:55]
    s_waitcnt lgkmcnt(2)
    v_mfma_f32_16x16x32_bf16 v[32:35], a[20:23], v[24:27], v[32:35]
    ds_read_b128 v[20:23], v7 offset:22528
    v_mfma_f32_16x16x32_bf16 v[40:43], a[84:87], v[24:27], v[40:43]
    v_mfma_f32_16x16x32_bf16 v[48:51], v[148:151], v[24:27], v[48:51]
    s_waitcnt lgkmcnt(2)
    v_mfma_f32_16x16x32_bf16 v[36:39], a[20:23], v[28:31], v[36:39]
    ds_read_b128 v[24:27], v67 offset:6144
    v_mfma_f32_16x16x32_bf16 v[44:47], a[84:87], v[28:31], v[44:47]
    v_mfma_f32_16x16x32_bf16 v[52:55], v[148:151], v[28:31], v[52:55]
    s_waitcnt lgkmcnt(2)
    v_mfma_f32_16x16x32_bf16 v[32:35], a[24:27], v[16:19], v[32:35]
    ds_read_b128 v[28:31], v67 offset:22528
    v_mfma_f32_16x16x32_bf16 v[40:43], a[88:91], v[16:19], v[40:43]
    v_mfma_f32_16x16x32_bf16 v[48:51], v[152:155], v[16:19], v[48:51]
    s_waitcnt lgkmcnt(2)
    v_mfma_f32_16x16x32_bf16 v[36:39], a[24:27], v[20:23], v[36:39]
    ds_read_b128 v[16:19], v7 offset:8192
    v_mfma_f32_16x16x32_bf16 v[44:47], a[88:91], v[20:23], v[44:47]
    v_mfma_f32_16x16x32_bf16 v[52:55], v[152:155], v[20:23], v[52:55]
    s_waitcnt lgkmcnt(2)
    v_mfma_f32_16x16x32_bf16 v[32:35], a[28:31], v[24:27], v[32:35]
    ds_read_b128 v[20:23], v7 offset:24576
    v_mfma_f32_16x16x32_bf16 v[40:43], a[92:95], v[24:27], v[40:43]
    v_mfma_f32_16x16x32_bf16 v[48:51], v[156:159], v[24:27], v[48:51]
    s_waitcnt lgkmcnt(2)
    v_mfma_f32_16x16x32_bf16 v[36:39], a[28:31], v[28:31], v[36:39]
    ds_read_b128 v[24:27], v67 offset:8192
    v_mfma_f32_16x16x32_bf16 v[44:47], a[92:95], v[28:31], v[44:47]
    v_mfma_f32_16x16x32_bf16 v[52:55], v[156:159], v[28:31], v[52:55]
    s_waitcnt lgkmcnt(2)
    v_mfma_f32_16x16x32_bf16 v[32:35], a[32:35], v[16:19], v[32:35]
    ds_read_b128 v[28:31], v67 offset:24576
    v_mfma_f32_16x16x32_bf16 v[40:43], a[96:99], v[16:19], v[40:43]
    v_mfma_f32_16x16x32_bf16 v[48:51], v[160:163], v[16:19], v[48:51]
    s_waitcnt lgkmcnt(2)
    v_mfma_f32_16x16x32_bf16 v[36:39], a[32:35], v[20:23], v[36:39]
    ds_read_b128 v[16:19], v7 offset:10240
    v_mfma_f32_16x16x32_bf16 v[44:47], a[96:99], v[20:23], v[44:47]
    v_mfma_f32_16x16x32_bf16 v[52:55], v[160:163], v[20:23], v[52:55]
    s_waitcnt lgkmcnt(2)
    v_mfma_f32_16x16x32_bf16 v[32:35], a[36:39], v[24:27], v[32:35]
    ds_read_b128 v[20:23], v7 offset:26624
    v_mfma_f32_16x16x32_bf16 v[40:43], a[100:103], v[24:27], v[40:43]
    v_mfma_f32_16x16x32_bf16 v[48:51], v[164:167], v[24:27], v[48:51]
    s_waitcnt lgkmcnt(2)
    v_mfma_f32_16x16x32_bf16 v[36:39], a[36:39], v[28:31], v[36:39]
    ds_read_b128 v[24:27], v67 offset:10240
    v_mfma_f32_16x16x32_bf16 v[44:47], a[100:103], v[28:31], v[44:47]
    v_mfma_f32_16x16x32_bf16 v[52:55], v[164:167], v[28:31], v[52:55]
    s_waitcnt lgkmcnt(2)
    v_mfma_f32_16x16x32_bf16 v[32:35], a[40:43], v[16:19], v[32:35]
    ds_read_b128 v[28:31], v67 offset:26624
    v_mfma_f32_16x16x32_bf16 v[40:43], a[104:107], v[16:19], v[40:43]
    v_mfma_f32_16x16x32_bf16 v[48:51], v[168:171], v[16:19], v[48:51]
    s_waitcnt lgkmcnt(2)
    v_mfma_f32_16x16x32_bf16 v[36:39], a[40:43], v[20:23], v[36:39]
    ds_read_b128 v[16:19], v7 offset:12288
    v_mfma_f32_16x16x32_bf16 v[44:47], a[104:107], v[20:23], v[44:47]
    v_mfma_f32_16x16x32_bf16 v[52:55], v[168:171], v[20:23], v[52:55]
    s_waitcnt lgkmcnt(2)
    v_mfma_f32_16x16x32_bf16 v[32:35], a[44:47], v[24:27], v[32:35]
    ds_read_b128 v[20:23], v7 offset:28672
    v_mfma_f32_16x16x32_bf16 v[40:43], a[108:111], v[24:27], v[40:43]
    v_mfma_f32_16x16x32_bf16 v[48:51], v[172:175], v[24:27], v[48:51]
    s_waitcnt lgkmcnt(2)
    v_mfma_f32_16x16x32_bf16 v[36:39], a[44:47], v[28:31], v[36:39]
    ds_read_b128 v[24:27], v67 offset:12288
    v_mfma_f32_16x16x32_bf16 v[44:47], a[108:111], v[28:31], v[44:47]
    v_mfma_f32_16x16x32_bf16 v[52:55], v[172:175], v[28:31], v[52:55]
    s_waitcnt lgkmcnt(2)
    v_mfma_f32_16x16x32_bf16 v[32:35], a[48:51], v[16:19], v[32:35]
    ds_read_b128 v[28:31], v67 offset:28672
    v_mfma_f32_16x16x32_bf16 v[40:43], a[112:115], v[16:19], v[40:43]
    v_mfma_f32_16x16x32_bf16 v[48:51], v[176:179], v[16:19], v[48:51]
    s_waitcnt lgkmcnt(2)
    v_mfma_f32_16x16x32_bf16 v[36:39], a[48:51], v[20:23], v[36:39]
    ds_read_b128 v[16:19], v7 offset:14336
    v_mfma_f32_16x16x32_bf16 v[44:47], a[112:115], v[20:23], v[44:47]
    v_mfma_f32_16x16x32_bf16 v[52:55], v[176:179], v[20:23], v[52:55]
    s_waitcnt lgkmcnt(2)
    v_mfma_f32_16x16x32_bf16 v[32:35], a[52:55], v[24:27], v[32:35]
    ds_read_b128 v[20:23], v7 offset:30720
    v_mfma_f32_16x16x32_bf16 v[40:43], a[116:119], v[24:27], v[40:43]
    v_mfma_f32_16x16x32_bf16 v[48:51], v[180:183], v[24:27], v[48:51]
    s_waitcnt lgkmcnt(2)
    v_mfma_f32_16x16x32_bf16 v[36:39], a[52:55], v[28:31], v[36:39]
    ds_read_b128 v[24:27], v67 offset:14336
    v_mfma_f32_16x16x32_bf16 v[44:47], a[116:119], v[28:31], v[44:47]
    v_mfma_f32_16x16x32_bf16 v[52:55], v[180:183], v[28:31], v[52:55]
    s_waitcnt lgkmcnt(2)
    v_mfma_f32_16x16x32_bf16 v[32:35], a[56:59], v[16:19], v[32:35]
    ds_read_b128 v[28:31], v67 offset:30720
    v_mfma_f32_16x16x32_bf16 v[40:43], a[120:123], v[16:19], v[40:43]
    v_mfma_f32_16x16x32_bf16 v[48:51], v[184:187], v[16:19], v[48:51]
    s_waitcnt lgkmcnt(2)
    v_mfma_f32_16x16x32_bf16 v[36:39], a[56:59], v[20:23], v[36:39]
    ds_read_b128 v[16:19], v8 offset:0
    v_mfma_f32_16x16x32_bf16 v[44:47], a[120:123], v[20:23], v[44:47]
    v_mfma_f32_16x16x32_bf16 v[52:55], v[184:187], v[20:23], v[52:55]
    s_waitcnt lgkmcnt(2)
    v_mfma_f32_16x16x32_bf16 v[32:35], a[60:63], v[24:27], v[32:35]
    ds_read_b128 v[20:23], v8 offset:16384
    v_mfma_f32_16x16x32_bf16 v[40:43], a[124:127], v[24:27], v[40:43]
    v_mfma_f32_16x16x32_bf16 v[48:51], v[188:191], v[24:27], v[48:51]
    s_waitcnt lgkmcnt(2)
    v_mfma_f32_16x16x32_bf16 v[36:39], a[60:63], v[28:31], v[36:39]
    ds_read_b128 v[24:27], v76 offset:0
    v_mfma_f32_16x16x32_bf16 v[44:47], a[124:127], v[28:31], v[44:47]
    v_mfma_f32_16x16x32_bf16 v[52:55], v[188:191], v[28:31], v[52:55]
    s_waitcnt lgkmcnt(2)
    v_mfma_f32_16x16x32_bf16 v[56:59], v[112:115], v[16:19], 0
    ds_read_b128 v[28:31], v76 offset:16384
    s_waitcnt lgkmcnt(2)
    v_mfma_f32_16x16x32_bf16 v[60:63], v[112:115], v[20:23], 0
    ds_read_b128 v[16:19], v8 offset:2048
    s_waitcnt lgkmcnt(2)
    v_mfma_f32_16x16x32_bf16 v[56:59], v[116:119], v[24:27], v[56:59]
    ds_read_b128 v[20:23], v8 offset:18432
    s_waitcnt lgkmcnt(2)
    v_mfma_f32_16x16x32_bf16 v[60:63], v[116:119], v[28:31], v[60:63]
    ds_read_b128 v[24:27], v76 offset:2048
    s_waitcnt lgkmcnt(2)
    v_mfma_f32_16x16x32_bf16 v[56:59], v[120:123], v[16:19], v[56:59]
    ds_read_b128 v[28:31], v76 offset:18432
    s_waitcnt lgkmcnt(2)
    v_mfma_f32_16x16x32_bf16 v[60:63], v[120:123], v[20:23], v[60:63]
    s_waitcnt lgkmcnt(1)
    v_mfma_f32_16x16x32_bf16 v[56:59], v[124:127], v[24:27], v[56:59]
    s_waitcnt lgkmcnt(0)
    v_mfma_f32_16x16x32_bf16 v[60:63], v[124:127], v[28:31], v[60:63]
    v_mul_f32 v32, s100, v32
    v_mul_f32 v33, s100, v33
    v_mul_f32 v34, s100, v34
    v_mul_f32 v35, s100, v35
    v_mul_f32 v36, s100, v36
    v_mul_f32 v37, s100, v37
    v_mul_f32 v38, s100, v38
    v_mul_f32 v39, s100, v39
    v_mul_f32 v40, s100, v40
    v_mul_f32 v41, s100, v41
    v_mul_f32 v42, s100, v42
    v_mul_f32 v43, s100, v43
    v_mul_f32 v44, s100, v44
    v_mul_f32 v45, s100, v45
    v_mul_f32 v46, s100, v46
    v_mul_f32 v47, s100, v47
    v_cvt_pk_bf16_f32 v68, v32, v40
    v_cvt_pk_bf16_f32 v69, v33, v41
    v_cvt_pk_bf16_f32 v70, v34, v42
    v_cvt_pk_bf16_f32 v71, v35, v43
    ds_write_b128 v6, v[68:71] offset:0
    v_cvt_pk_bf16_f32 v72, v36, v44
    v_cvt_pk_bf16_f32 v73, v37, v45
    v_cvt_pk_bf16_f32 v74, v38, v46
    v_cvt_pk_bf16_f32 v75, v39, v47
    ds_write_b128 v6, v[72:75] offset:4096
    ds_write_b32 v4, v56 offset:0
    ds_write_b32 v4, v60 offset:256
    s_waitcnt lgkmcnt(0)
    s_barrier
    ds_read_b128 v[68:71], v5 offset:0
    ds_read_b128 v[72:75], v5 offset:256
    s_waitcnt lgkmcnt(0)
    s_mov_b32 s9, 0xbfb8aa3b
    v_add_f32 v68, v68, v69
    v_add_f32 v70, v70, v71
    v_add_f32 v68, v68, v70
    v_mul_f32 v68, s9, v68
    v_exp_f32 v68, v68
    s_nop 0
    v_add_f32 v68, 1.0, v68
    v_rcp_f32 v56, v68
    v_add_f32 v72, v72, v73
    v_add_f32 v74, v74, v75
    v_add_f32 v72, v72, v74
    v_mul_f32 v72, s9, v72
    v_exp_f32 v72, v72
    s_nop 0
    v_add_f32 v72, 1.0, v72
    v_rcp_f32 v57, v72
    s_and_b32 s7, s3, 1
    s_cmp_eq_u32 s7, 1
    s_cselect_b64 vcc, -1, 0
    v_cndmask_b32 v65, v56, v57, vcc
    v_sub_f32 v76, 1.0, v56
    v_mul_f32 v68, s9, v48
    v_mul_f32 v69, s9, v49
    v_mul_f32 v70, s9, v50
    v_mul_f32 v71, s9, v51
    v_exp_f32 v68, v68
    v_exp_f32 v69, v69
    v_exp_f32 v70, v70
    v_exp_f32 v71, v71
    v_add_f32 v68, 1.0, v68
    v_mul_f32 v48, v48, v76
    v_add_f32 v69, 1.0, v69
    v_mul_f32 v49, v49, v76
    v_add_f32 v70, 1.0, v70
    v_mul_f32 v50, v50, v76
    v_add_f32 v71, 1.0, v71
    v_mul_f32 v51, v51, v76
    v_rcp_f32 v68, v68
    v_rcp_f32 v69, v69
    v_rcp_f32 v70, v70
    v_rcp_f32 v71, v71
    v_mul_f32 v48, v48, v68
    v_mul_f32 v49, v49, v69
    v_mul_f32 v50, v50, v70
    v_mul_f32 v51, v51, v71
    v_cvt_pk_bf16_f32 v72, v48, v49
    v_cvt_pk_bf16_f32 v73, v50, v51
    ds_write_b64 v9, v[72:73] offset:0
    v_sub_f32 v76, 1.0, v57
    v_mul_f32 v68, s9, v52
    v_mul_f32 v69, s9, v53
    v_mul_f32 v70, s9, v54
    v_mul_f32 v71, s9, v55
    v_exp_f32 v68, v68
    v_exp_f32 v69, v69
    v_exp_f32 v70, v70
    v_exp_f32 v71, v71
    v_add_f32 v68, 1.0, v68
    v_mul_f32 v52, v52, v76
    v_add_f32 v69, 1.0, v69
    v_mul_f32 v53, v53, v76
    v_add_f32 v70, 1.0, v70
    v_mul_f32 v54, v54, v76
    v_add_f32 v71, 1.0, v71
    v_mul_f32 v55, v55, v76
    v_rcp_f32 v68, v68
    v_rcp_f32 v69, v69
    v_rcp_f32 v70, v70
    v_rcp_f32 v71, v71
    v_mul_f32 v52, v52, v68
    v_mul_f32 v53, v53, v69
    v_mul_f32 v54, v54, v70
    v_mul_f32 v55, v55, v71
    v_cvt_pk_bf16_f32 v72, v52, v53
    v_cvt_pk_bf16_f32 v73, v54, v55
    ds_write_b64 v9, v[72:73] offset:2048
    s_add_u32 s33, s33, 4
    s_mov_b32 s7, s23
    s_mov_b32 s23, s24
    s_mov_b32 s24, s7
    v_xor_b32 v6, 0x8000, v6
    v_xor_b32 v9, 0x8000, v9
    s_nop 1
L_p3:
    s_cmp_ge_u32 s14, 64
    s_cbranch_scc1 L_p3end_34
    v_mov_b32 v66, v65
    s_cmp_ge_u32 s33, 64
    s_cbranch_scc1 L_noa_35
    s_waitcnt vmcnt(0)
    s_barrier
    s_lshl_b32 s10, s14, 7
    s_lshl_b32 s7, s5, 2
    s_add_u32 s22, s10, s7
    s_add_u32 s10, s22, 48234496
    s_lshl_b32 s20, s14, 18
    s_lshl_b32 s7, s5, 13
    s_add_u32 s20, s20, s7
    buffer_load_dword v69, off, s[68:71], s10 sc1
    s_add_u32 s28, s33, 4
    v_xor_b32 v68, 64, v0
    s_lshl_b32 s25, s28, 15
    s_lshr_b32 s26, s3, 1
    s_lshl_b32 s26, s26, 14
    s_add_u32 s25, s25, s26
    s_and_b32 s26, s3, 1
    s_lshl_b32 s26, s26, 9
    s_add_u32 s25, s25, s26
    s_lshl_b32 s26, s3, 13
    s_add_u32 s26, s26, s24
    s_add_u32 m0, s26, 0
    s_add_u32 s27, s25, 0
    buffer_load_dwordx4 v0, s[36:39], s27 offen lds
    s_add_u32 m0, s26, 1024
    s_add_u32 s27, s25, 8192
    buffer_load_dwordx4 v68, s[36:39], s27 offen lds
    s_add_u32 m0, s26, 2048
    s_add_u32 s27, s25, 128
    buffer_load_dwordx4 v0, s[36:39], s27 offen lds
    s_add_u32 m0, s26, 3072
    s_add_u32 s27, s25, 8320
    buffer_load_dwordx4 v68, s[36:39], s27 offen lds
    s_add_u32 m0, s26, 4096
    s_add_u32 s27, s25, 256
    buffer_load_dwordx4 v0, s[36:39], s27 offen lds
    s_add_u32 m0, s26, 5120
    s_add_u32 s27, s25, 8448
    buffer_load_dwordx4 v68, s[36:39], s27 offen lds
    s_add_u32 m0, s26, 6144
    s_add_u32 s27, s25, 384
    buffer_load_dwordx4 v0, s[36:39], s27 offen lds
    s_add_u32 m0, s26, 7168
    s_add_u32 s27, s25, 8576
    buffer_load_dwordx4 v68, s[36:39], s27 offen lds
    v_add_u32 v7, s23, v3
    v_xor_b32 v67, 64, v7
    s_lshl_b32 s7, s3, 12
    v_add_u32 v8, s7, v7
    v_xor_b32 v76, 64, v8
    ds_read_b128 v[16:19], v7 offset:0
    ds_read_b128 v[20:23], v7 offset:16384
    ds_read_b128 v[24:27], v67 offset:0
    s_waitcnt lgkmcnt(2)
    v_mfma_f32_16x16x32_bf16 v[32:35], a[0:3], v[16:19], 0
    ds_read_b128 v[28:31], v67 offset:16384
    v_mfma_f32_16x16x32_bf16 v[40:43], a[64:67], v[16:19], 0
    v_mfma_f32_16x16x32_bf16 v[48:51], v[128:131], v[16:19], 0
    s_waitcnt lgkmcnt(2)
    v_mfma_f32_16x16x32_bf16 v[36:39], a[0:3], v[20:23], 0
    ds_read_b128 v[16:19], v7 offset:2048
    v_mfma_f32_16x16x32_bf16 v[44:47], a[64:67], v[20:23], 0
    v_mfma_f32_16x16x32_bf16 v[52:55], v[128:131], v[20:23], 0
    s_waitcnt lgkmcnt(2)
    v_mfma_f32_16x16x32_bf16 v[32:35], a[4:7], v[24:27], v[32:35]
    ds_read_b128 v[20:23], v7 offset:18432
    v_mfma_f32_16x16x32_bf16 v[40:43], a[68:71], v[24:27], v[40:43]
    v_mfma_f32_16x16x32_bf16 v[48:51], v[132:135], v[24:27], v[48:51]
    s_waitcnt lgkmcnt(2)
    v_mfma_f32_16x16x32_bf16 v[36:39], a[4:7], v[28:31], v[36:39]
    ds_read_b128 v[24:27], v67 offset:2048
    v_mfma_f32_16x16x32_bf16 v[44:47], a[68:71], v[28:31], v[44:47]
    v_mfma_f32_16x16x32_bf16 v[52:55], v[132:135], v[28:31], v[52:55]
    s_waitcnt lgkmcnt(2)
    v_mfma_f32_16x16x32_bf16 v[32:35], a[8:11], v[16:19], v[32:35]
    ds_read_b128 v[28:31], v67 offset:18432
    v_mfma_f32_16x16x32_bf16 v[40:43], a[72:75], v[16:19], v[40:43]
    v_mfma_f32_16x16x32_bf16 v[48:51], v[136:139], v[16:19], v[48:51]
    s_waitcnt lgkmcnt(2)
    v_mfma_f32_16x16x32_bf16 v[36:39], a[8:11], v[20:23], v[36:39]
    ds_read_b128 v[16:19], v7 offset:4096
    v_mfma_f32_16x16x32_bf16 v[44:47], a[72:75], v[20:23], v[44:47]
    v_mfma_f32_16x16x32_bf16 v[52:55], v[136:139], v[20:23], v[52:55]
    s_waitcnt lgkmcnt(2)
    v_mfma_f32_16x16x32_bf16 v[32:35], a[12:15], v[24:27], v[32:35]
    ds_read_b128 v[20:23], v7 offset:20480
    v_mfma_f32_16x16x32_bf16 v[40:43], a[76:79], v[24:27], v[40:43]
    v_mfma_f32_16x16x32_bf16 v[48:51], v[140:143], v[24:27], v[48:51]
    s_waitcnt lgkmcnt(2)
    v_mfma_f32_16x16x32_bf16 v[36:39], a[12:15], v[28:31], v[36:39]
    ds_read_b128 v[24:27], v67 offset:4096
    v_mfma_f32_16x16x32_bf16 v[44:47], a[76:79], v[28:31], v[44:47]
    v_mfma_f32_16x16x32_bf16 v[52:55], v[140:143], v[28:31], v[52:55]
    s_waitcnt lgkmcnt(2)
    v_mfma_f32_16x16x32_bf16 v[32:35], a[16:19], v[16:19], v[32:35]
    ds_read_b128 v[28:31], v67 offset:20480
    v_mfma_f32_16x16x32_bf16 v[40:43], a[80:83], v[16:19], v[40:43]
    v_mfma_f32_16x16x32_bf16 v[48:51], v[144:147], v[16:19], v[48:51]
    s_waitcnt lgkmcnt(2)
    v_mfma_f32_16x16x32_bf16 v[36:39], a[16:19], v[20:23], v[36:39]
    ds_read_b128 v[16:19], v7 offset:6144
    v_mfma_f32_16x16x32_bf16 v[44:47], a[80:83], v[20:23], v[44:47]
    v_mfma_f32_16x16x32_bf16 v[52:55], v[144:147], v[20:23], v[52:55]
    s_waitcnt lgkmcnt(2)
    v_mfma_f32_16x16x32_bf16 v[32:35], a[20:23], v[24:27], v[32:35]
    ds_read_b128 v[20:23], v7 offset:22528
    v_mfma_f32_16x16x32_bf16 v[40:43], a[84:87], v[24:27], v[40:43]
    v_mfma_f32_16x16x32_bf16 v[48:51], v[148:151], v[24:27], v[48:51]
    s_waitcnt lgkmcnt(2)
    v_mfma_f32_16x16x32_bf16 v[36:39], a[20:23], v[28:31], v[36:39]
    ds_read_b128 v[24:27], v67 offset:6144
    v_mfma_f32_16x16x32_bf16 v[44:47], a[84:87], v[28:31], v[44:47]
    v_mfma_f32_16x16x32_bf16 v[52:55], v[148:151], v[28:31], v[52:55]
    s_waitcnt lgkmcnt(2)
    v_mfma_f32_16x16x32_bf16 v[32:35], a[24:27], v[16:19], v[32:35]
    ds_read_b128 v[28:31], v67 offset:22528
    v_mfma_f32_16x16x32_bf16 v[40:43], a[88:91], v[16:19], v[40:43]
    v_mfma_f32_16x16x32_bf16 v[48:51], v[152:155], v[16:19], v[48:51]
    s_waitcnt lgkmcnt(2)
    v_mfma_f32_16x16x32_bf16 v[36:39], a[24:27], v[20:23], v[36:39]
    ds_read_b128 v[16:19], v7 offset:8192
    v_mfma_f32_16x16x32_bf16 v[44:47], a[88:91], v[20:23], v[44:47]
    v_mfma_f32_16x16x32_bf16 v[52:55], v[152:155], v[20:23], v[52:55]
    s_waitcnt lgkmcnt(2)
    v_mfma_f32_16x16x32_bf16 v[32:35], a[28:31], v[24:27], v[32:35]
    ds_read_b128 v[20:23], v7 offset:24576
    v_mfma_f32_16x16x32_bf16 v[40:43], a[92:95], v[24:27], v[40:43]
    v_mfma_f32_16x16x32_bf16 v[48:51], v[156:159], v[24:27], v[48:51]
    s_waitcnt lgkmcnt(2)
    v_mfma_f32_16x16x32_bf16 v[36:39], a[28:31], v[28:31], v[36:39]
    ds_read_b128 v[24:27], v67 offset:8192
    v_mfma_f32_16x16x32_bf16 v[44:47], a[92:95], v[28:31], v[44:47]
    v_mfma_f32_16x16x32_bf16 v[52:55], v[156:159], v[28:31], v[52:55]
    s_waitcnt vmcnt(8)
    v_readfirstlane_b32 s7, v69
    s_nop 0
    s_cmp_eq_u32 s7, 1
    s_cbranch_scc1 L_kvr_37
    s_mov_b32 s15, 1048576
    s_nop 1
L_poll_38:
    buffer_load_dword v69, off, s[68:71], s10 offset:0 sc1
    s_waitcnt vmcnt(0)
    v_readfirstlane_b32 s7, v69
    s_nop 0
    s_cmp_eq_u32 s7, 1
    s_cbranch_scc1 L_polld_39
    s_sub_u32 s15, s15, 1
    s_cmp_eq_u32 s15, 0
    s_cbranch_scc1 L_err_12
    s_sleep 2
    s_branch L_poll_38
L_polld_39:
L_kvr_37:
    s_add_u32 s8, s20, 4096
    buffer_load_dwordx4 v[80:83], v1, s[68:71], s20 offen offset:0 sc1
    buffer_load_dwordx4 v[84:87], v1, s[68:71], s20 offen offset:1024 sc1
    buffer_load_dwordx4 v[88:91], v1, s[68:71], s20 offen offset:2048 sc1
    buffer_load_dwordx4 v[92:95], v1, s[68:71], s20 offen offset:3072 sc1
    buffer_load_dwordx4 v[96:99], v1, s[68:71], s8 offen offset:0 sc1
    buffer_load_dwordx4 v[100:103], v1, s[68:71], s8 offen offset:1024 sc1
    buffer_load_dwordx4 v[104:107], v1, s[68:71], s8 offen offset:2048 sc1
    buffer_load_dwordx4 v[108:111], v1, s[68:71], s8 offen offset:3072 sc1
    s_waitcnt lgkmcnt(2)
    v_mfma_f32_16x16x32_bf16 v[32:35], a[32:35], v[16:19], v[32:35]
    ds_read_b128 v[28:31], v67 offset:24576
    v_mfma_f32_16x16x32_bf16 v[40:43], a[96:99], v[16:19], v[40:43]
    v_mfma_f32_16x16x32_bf16 v[48:51], v[160:163], v[16:19], v[48:51]
    s_waitcnt lgkmcnt(2)
    v_mfma_f32_16x16x32_bf16 v[36:39], a[32:35], v[20:23], v[36:39]
    ds_read_b128 v[16:19], v7 offset:10240
    v_mfma_f32_16x16x32_bf16 v[44:47], a[96:99], v[20:23], v[44:47]
    v_mfma_f32_16x16x32_bf16 v[52:55], v[160:163], v[20:23], v[52:55]
    s_waitcnt lgkmcnt(2)
    v_mfma_f32_16x16x32_bf16 v[32:35], a[36:39], v[24:27], v[32:35]
    ds_read_b128 v[20:23], v7 offset:26624
    v_mfma_f32_16x16x32_bf16 v[40:43], a[100:103], v[24:27], v[40:43]
    v_mfma_f32_16x16x32_bf16 v[48:51], v[164:167], v[24:27], v[48:51]
    s_waitcnt lgkmcnt(2)
    v_mfma_f32_16x16x32_bf16 v[36:39], a[36:39], v[28:31], v[36:39]
    ds_read_b128 v[24:27], v67 offset:10240
    v_mfma_f32_16x16x32_bf16 v[44:47], a[100:103], v[28:31], v[44:47]
    v_mfma_f32_16x16x32_bf16 v[52:55], v[164:167], v[28:31], v[52:55]
    s_waitcnt lgkmcnt(2)
    v_mfma_f32_16x16x32_bf16 v[32:35], a[40:43], v[16:19], v[32:35]
    ds_read_b128 v[28:31], v67 offset:26624
    v_mfma_f32_16x16x32_bf16 v[40:43], a[104:107], v[16:19], v[40:43]
    v_mfma_f32_16x16x32_bf16 v[48:51], v[168:171], v[16:19], v[48:51]
    s_waitcnt lgkmcnt(2)
    v_mfma_f32_16x16x32_bf16 v[36:39], a[40:43], v[20:23], v[36:39]
    ds_read_b128 v[16:19], v7 offset:12288
    v_mfma_f32_16x16x32_bf16 v[44:47], a[104:107], v[20:23], v[44:47]
    v_mfma_f32_16x16x32_bf16 v[52:55], v[168:171], v[20:23], v[52:55]
    s_waitcnt lgkmcnt(2)
    v_mfma_f32_16x16x32_bf16 v[32:35], a[44:47], v[24:27], v[32:35]
    ds_read_b128 v[20:23], v7 offset:28672
    v_mfma_f32_16x16x32_bf16 v[40:43], a[108:111], v[24:27], v[40:43]
    v_mfma_f32_16x16x32_bf16 v[48:51], v[172:175], v[24:27], v[48:51]
    s_waitcnt lgkmcnt(2)
    v_mfma_f32_16x16x32_bf16 v[36:39], a[44:47], v[28:31], v[36:39]
    ds_read_b128 v[24:27], v67 offset:12288
    v_mfma_f32_16x16x32_bf16 v[44:47], a[108:111], v[28:31], v[44:47]
    v_mfma_f32_16x16x32_bf16 v[52:55], v[172:175], v[28:31], v[52:55]
    s_waitcnt lgkmcnt(2)
    v_mfma_f32_16x16x32_bf16 v[32:35], a[48:51], v[16:19], v[32:35]
    ds_read_b128 v[28:31], v67 offset:28672
    v_mfma_f32_16x16x32_bf16 v[40:43], a[112:115], v[16:19], v[40:43]
    v_mfma_f32_16x16x32_bf16 v[48:51], v[176:179], v[16:19], v[48:51]
    s_waitcnt lgkmcnt(2)
    v_mfma_f32_16x16x32_bf16 v[36:39], a[48:51], v[20:23], v[36:39]
    ds_read_b128 v[16:19], v7 offset:14336
    v_mfma_f32_16x16x32_bf16 v[44:47], a[112:115], v[20:23], v[44:47]
    v_mfma_f32_16x16x32_bf16 v[52:55], v[176:179], v[20:23], v[52:55]
    s_waitcnt lgkmcnt(2)
    v_mfma_f32_16x16x32_bf16 v[32:35], a[52:55], v[24:27], v[32:35]
    ds_read_b128 v[20:23], v7 offset:30720
    v_mfma_f32_16x16x32_bf16 v[40:43], a[116:119], v[24:27], v[40:43]
    v_mfma_f32_16x16x32_bf16 v[48:51], v[180:183], v[24:27], v[48:51]
    s_waitcnt lgkmcnt(2)
    v_mfma_f32_16x16x32_bf16 v[36:39], a[52:55], v[28:31], v[36:39]
    ds_read_b128 v[24:27], v67 offset:14336
    v_mfma_f32_16x16x32_bf16 v[44:47], a[116:119], v[28:31], v[44:47]
    v_mfma_f32_16x16x32_bf16 v[52:55], v[180:183], v[28:31], v[52:55]
    s_waitcnt lgkmcnt(2)
    v_mfma_f32_16x16x32_bf16 v[32:35], a[56:59], v[16:19], v[32:35]
    ds_read_b128 v[28:31], v67 offset:30720
    v_mfma_f32_16x16x32_bf16 v[40:43], a[120:123], v[16:19], v[40:43]
    v_mfma_f32_16x16x32_bf16 v[48:51], v[184:187], v[16:19], v[48:51]
    s_waitcnt lgkmcnt(2)
    v_mfma_f32_16x16x32_bf16 v[36:39], a[56:59], v[20:23], v[36:39]
    ds_read_b128 v[16:19], v8 offset:0
    v_mfma_f32_16x16x32_bf16 v[44:47], a[120:123], v[20:23], v[44:47]
    v_mfma_f32_16x16x32_bf16 v[52:55], v[184:187], v[20:23], v[52:55]
    s_waitcnt lgkmcnt(2)
    v_mfma_f32_16x16x32_bf16 v[32:35], a[60:63], v[24:27], v[32:35]
    ds_read_b128 v[20:23], v8 offset:16384
    v_mfma_f32_16x16x32_bf16 v[40:43], a[124:127], v[24:27], v[40:43]
    v_mfma_f32_16x16x32_bf16 v[48:51], v[188:191], v[24:27], v[48:51]
    s_waitcnt lgkmcnt(2)
    v_mfma_f32_16x16x32_bf16 v[36:39], a[60:63], v[28:31], v[36:39]
    ds_read_b128 v[24:27], v76 offset:0
    v_mfma_f32_16x16x32_bf16 v[44:47], a[124:127], v[28:31], v[44:47]
    v_mfma_f32_16x16x32_bf16 v[52:55], v[188:191], v[28:31], v[52:55]
    s_waitcnt lgkmcnt(2)
    v_mfma_f32_16x16x32_bf16 v[56:59], v[112:115], v[16:19], 0
    ds_read_b128 v[28:31], v76 offset:16384
    s_waitcnt lgkmcnt(2)
    v_mfma_f32_16x16x32_bf16 v[60:63], v[112:115], v[20:23], 0
    ds_read_b128 v[16:19], v8 offset:2048
    s_waitcnt lgkmcnt(2)
    v_mfma_f32_16x16x32_bf16 v[56:59], v[116:119], v[24:27], v[56:59]
    ds_read_b128 v[20:23], v8 offset:18432
    s_waitcnt lgkmcnt(2)
    v_mfma_f32_16x16x32_bf16 v[60:63], v[116:119], v[28:31], v[60:63]
    ds_read_b128 v[24:27], v76 offset:2048
    s_waitcnt lgkmcnt(2)
    v_mfma_f32_16x16x32_bf16 v[56:59], v[120:123], v[16:19], v[56:59]
    ds_read_b128 v[28:31], v76 offset:18432
    s_waitcnt lgkmcnt(2)
    v_mfma_f32_16x16x32_bf16 v[60:63], v[120:123], v[20:23], v[60:63]
    s_waitcnt lgkmcnt(1)
    v_mfma_f32_16x16x32_bf16 v[56:59], v[124:127], v[24:27], v[56:59]
    s_waitcnt lgkmcnt(0)
    v_mfma_f32_16x16x32_bf16 v[60:63], v[124:127], v[28:31], v[60:63]
    v_mul_f32 v32, s100, v32
    v_mul_f32 v33, s100, v33
    v_mul_f32 v34, s100, v34
    v_mul_f32 v35, s100, v35
    v_mul_f32 v36, s100, v36
    v_mul_f32 v37, s100, v37
    v_mul_f32 v38, s100, v38
    v_mul_f32 v39, s100, v39
    v_mul_f32 v40, s100, v40
    v_mul_f32 v41, s100, v41
    v_mul_f32 v42, s100, v42
    v_mul_f32 v43, s100, v43
    v_mul_f32 v44, s100, v44
    v_mul_f32 v45, s100, v45
    v_mul_f32 v46, s100, v46
    v_mul_f32 v47, s100, v47
    v_cvt_pk_bf16_f32 v68, v32, v40
    v_cvt_pk_bf16_f32 v69, v33, v41
    v_cvt_pk_bf16_f32 v70, v34, v42
    v_cvt_pk_bf16_f32 v71, v35, v43
    ds_write_b128 v6, v[68:71] offset:0
    v_cvt_pk_bf16_f32 v72, v36, v44
    v_cvt_pk_bf16_f32 v73, v37, v45
    v_cvt_pk_bf16_f32 v74, v38, v46
    v_cvt_pk_bf16_f32 v75, v39, v47
    ds_write_b128 v6, v[72:75] offset:4096
    ds_write_b32 v4, v56 offset:0
    ds_write_b32 v4, v60 offset:256
    s_waitcnt lgkmcnt(0)
    s_barrier
    ds_read_b128 v[68:71], v5 offset:0
    ds_read_b128 v[72:75], v5 offset:256
    s_waitcnt lgkmcnt(0)
    s_mov_b32 s9, 0xbfb8aa3b
    v_add_f32 v68, v68, v69
    v_add_f32 v70, v70, v71
    v_add_f32 v68, v68, v70
    v_mul_f32 v68, s9, v68
    v_exp_f32 v68, v68
    s_nop 0
    v_add_f32 v68, 1.0, v68
    v_rcp_f32 v56, v68
    v_add_f32 v72, v72, v73
    v_add_f32 v74, v74, v75
    v_add_f32 v72, v72, v74
    v_mul_f32 v72, s9, v72
    v_exp_f32 v72, v72
    s_nop 0
    v_add_f32 v72, 1.0, v72
    v_rcp_f32 v57, v72
    s_and_b32 s7, s3, 1
    s_cmp_eq_u32 s7, 1
    s_cselect_b64 vcc, -1, 0
    v_cndmask_b32 v65, v56, v57, vcc
    v_sub_f32 v76, 1.0, v56
    v_mul_f32 v68, s9, v48
    v_mul_f32 v69, s9, v49
    v_mul_f32 v70, s9, v50
    v_mul_f32 v71, s9, v51
    v_exp_f32 v68, v68
    v_exp_f32 v69, v69
    v_exp_f32 v70, v70
    v_exp_f32 v71, v71
    v_add_f32 v68, 1.0, v68
    v_mul_f32 v48, v48, v76
    v_add_f32 v69, 1.0, v69
    v_mul_f32 v49, v49, v76
    v_add_f32 v70, 1.0, v70
    v_mul_f32 v50, v50, v76
    v_add_f32 v71, 1.0, v71
    v_mul_f32 v51, v51, v76
    v_rcp_f32 v68, v68
    v_rcp_f32 v69, v69
    v_rcp_f32 v70, v70
    v_rcp_f32 v71, v71
    v_mul_f32 v48, v48, v68
    v_mul_f32 v49, v49, v69
    v_mul_f32 v50, v50, v70
    v_mul_f32 v51, v51, v71
    v_cvt_pk_bf16_f32 v72, v48, v49
    v_cvt_pk_bf16_f32 v73, v50, v51
    ds_write_b64 v9, v[72:73] offset:0
    v_sub_f32 v76, 1.0, v57
    v_mul_f32 v68, s9, v52
    v_mul_f32 v69, s9, v53
    v_mul_f32 v70, s9, v54
    v_mul_f32 v71, s9, v55
    v_exp_f32 v68, v68
    v_exp_f32 v69, v69
    v_exp_f32 v70, v70
    v_exp_f32 v71, v71
    v_add_f32 v68, 1.0, v68
    v_mul_f32 v52, v52, v76
    v_add_f32 v69, 1.0, v69
    v_mul_f32 v53, v53, v76
    v_add_f32 v70, 1.0, v70
    v_mul_f32 v54, v54, v76
    v_add_f32 v71, 1.0, v71
    v_mul_f32 v55, v55, v76
    v_rcp_f32 v68, v68
    v_rcp_f32 v69, v69
    v_rcp_f32 v70, v70
    v_rcp_f32 v71, v71
    v_mul_f32 v52, v52, v68
    v_mul_f32 v53, v53, v69
    v_mul_f32 v54, v54, v70
    v_mul_f32 v55, v55, v71
    v_cvt_pk_bf16_f32 v72, v52, v53
    v_cvt_pk_bf16_f32 v73, v54, v55
    ds_write_b64 v9, v[72:73] offset:2048
    s_add_u32 s33, s33, 4
    s_mov_b32 s7, s23
    s_mov_b32 s23, s24
    s_mov_b32 s24, s7
    v_xor_b32 v6, 0x8000, v6
    v_xor_b32 v9, 0x8000, v9
    s_branch L_ja_36
    s_nop 0
L_noa_35:
    s_waitcnt vmcnt(0) lgkmcnt(0)
    s_barrier
    s_lshl_b32 s10, s14, 7
    s_lshl_b32 s7, s5, 2
    s_add_u32 s22, s10, s7
    s_add_u32 s10, s22, 48234496
    s_lshl_b32 s20, s14, 18
    s_lshl_b32 s7, s5, 13
    s_add_u32 s20, s20, s7
    buffer_load_dword v69, off, s[68:71], s10 sc1
    s_waitcnt vmcnt(0)
    v_readfirstlane_b32 s7, v69
    s_nop 0
    s_cmp_eq_u32 s7, 1
    s_cbranch_scc1 L_kvr_40
    s_mov_b32 s15, 1048576
    s_nop 0
L_poll_41:
    buffer_load_dword v69, off, s[68:71], s10 offset:0 sc1
    s_waitcnt vmcnt(0)
    v_readfirstlane_b32 s7, v69
    s_nop 0
    s_cmp_eq_u32 s7, 1
    s_cbranch_scc1 L_polld_42
    s_sub_u32 s15, s15, 1
    s_cmp_eq_u32 s15, 0
    s_cbranch_scc1 L_err_12
    s_sleep 2
    s_branch L_poll_41
L_polld_42:
L_kvr_40:
    s_add_u32 s8, s20, 4096
    buffer_load_dwordx4 v[80:83], v1, s[68:71], s20 offen offset:0 sc1
    buffer_load_dwordx4 v[84:87], v1, s[68:71], s20 offen offset:1024 sc1
    buffer_load_dwordx4 v[88:91], v1, s[68:71], s20 offen offset:2048 sc1
    buffer_load_dwordx4 v[92:95], v1, s[68:71], s20 offen offset:3072 sc1
    buffer_load_dwordx4 v[96:99], v1, s[68:71], s8 offen offset:0 sc1
    buffer_load_dwordx4 v[100:103], v1, s[68:71], s8 offen offset:1024 sc1
    buffer_load_dwordx4 v[104:107], v1, s[68:71], s8 offen offset:2048 sc1
    buffer_load_dwordx4 v[108:111], v1, s[68:71], s8 offen offset:3072 sc1
L_ja_36:
    s_lshr_b32 s7, s3, 1
    s_lshl_b32 s7, s7, 12
    s_add_u32 s8, s20, s7
    s_add_u32 s8, s8, 16777216
    buffer_load_dwordx4 v[16:19], v1, s[68:71], s8 offen offset:0 sc1
    buffer_load_dwordx4 v[20:23], v1, s[68:71], s8 offen offset:1024 sc1
    buffer_load_dwordx4 v[24:27], v1, s[68:71], s8 offen offset:2048 sc1
    buffer_load_dwordx4 v[28:31], v1, s[68:71], s8 offen offset:3072 sc1
    ds_read_b128 v[32:35], v10 offset:0
    ds_read_b128 v[36:39], v10 offset:1024
    ds_read_b128 v[40:43], v10 offset:2048
    ds_read_b128 v[44:47], v10 offset:3072
    v_add_u32 v67, 88064, v1
    ds_read_b128 v[60:63], v67 offset:1024
    s_waitcnt lgkmcnt(0)
    s_waitcnt vmcnt(4)
    v_mfma_f32_16x16x32_bf16 v[48:51], v[80:83], v[32:35], 0
    v_mfma_f32_16x16x32_bf16 v[48:51], v[84:87], v[36:39], v[48:51]
    v_mfma_f32_16x16x32_bf16 v[48:51], v[88:91], v[40:43], v[48:51]
    v_mfma_f32_16x16x32_bf16 v[48:51], v[92:95], v[44:47], v[48:51]
    v_mfma_f32_16x16x32_bf16 v[52:55], v[96:99], v[32:35], 0
    v_mfma_f32_16x16x32_bf16 v[52:55], v[100:103], v[36:39], v[52:55]
    v_mfma_f32_16x16x32_bf16 v[52:55], v[104:107], v[40:43], v[52:55]
    v_mfma_f32_16x16x32_bf16 v[52:55], v[108:111], v[44:47], v[52:55]
    v_mov_b32 v69, 0
    v_mov_b32 v70, 0
    v_exp_f32 v48, v48
    v_exp_f32 v49, v49
    v_exp_f32 v50, v50
    v_exp_f32 v51, v51
    v_exp_f32 v52, v52
    v_exp_f32 v53, v53
    v_exp_f32 v54, v54
    v_exp_f32 v55, v55
    v_cndmask_b32 v48, 0, v48, s[84:85]
    v_cndmask_b32 v49, 0, v49, s[86:87]
    v_cndmask_b32 v50, 0, v50, s[88:89]
    v_cndmask_b32 v51, 0, v51, s[90:91]
    v_cndmask_b32 v52, 0, v52, s[92:93]
    v_cndmask_b32 v53, 0, v53, s[94:95]
    v_cndmask_b32 v54, 0, v54, s[96:97]
    v_cndmask_b32 v55, 0, v55, s[98:99]
    s_waitcnt vmcnt(0)
    v_cvt_pk_bf16_f32 v72, v48, v49
    v_cvt_pk_bf16_f32 v73, v50, v51
    v_cvt_pk_bf16_f32 v74, v52, v53
    v_cvt_pk_bf16_f32 v75, v54, v55
    s_nop 1
    v_mfma_f32_16x16x32_bf16 v[56:59], v[60:63], v[72:75], 0
    v_mfma_f32_16x16x32_bf16 v[80:83], v[16:19], v[72:75], 0
    v_mfma_f32_16x16x32_bf16 v[84:87], v[20:23], v[72:75], 0
    v_mfma_f32_16x16x32_bf16 v[88:91], v[24:27], v[72:75], 0
    v_mfma_f32_16x16x32_bf16 v[92:95], v[28:31], v[72:75], 0
    s_cmp_eq_u32 s35, 0
    s_cbranch_scc1 L_first_43
    s_lshl_b32 s10, s4, 5
    s_mov_b32 s15, 1048576
    s_nop 3
L_poll_44:
    buffer_load_dword v52, off, s[72:75], s10 offset:24 sc1
    s_waitcnt vmcnt(0)
    v_readfirstlane_b32 s7, v52
    s_nop 0
    s_cmp_eq_u32 s7, 32
    s_cbranch_scc1 L_polld_45
    s_sub_u32 s15, s15, 1
    s_cmp_eq_u32 s15, 0
    s_cbranch_scc1 L_err_13
    s_sleep 2
    s_branch L_poll_44
L_polld_45:
    s_mov_b32 s35, 0
L_first_43:
    s_lshr_b32 s8, s20, 1
    s_add_u32 s9, s8, 33554432
    s_lshr_b32 s8, s20, 2
    s_lshr_b32 s11, s3, 1
    s_lshl_b32 s11, s11, 10
    s_add_u32 s8, s8, s11
    s_add_u32 s8, s8, 41943040
    s_add_u32 s10, s22, 48242688
    s_mov_b32 s15, 1048576
L_poll_46:
    buffer_load_dword v52, off, s[68:71], s10 offset:0 sc1
    s_waitcnt vmcnt(0)
    v_readfirstlane_b32 s7, v52
    s_nop 0
    s_cmp_eq_u32 s7, 1
    s_cbranch_scc1 L_polld_47
    s_sub_u32 s15, s15, 1
    s_cmp_eq_u32 s15, 0
    s_cbranch_scc1 L_err_4
    s_cmp_ge_u32 s14, 58
    s_cbranch_scc1 L_poll_46
    s_sleep 8
    s_branch L_poll_46
L_polld_47:
    buffer_load_dwordx4 v[96:99], v1, s[68:71], s9 offen offset:0 sc1
    buffer_load_dwordx4 v[100:103], v1, s[68:71], s9 offen offset:1024 sc1
    buffer_load_dwordx4 v[104:107], v1, s[68:71], s9 offen offset:2048 sc1
    buffer_load_dwordx4 v[108:111], v1, s[68:71], s9 offen offset:3072 sc1
    buffer_load_dwordx2 v[76:77], v15, s[68:71], s8 offen offset:0 sc1
    buffer_load_dwordx2 v[78:79], v15, s[68:71], s8 offen offset:512 sc1
    s_waitcnt vmcnt(5)
    v_mfma_f32_16x16x32_bf16 v[48:51], v[96:99], v[32:35], 0
    s_waitcnt vmcnt(4)
    v_mfma_f32_16x16x32_bf16 v[48:51], v[100:103], v[36:39], v[48:51]
    s_waitcnt vmcnt(3)
    v_mfma_f32_16x16x32_bf16 v[48:51], v[104:107], v[40:43], v[48:51]
    s_waitcnt vmcnt(2)
    v_mfma_f32_16x16x32_bf16 v[48:51], v[108:111], v[44:47], v[48:51]
    s_nop 7
    v_exp_f32 v48, v48
    v_exp_f32 v49, v49
    s_waitcnt vmcnt(0)
    v_cvt_pk_bf16_f32 v68, v48, v49
    v_cvt_pk_bf16_f32 v71, v48, v49
    s_nop 0
    v_mfma_f32_16x16x16_bf16 v[56:59], v[60:61], v[68:69], v[56:59]
    v_mfma_f32_16x16x16_bf16 v[80:83], v[76:77], v[68:69], v[80:83]
    v_mfma_f32_16x16x16_bf16 v[84:87], v[76:77], v[70:71], v[84:87]
    v_mfma_f32_16x16x16_bf16 v[88:91], v[78:79], v[68:69], v[88:91]
    v_mfma_f32_16x16x16_bf16 v[92:95], v[78:79], v[70:71], v[92:95]
    v_rcp_f32 v52, v56
    s_nop 0
    v_max_f32 v53, v56, v52
    v_cmp_ngt_f32 vcc, s34, v53
    s_cbranch_vccnz L_wslow_48
L_wback_49:
    v_mul_f32 v52, v52, v66
    v_pk_mul_f32 v[80:81], v[80:81], v[52:53] op_sel_hi:[1,0]
    v_pk_mul_f32 v[82:83], v[82:83], v[52:53] op_sel_hi:[1,0]
    v_pk_mul_f32 v[84:85], v[84:85], v[52:53] op_sel_hi:[1,0]
    v_pk_mul_f32 v[86:87], v[86:87], v[52:53] op_sel_hi:[1,0]
    v_pk_mul_f32 v[88:89], v[88:89], v[52:53] op_sel_hi:[1,0]
    v_pk_mul_f32 v[90:91], v[90:91], v[52:53] op_sel_hi:[1,0]
    v_pk_mul_f32 v[92:93], v[92:93], v[52:53] op_sel_hi:[1,0]
    v_pk_mul_f32 v[94:95], v[94:95], v[52:53] op_sel_hi:[1,0]
    v_cvt_pk_bf16_f32 v68, v80, v81
    v_cvt_pk_bf16_f32 v69, v82, v83
    v_cvt_pk_bf16_f32 v70, v84, v85
    v_cvt_pk_bf16_f32 v71, v86, v87
    ds_write_b128 v11, v[68:71] offset:0
    v_cvt_pk_bf16_f32 v72, v88, v89
    v_cvt_pk_bf16_f32 v73, v90, v91
    v_cvt_pk_bf16_f32 v74, v92, v93
    v_cvt_pk_bf16_f32 v75, v94, v95
    ds_write_b128 v11, v[72:75] offset:1024
    s_waitcnt lgkmcnt(0)
    s_barrier
    v_add_u32 v64, 73728, v1
    ds_read_b128 v[16:19], v64 offset:0
    ds_read_b128 v[20:23], v64 offset:1024
    ds_read_b128 v[24:27], v64 offset:2048
    ds_read_b128 v[28:31], v64 offset:3072
    ds_read_b128 v[32:35], v64 offset:4096
    ds_read_b128 v[36:39], v64 offset:5120
    ds_read_b128 v[40:43], v64 offset:6144
    ds_read_b128 v[44:47], v64 offset:7168
    v_add_u32 v64, s101, v64
    ds_read_b128 v[48:51], v64 offset:8192
    ds_read_b128 v[52:55], v64 offset:9216
    ds_read_b128 v[56:59], v64 offset:10240
    ds_read_b128 v[60:63], v64 offset:11264
    ds_read_b128 v[68:71], v67
    ds_read_b128 v[76:79], v67 offset:2048
    s_add_u32 s8, s21, 524288
    s_cmp_eq_u32 s6, 1
    s_cbranch_scc1 L_osafe_50
    s_waitcnt lgkmcnt(13)
    v_mfma_f32_16x16x32_bf16 v[80:83], a[128:131], v[16:19], 0
    s_waitcnt lgkmcnt(12)
    v_mfma_f32_16x16x32_bf16 v[80:83], a[132:135], v[20:23], v[80:83]
    s_waitcnt lgkmcnt(11)
    v_mfma_f32_16x16x32_bf16 v[80:83], a[136:139], v[24:27], v[80:83]
    s_waitcnt lgkmcnt(10)
    v_mfma_f32_16x16x32_bf16 v[80:83], a[140:143], v[28:31], v[80:83]
    s_waitcnt lgkmcnt(5)
    v_mfma_f32_16x16x32_bf16 v[80:83], v[192:195], v[48:51], v[80:83]
    s_waitcnt lgkmcnt(4)
    v_mfma_f32_16x16x32_bf16 v[80:83], v[196:199], v[52:55], v[80:83]
    v_mfma_f32_16x16x32_bf16 v[84:87], a[144:147], v[16:19], 0
    v_mfma_f32_16x16x32_bf16 v[84:87], a[148:151], v[20:23], v[84:87]
    v_mfma_f32_16x16x32_bf16 v[84:87], a[152:155], v[24:27], v[84:87]
    v_mfma_f32_16x16x32_bf16 v[84:87], a[156:159], v[28:31], v[84:87]
    v_mfma_f32_16x16x32_bf16 v[84:87], v[200:203], v[48:51], v[84:87]
    v_mfma_f32_16x16x32_bf16 v[84:87], v[204:207], v[52:55], v[84:87]
    v_mfma_f32_16x16x32_bf16 v[88:91], a[128:131], v[32:35], 0
    v_mfma_f32_16x16x32_bf16 v[88:91], a[132:135], v[36:39], v[88:91]
    v_cvt_pk_bf16_f32 v80, v80, v81
    v_mfma_f32_16x16x32_bf16 v[88:91], a[136:139], v[40:43], v[88:91]
    v_cvt_pk_bf16_f32 v81, v82, v83
    v_mfma_f32_16x16x32_bf16 v[88:91], a[140:143], v[44:47], v[88:91]
    v_cvt_pk_bf16_f32 v82, v84, v85
    s_waitcnt lgkmcnt(3)
    v_mfma_f32_16x16x32_bf16 v[88:91], v[192:195], v[56:59], v[88:91]
    s_waitcnt lgkmcnt(2)
    v_mfma_f32_16x16x32_bf16 v[88:91], v[196:199], v[60:63], v[88:91]
    v_mfma_f32_16x16x32_bf16 v[92:95], a[144:147], v[32:35], 0
    v_mfma_f32_16x16x32_bf16 v[92:95], a[148:151], v[36:39], v[92:95]
    v_cvt_pk_bf16_f32 v83, v86, v87
    v_mfma_f32_16x16x32_bf16 v[92:95], a[152:155], v[40:43], v[92:95]
    buffer_store_dwordx4 v[80:83], v12, s[68:71], s21 offen offset:0
    v_mfma_f32_16x16x32_bf16 v[92:95], a[156:159], v[44:47], v[92:95]
    v_mfma_f32_16x16x32_bf16 v[92:95], v[200:203], v[56:59], v[92:95]
    v_mfma_f32_16x16x32_bf16 v[92:95], v[204:207], v[60:63], v[92:95]
    v_mfma_f32_16x16x32_bf16 v[96:99], a[160:163], v[16:19], 0
    v_mfma_f32_16x16x32_bf16 v[96:99], a[164:167], v[20:23], v[96:99]
    v_cvt_pk_bf16_f32 v88, v88, v89
    v_mfma_f32_16x16x32_bf16 v[96:99], a[168:171], v[24:27], v[96:99]
    v_cvt_pk_bf16_f32 v89, v90, v91
    v_mfma_f32_16x16x32_bf16 v[96:99], a[172:175], v[28:31], v[96:99]
    v_cvt_pk_bf16_f32 v90, v92, v93
    v_mfma_f32_16x16x32_bf16 v[96:99], v[208:211], v[48:51], v[96:99]
    v_mfma_f32_16x16x32_bf16 v[96:99], v[212:215], v[52:55], v[96:99]
    v_mfma_f32_16x16x32_bf16 v[100:103], a[176:179], v[16:19], 0
    v_mfma_f32_16x16x32_bf16 v[100:103], a[180:183], v[20:23], v[100:103]
    v_cvt_pk_bf16_f32 v91, v94, v95
    v_mfma_f32_16x16x32_bf16 v[100:103], a[184:187], v[24:27], v[100:103]
    buffer_store_dwordx4 v[88:91], v12, s[68:71], s8 offen offset:0
    v_mfma_f32_16x16x32_bf16 v[100:103], a[188:191], v[28:31], v[100:103]
    v_mfma_f32_16x16x32_bf16 v[100:103], v[216:219], v[48:51], v[100:103]
    v_mfma_f32_16x16x32_bf16 v[100:103], v[220:223], v[52:55], v[100:103]
    v_mfma_f32_16x16x32_bf16 v[104:107], a[160:163], v[32:35], 0
    v_mfma_f32_16x16x32_bf16 v[104:107], a[164:167], v[36:39], v[104:107]
    v_cvt_pk_bf16_f32 v96, v96, v97
    v_mfma_f32_16x16x32_bf16 v[104:107], a[168:171], v[40:43], v[104:107]
    v_cvt_pk_bf16_f32 v97, v98, v99
    v_mfma_f32_16x16x32_bf16 v[104:107], a[172:175], v[44:47], v[104:107]
    v_cvt_pk_bf16_f32 v98, v100, v101
    v_mfma_f32_16x16x32_bf16 v[104:107], v[208:211], v[56:59], v[104:107]
    v_mfma_f32_16x16x32_bf16 v[104:107], v[212:215], v[60:63], v[104:107]
    v_mfma_f32_16x16x32_bf16 v[108:111], a[176:179], v[32:35], 0
    v_mfma_f32_16x16x32_bf16 v[108:111], a[180:183], v[36:39], v[108:111]
    v_cvt_pk_bf16_f32 v99, v102, v103
    v_mfma_f32_16x16x32_bf16 v[108:111], a[184:187], v[40:43], v[108:111]
    buffer_store_dwordx4 v[96:99], v12, s[68:71], s21 offen offset:64
    v_mfma_f32_16x16x32_bf16 v[108:111], a[188:191], v[44:47], v[108:111]
    v_mfma_f32_16x16x32_bf16 v[108:111], v[216:219], v[56:59], v[108:111]
    v_mfma_f32_16x16x32_bf16 v[108:111], v[220:223], v[60:63], v[108:111]
    v_mfma_f32_16x16x32_bf16 v[80:83], a[192:195], v[16:19], 0
    v_mfma_f32_16x16x32_bf16 v[80:83], a[196:199], v[20:23], v[80:83]
    v_cvt_pk_bf16_f32 v104, v104, v105
    v_mfma_f32_16x16x32_bf16 v[80:83], a[200:203], v[24:27], v[80:83]
    v_cvt_pk_bf16_f32 v105, v106, v107
    v_mfma_f32_16x16x32_bf16 v[80:83], a[204:207], v[28:31], v[80:83]
    v_cvt_pk_bf16_f32 v106, v108, v109
    v_mfma_f32_16x16x32_bf16 v[80:83], v[224:227], v[48:51], v[80:83]
    v_mfma_f32_16x16x32_bf16 v[80:83], v[228:231], v[52:55], v[80:83]
    v_mfma_f32_16x16x32_bf16 v[84:87], a[208:211], v[16:19], 0
    v_mfma_f32_16x16x32_bf16 v[84:87], a[212:215], v[20:23], v[84:87]
    v_cvt_pk_bf16_f32 v107, v110, v111
    v_mfma_f32_16x16x32_bf16 v[84:87], a[216:219], v[24:27], v[84:87]
    buffer_store_dwordx4 v[104:107], v12, s[68:71], s8 offen offset:64
    v_mfma_f32_16x16x32_bf16 v[84:87], a[220:223], v[28:31], v[84:87]
    v_mfma_f32_16x16x32_bf16 v[84:87], v[232:235], v[48:51], v[84:87]
    v_mfma_f32_16x16x32_bf16 v[84:87], v[236:239], v[52:55], v[84:87]
    v_mfma_f32_16x16x32_bf16 v[88:91], a[192:195], v[32:35], 0
    v_mfma_f32_16x16x32_bf16 v[88:91], a[196:199], v[36:39], v[88:91]
    v_cvt_pk_bf16_f32 v80, v80, v81
    v_mfma_f32_16x16x32_bf16 v[88:91], a[200:203], v[40:43], v[88:91]
    v_cvt_pk_bf16_f32 v81, v82, v83
    v_mfma_f32_16x16x32_bf16 v[88:91], a[204:207], v[44:47], v[88:91]
    v_cvt_pk_bf16_f32 v82, v84, v85
    v_mfma_f32_16x16x32_bf16 v[88:91], v[224:227], v[56:59], v[88:91]
    v_mfma_f32_16x16x32_bf16 v[88:91], v[228:231], v[60:63], v[88:91]
    v_mfma_f32_16x16x32_bf16 v[92:95], a[208:211], v[32:35], 0
    v_mfma_f32_16x16x32_bf16 v[92:95], a[212:215], v[36:39], v[92:95]
    v_cvt_pk_bf16_f32 v83, v86, v87
    v_mfma_f32_16x16x32_bf16 v[92:95], a[216:219], v[40:43], v[92:95]
    buffer_store_dwordx4 v[80:83], v12, s[68:71], s21 offen offset:128
    v_mfma_f32_16x16x32_bf16 v[92:95], a[220:223], v[44:47], v[92:95]
    v_mfma_f32_16x16x32_bf16 v[92:95], v[232:235], v[56:59], v[92:95]
    v_mfma_f32_16x16x32_bf16 v[92:95], v[236:239], v[60:63], v[92:95]
    v_mfma_f32_16x16x32_bf16 v[96:99], a[224:227], v[16:19], 0
    v_mfma_f32_16x16x32_bf16 v[96:99], a[228:231], v[20:23], v[96:99]
    v_cvt_pk_bf16_f32 v88, v88, v89
    v_mfma_f32_16x16x32_bf16 v[96:99], a[232:235], v[24:27], v[96:99]
    v_cvt_pk_bf16_f32 v89, v90, v91
    v_mfma_f32_16x16x32_bf16 v[96:99], a[236:239], v[28:31], v[96:99]
    v_cvt_pk_bf16_f32 v90, v92, v93
    v_mfma_f32_16x16x32_bf16 v[96:99], v[240:243], v[48:51], v[96:99]
    v_mfma_f32_16x16x32_bf16 v[96:99], v[244:247], v[52:55], v[96:99]
    v_mfma_f32_16x16x32_bf16 v[100:103], a[240:243], v[16:19], 0
    v_mfma_f32_16x16x32_bf16 v[100:103], a[244:247], v[20:23], v[100:103]
    v_cvt_pk_bf16_f32 v91, v94, v95
    v_mfma_f32_16x16x32_bf16 v[100:103], a[248:251], v[24:27], v[100:103]
    buffer_store_dwordx4 v[88:91], v12, s[68:71], s8 offen offset:128
    v_mfma_f32_16x16x32_bf16 v[100:103], a[252:255], v[28:31], v[100:103]
    v_mfma_f32_16x16x32_bf16 v[100:103], v[248:251], v[48:51], v[100:103]
    v_mfma_f32_16x16x32_bf16 v[100:103], v[252:255], v[52:55], v[100:103]
    v_mfma_f32_16x16x32_bf16 v[104:107], a[224:227], v[32:35], 0
    v_mfma_f32_16x16x32_bf16 v[104:107], a[228:231], v[36:39], v[104:107]
    v_cvt_pk_bf16_f32 v96, v96, v97
    v_mfma_f32_16x16x32_bf16 v[104:107], a[232:235], v[40:43], v[104:107]
    v_cvt_pk_bf16_f32 v97, v98, v99
    v_mfma_f32_16x16x32_bf16 v[104:107], a[236:239], v[44:47], v[104:107]
    v_cvt_pk_bf16_f32 v98, v100, v101
    v_mfma_f32_16x16x32_bf16 v[104:107], v[240:243], v[56:59], v[104:107]
    v_mfma_f32_16x16x32_bf16 v[104:107], v[244:247], v[60:63], v[104:107]
    v_mfma_f32_16x16x32_bf16 v[108:111], a[240:243], v[32:35], 0
    v_mfma_f32_16x16x32_bf16 v[108:111], a[244:247], v[36:39], v[108:111]
    v_cvt_pk_bf16_f32 v99, v102, v103
    v_mfma_f32_16x16x32_bf16 v[108:111], a[248:251], v[40:43], v[108:111]
    buffer_store_dwordx4 v[96:99], v12, s[68:71], s21 offen offset:192
    v_mfma_f32_16x16x32_bf16 v[108:111], a[252:255], v[44:47], v[108:111]
    v_mfma_f32_16x16x32_bf16 v[108:111], v[248:251], v[56:59], v[108:111]
    v_mfma_f32_16x16x32_bf16 v[108:111], v[252:255], v[60:63], v[108:111]
    v_cvt_pk_bf16_f32 v104, v104, v105
    v_cvt_pk_bf16_f32 v105, v106, v107
    s_nop 4
    v_cvt_pk_bf16_f32 v106, v108, v109
    v_cvt_pk_bf16_f32 v107, v110, v111
    buffer_store_dwordx4 v[104:107], v12, s[68:71], s8 offen offset:192
    s_mov_b32 s15, 1048576
    s_add_u32 s8, s21, 4096
    s_waitcnt lgkmcnt(0)
    s_nop 7
    s_nop 7
    s_nop 7
    s_nop 7
L_rp_52:
    buffer_load_dwordx4 v[16:19], v13, s[68:71], s21 offen offset:0 sc1
    buffer_load_dwordx4 v[20:23], v13, s[68:71], s21 offen offset:1024 sc1
    buffer_load_dwordx4 v[24:27], v13, s[68:71], s21 offen offset:2048 sc1
    buffer_load_dwordx4 v[28:31], v13, s[68:71], s21 offen offset:3072 sc1
    buffer_load_dwordx4 v[32:35], v13, s[68:71], s8 offen offset:0 sc1
    buffer_load_dwordx4 v[36:39], v13, s[68:71], s8 offen offset:1024 sc1
    buffer_load_dwordx4 v[40:43], v13, s[68:71], s8 offen offset:2048 sc1
    buffer_load_dwordx4 v[44:47], v13, s[68:71], s8 offen offset:3072 sc1
    s_waitcnt vmcnt(7)
    v_mfma_f32_16x16x32_bf16 v[72:75], v[68:71], v[16:19], 0
    s_waitcnt vmcnt(6)
    v_mfma_f32_16x16x32_bf16 v[72:75], v[68:71], v[20:23], v[72:75]
    s_waitcnt vmcnt(5)
    v_mfma_f32_16x16x32_bf16 v[72:75], v[68:71], v[24:27], v[72:75]
    s_waitcnt vmcnt(4)
    v_mfma_f32_16x16x32_bf16 v[72:75], v[68:71], v[28:31], v[72:75]
    s_waitcnt vmcnt(3)
    v_mfma_f32_16x16x32_bf16 v[72:75], v[68:71], v[32:35], v[72:75]
    s_waitcnt vmcnt(2)
    v_mfma_f32_16x16x32_bf16 v[72:75], v[68:71], v[36:39], v[72:75]
    s_waitcnt vmcnt(1)
    v_mfma_f32_16x16x32_bf16 v[72:75], v[68:71], v[40:43], v[72:75]
    s_waitcnt vmcnt(0)
    v_mfma_f32_16x16x32_bf16 v[72:75], v[68:71], v[44:47], v[72:75]
    s_nop 7
    v_cmp_u_f32 vcc, v72, v73
    v_cvt_pk_bf16_f32 v48, v72, v73
    v_cvt_pk_bf16_f32 v49, v74, v75
    s_cbranch_vccnz L_rr_54
L_rd_53:
    s_lshl_b32 s9, s14, 15
    s_mov_b64 exec, 0xffffffff
    buffer_store_dwordx2 v[48:49], v14, s[64:67], s9 offen
    s_mov_b64 exec, -1
    buffer_store_dwordx4 v[76:79], v13, s[68:71], s21 offen offset:0
    buffer_store_dwordx4 v[76:79], v13, s[68:71], s21 offen offset:1024
    buffer_store_dwordx4 v[76:79], v13, s[68:71], s21 offen offset:2048
    buffer_store_dwordx4 v[76:79], v13, s[68:71], s21 offen offset:3072
    buffer_store_dwordx4 v[76:79], v13, s[68:71], s8 offen offset:0
    buffer_store_dwordx4 v[76:79], v13, s[68:71], s8 offen offset:1024
    buffer_store_dwordx4 v[76:79], v13, s[68:71], s8 offen offset:2048
    buffer_store_dwordx4 v[76:79], v13, s[68:71], s8 offen offset:3072
    s_branch L_onext_51
    s_nop 0
L_rr_54:
    s_sub_u32 s15, s15, 1
    s_cmp_eq_u32 s15, 0
    s_cbranch_scc1 L_err_5
    s_and_b32 s7, s15, 7
    s_cmp_lg_u32 s7, 0
    s_cbranch_scc1 L_rp_52
    s_mov_b64 s[12:13], 0
    v_cmp_eq_u32 vcc, v76, v16
    s_nop 0
    s_or_b64 s[12:13], s[12:13], vcc
    v_cmp_eq_u32 vcc, v76, v17
    s_nop 0
    s_or_b64 s[12:13], s[12:13], vcc
    v_cmp_eq_u32 vcc, v76, v18
    s_nop 0
    s_or_b64 s[12:13], s[12:13], vcc
    v_cmp_eq_u32 vcc, v76, v19
    s_nop 0
    s_or_b64 s[12:13], s[12:13], vcc
    v_cmp_eq_u32 vcc, v76, v20
    s_nop 0
    s_or_b64 s[12:13], s[12:13], vcc
    v_cmp_eq_u32 vcc, v76, v21
    s_nop 0
    s_or_b64 s[12:13], s[12:13], vcc
    v_cmp_eq_u32 vcc, v76, v22
    s_nop 0
    s_or_b64 s[12:13], s[12:13], vcc
    v_cmp_eq_u32 vcc, v76, v23
    s_nop 0
    s_or_b64 s[12:13], s[12:13], vcc
    v_cmp_eq_u32 vcc, v76, v24
    s_nop 0
    s_or_b64 s[12:13], s[12:13], vcc
    v_cmp_eq_u32 vcc, v76, v25
    s_nop 0
    s_or_b64 s[12:13], s[12:13], vcc
    v_cmp_eq_u32 vcc, v76, v26
    s_nop 0
    s_or_b64 s[12:13], s[12:13], vcc
    v_cmp_eq_u32 vcc, v76, v27
    s_nop 0
    s_or_b64 s[12:13], s[12:13], vcc
    v_cmp_eq_u32 vcc, v76, v28
    s_nop 0
    s_or_b64 s[12:13], s[12:13], vcc
    v_cmp_eq_u32 vcc, v76, v29
    s_nop 0
    s_or_b64 s[12:13], s[12:13], vcc
    v_cmp_eq_u32 vcc, v76, v30
    s_nop 0
    s_or_b64 s[12:13], s[12:13], vcc
    v_cmp_eq_u32 vcc, v76, v31
    s_nop 0
    s_or_b64 s[12:13], s[12:13], vcc
    v_cmp_eq_u32 vcc, v76, v32
    s_nop 0
    s_or_b64 s[12:13], s[12:13], vcc
    v_cmp_eq_u32 vcc, v76, v33
    s_nop 0
    s_or_b64 s[12:13], s[12:13], vcc
    v_cmp_eq_u32 vcc, v76, v34
    s_nop 0
    s_or_b64 s[12:13], s[12:13], vcc
    v_cmp_eq_u32 vcc, v76, v35
    s_nop 0
    s_or_b64 s[12:13], s[12:13], vcc
    v_cmp_eq_u32 vcc, v76, v36
    s_nop 0
    s_or_b64 s[12:13], s[12:13], vcc
    v_cmp_eq_u32 vcc, v76, v37
    s_nop 0
    s_or_b64 s[12:13], s[12:13], vcc
    v_cmp_eq_u32 vcc, v76, v38
    s_nop 0
    s_or_b64 s[12:13], s[12:13], vcc
    v_cmp_eq_u32 vcc, v76, v39
    s_nop 0
    s_or_b64 s[12:13], s[12:13], vcc
    v_cmp_eq_u32 vcc, v76, v40
    s_nop 0
    s_or_b64 s[12:13], s[12:13], vcc
    v_cmp_eq_u32 vcc, v76, v41
    s_nop 0
    s_or_b64 s[12:13], s[12:13], vcc
    v_cmp_eq_u32 vcc, v76, v42
    s_nop 0
    s_or_b64 s[12:13], s[12:13], vcc
    v_cmp_eq_u32 vcc, v76, v43
    s_nop 0
    s_or_b64 s[12:13], s[12:13], vcc
    v_cmp_eq_u32 vcc, v76, v44
    s_nop 0
    s_or_b64 s[12:13], s[12:13], vcc
    v_cmp_eq_u32 vcc, v76, v45
    s_nop 0
    s_or_b64 s[12:13], s[12:13], vcc
    v_cmp_eq_u32 vcc, v76, v46
    s_nop 0
    s_or_b64 s[12:13], s[12:13], vcc
    v_cmp_eq_u32 vcc, v76, v47
    s_nop 0
    s_or_b64 s[12:13], s[12:13], vcc
    s_cmp_eq_u64 s[12:13], 0
    s_cbranch_scc1 L_rd_53
    s_branch L_rp_52
L_osafe_50:
    s_waitcnt lgkmcnt(13)
    v_mfma_f32_16x16x32_bf16 v[80:83], a[128:131], v[16:19], 0
    s_waitcnt lgkmcnt(12)
    v_mfma_f32_16x16x32_bf16 v[80:83], a[132:135], v[20:23], v[80:83]
    s_waitcnt lgkmcnt(11)
    v_mfma_f32_16x16x32_bf16 v[80:83], a[136:139], v[24:27], v[80:83]
    s_waitcnt lgkmcnt(10)
    v_mfma_f32_16x16x32_bf16 v[80:83], a[140:143], v[28:31], v[80:83]
    s_waitcnt lgkmcnt(5)
    v_mfma_f32_16x16x32_bf16 v[80:83], v[192:195], v[48:51], v[80:83]
    s_waitcnt lgkmcnt(4)
    v_mfma_f32_16x16x32_bf16 v[80:83], v[196:199], v[52:55], v[80:83]
    v_mfma_f32_16x16x32_bf16 v[84:87], a[144:147], v[16:19], 0
    v_mfma_f32_16x16x32_bf16 v[84:87], a[148:151], v[20:23], v[84:87]
    v_mfma_f32_16x16x32_bf16 v[84:87], a[152:155], v[24:27], v[84:87]
    v_mfma_f32_16x16x32_bf16 v[84:87], a[156:159], v[28:31], v[84:87]
    v_mfma_f32_16x16x32_bf16 v[84:87], v[200:203], v[48:51], v[84:87]
    v_mfma_f32_16x16x32_bf16 v[84:87], v[204:207], v[52:55], v[84:87]
    v_mfma_f32_16x16x32_bf16 v[88:91], a[128:131], v[32:35], 0
    v_mfma_f32_16x16x32_bf16 v[88:91], a[132:135], v[36:39], v[88:91]
    v_cvt_pk_bf16_f32 v80, v80, v81
    v_mfma_f32_16x16x32_bf16 v[88:91], a[136:139], v[40:43], v[88:91]
    v_cvt_pk_bf16_f32 v81, v82, v83
    v_mfma_f32_16x16x32_bf16 v[88:91], a[140:143], v[44:47], v[88:91]
    v_cvt_pk_bf16_f32 v82, v84, v85
    s_waitcnt lgkmcnt(3)
    v_mfma_f32_16x16x32_bf16 v[88:91], v[192:195], v[56:59], v[88:91]
    s_waitcnt lgkmcnt(2)
    v_mfma_f32_16x16x32_bf16 v[88:91], v[196:199], v[60:63], v[88:91]
    v_mfma_f32_16x16x32_bf16 v[92:95], a[144:147], v[32:35], 0
    v_mfma_f32_16x16x32_bf16 v[92:95], a[148:151], v[36:39], v[92:95]
    v_cvt_pk_bf16_f32 v83, v86, v87
    v_mfma_f32_16x16x32_bf16 v[92:95], a[152:155], v[40:43], v[92:95]
    buffer_store_dwordx4 v[80:83], v12, s[68:71], s21 offen offset:0 sc1
    v_mfma_f32_16x16x32_bf16 v[92:95], a[156:159], v[44:47], v[92:95]
    v_mfma_f32_16x16x32_bf16 v[92:95], v[200:203], v[56:59], v[92:95]
    v_mfma_f32_16x16x32_bf16 v[92:95], v[204:207], v[60:63], v[92:95]
    v_mfma_f32_16x16x32_bf16 v[96:99], a[160:163], v[16:19], 0
    v_mfma_f32_16x16x32_bf16 v[96:99], a[164:167], v[20:23], v[96:99]
    v_cvt_pk_bf16_f32 v88, v88, v89
    v_mfma_f32_16x16x32_bf16 v[96:99], a[168:171], v[24:27], v[96:99]
    v_cvt_pk_bf16_f32 v89, v90, v91
    v_mfma_f32_16x16x32_bf16 v[96:99], a[172:175], v[28:31], v[96:99]
    v_cvt_pk_bf16_f32 v90, v92, v93
    v_mfma_f32_16x16x32_bf16 v[96:99], v[208:211], v[48:51], v[96:99]
    v_mfma_f32_16x16x32_bf16 v[96:99], v[212:215], v[52:55], v[96:99]
    v_mfma_f32_16x16x32_bf16 v[100:103], a[176:179], v[16:19], 0
    v_mfma_f32_16x16x32_bf16 v[100:103], a[180:183], v[20:23], v[100:103]
    v_cvt_pk_bf16_f32 v91, v94, v95
    v_mfma_f32_16x16x32_bf16 v[100:103], a[184:187], v[24:27], v[100:103]
    buffer_store_dwordx4 v[88:91], v12, s[68:71], s8 offen offset:0 sc1
    v_mfma_f32_16x16x32_bf16 v[100:103], a[188:191], v[28:31], v[100:103]
    v_mfma_f32_16x16x32_bf16 v[100:103], v[216:219], v[48:51], v[100:103]
    v_mfma_f32_16x16x32_bf16 v[100:103], v[220:223], v[52:55], v[100:103]
    v_mfma_f32_16x16x32_bf16 v[104:107], a[160:163], v[32:35], 0
    v_mfma_f32_16x16x32_bf16 v[104:107], a[164:167], v[36:39], v[104:107]
    v_cvt_pk_bf16_f32 v96, v96, v97
    v_mfma_f32_16x16x32_bf16 v[104:107], a[168:171], v[40:43], v[104:107]
    v_cvt_pk_bf16_f32 v97, v98, v99
    v_mfma_f32_16x16x32_bf16 v[104:107], a[172:175], v[44:47], v[104:107]
    v_cvt_pk_bf16_f32 v98, v100, v101
    v_mfma_f32_16x16x32_bf16 v[104:107], v[208:211], v[56:59], v[104:107]
    v_mfma_f32_16x16x32_bf16 v[104:107], v[212:215], v[60:63], v[104:107]
    v_mfma_f32_16x16x32_bf16 v[108:111], a[176:179], v[32:35], 0
    v_mfma_f32_16x16x32_bf16 v[108:111], a[180:183], v[36:39], v[108:111]
    v_cvt_pk_bf16_f32 v99, v102, v103
    v_mfma_f32_16x16x32_bf16 v[108:111], a[184:187], v[40:43], v[108:111]
    buffer_store_dwordx4 v[96:99], v12, s[68:71], s21 offen offset:64 sc1
    v_mfma_f32_16x16x32_bf16 v[108:111], a[188:191], v[44:47], v[108:111]
    v_mfma_f32_16x16x32_bf16 v[108:111], v[216:219], v[56:59], v[108:111]
    v_mfma_f32_16x16x32_bf16 v[108:111], v[220:223], v[60:63], v[108:111]
    v_mfma_f32_16x16x32_bf16 v[80:83], a[192:195], v[16:19], 0
    v_mfma_f32_16x16x32_bf16 v[80:83], a[196:199], v[20:23], v[80:83]
    v_cvt_pk_bf16_f32 v104, v104, v105
    v_mfma_f32_16x16x32_bf16 v[80:83], a[200:203], v[24:27], v[80:83]
    v_cvt_pk_bf16_f32 v105, v106, v107
    v_mfma_f32_16x16x32_bf16 v[80:83], a[204:207], v[28:31], v[80:83]
    v_cvt_pk_bf16_f32 v106, v108, v109
    v_mfma_f32_16x16x32_bf16 v[80:83], v[224:227], v[48:51], v[80:83]
    v_mfma_f32_16x16x32_bf16 v[80:83], v[228:231], v[52:55], v[80:83]
    v_mfma_f32_16x16x32_bf16 v[84:87], a[208:211], v[16:19], 0
    v_mfma_f32_16x16x32_bf16 v[84:87], a[212:215], v[20:23], v[84:87]
    v_cvt_pk_bf16_f32 v107, v110, v111
    v_mfma_f32_16x16x32_bf16 v[84:87], a[216:219], v[24:27], v[84:87]
    buffer_store_dwordx4 v[104:107], v12, s[68:71], s8 offen offset:64 sc1
    v_mfma_f32_16x16x32_bf16 v[84:87], a[220:223], v[28:31], v[84:87]
    v_mfma_f32_16x16x32_bf16 v[84:87], v[232:235], v[48:51], v[84:87]
    v_mfma_f32_16x16x32_bf16 v[84:87], v[236:239], v[52:55], v[84:87]
    v_mfma_f32_16x16x32_bf16 v[88:91], a[192:195], v[32:35], 0
    v_mfma_f32_16x16x32_bf16 v[88:91], a[196:199], v[36:39], v[88:91]
    v_cvt_pk_bf16_f32 v80, v80, v81
    v_mfma_f32_16x16x32_bf16 v[88:91], a[200:203], v[40:43], v[88:91]
    v_cvt_pk_bf16_f32 v81, v82, v83
    v_mfma_f32_16x16x32_bf16 v[88:91], a[204:207], v[44:47], v[88:91]
    v_cvt_pk_bf16_f32 v82, v84, v85
    v_mfma_f32_16x16x32_bf16 v[88:91], v[224:227], v[56:59], v[88:91]
    v_mfma_f32_16x16x32_bf16 v[88:91], v[228:231], v[60:63], v[88:91]
    v_mfma_f32_16x16x32_bf16 v[92:95], a[208:211], v[32:35], 0
    v_mfma_f32_16x16x32_bf16 v[92:95], a[212:215], v[36:39], v[92:95]
    v_cvt_pk_bf16_f32 v83, v86, v87
    v_mfma_f32_16x16x32_bf16 v[92:95], a[216:219], v[40:43], v[92:95]
    buffer_store_dwordx4 v[80:83], v12, s[68:71], s21 offen offset:128 sc1
    v_mfma_f32_16x16x32_bf16 v[92:95], a[220:223], v[44:47], v[92:95]
    v_mfma_f32_16x16x32_bf16 v[92:95], v[232:235], v[56:59], v[92:95]
    v_mfma_f32_16x16x32_bf16 v[92:95], v[236:239], v[60:63], v[92:95]
    v_mfma_f32_16x16x32_bf16 v[96:99], a[224:227], v[16:19], 0
    v_mfma_f32_16x16x32_bf16 v[96:99], a[228:231], v[20:23], v[96:99]
    v_cvt_pk_bf16_f32 v88, v88, v89
    v_mfma_f32_16x16x32_bf16 v[96:99], a[232:235], v[24:27], v[96:99]
    v_cvt_pk_bf16_f32 v89, v90, v91
    v_mfma_f32_16x16x32_bf16 v[96:99], a[236:239], v[28:31], v[96:99]
    v_cvt_pk_bf16_f32 v90, v92, v93
    v_mfma_f32_16x16x32_bf16 v[96:99], v[240:243], v[48:51], v[96:99]
    v_mfma_f32_16x16x32_bf16 v[96:99], v[244:247], v[52:55], v[96:99]
    v_mfma_f32_16x16x32_bf16 v[100:103], a[240:243], v[16:19], 0
    v_mfma_f32_16x16x32_bf16 v[100:103], a[244:247], v[20:23], v[100:103]
    v_cvt_pk_bf16_f32 v91, v94, v95
    v_mfma_f32_16x16x32_bf16 v[100:103], a[248:251], v[24:27], v[100:103]
    buffer_store_dwordx4 v[88:91], v12, s[68:71], s8 offen offset:128 sc1
    v_mfma_f32_16x16x32_bf16 v[100:103], a[252:255], v[28:31], v[100:103]
    v_mfma_f32_16x16x32_bf16 v[100:103], v[248:251], v[48:51], v[100:103]
    v_mfma_f32_16x16x32_bf16 v[100:103], v[252:255], v[52:55], v[100:103]
    v_mfma_f32_16x16x32_bf16 v[104:107], a[224:227], v[32:35], 0
    v_mfma_f32_16x16x32_bf16 v[104:107], a[228:231], v[36:39], v[104:107]
    v_cvt_pk_bf16_f32 v96, v96, v97
    v_mfma_f32_16x16x32_bf16 v[104:107], a[232:235], v[40:43], v[104:107]
    v_cvt_pk_bf16_f32 v97, v98, v99
    v_mfma_f32_16x16x32_bf16 v[104:107], a[236:239], v[44:47], v[104:107]
    v_cvt_pk_bf16_f32 v98, v100, v101
    v_mfma_f32_16x16x32_bf16 v[104:107], v[240:243], v[56:59], v[104:107]
    v_mfma_f32_16x16x32_bf16 v[104:107], v[244:247], v[60:63], v[104:107]
    v_mfma_f32_16x16x32_bf16 v[108:111], a[240:243], v[32:35], 0
    v_mfma_f32_16x16x32_bf16 v[108:111], a[244:247], v[36:39], v[108:111]
    v_cvt_pk_bf16_f32 v99, v102, v103
    v_mfma_f32_16x16x32_bf16 v[108:111], a[248:251], v[40:43], v[108:111]
    buffer_store_dwordx4 v[96:99], v12, s[68:71], s21 offen offset:192 sc1
    v_mfma_f32_16x16x32_bf16 v[108:111], a[252:255], v[44:47], v[108:111]
    v_mfma_f32_16x16x32_bf16 v[108:111], v[248:251], v[56:59], v[108:111]
    v_mfma_f32_16x16x32_bf16 v[108:111], v[252:255], v[60:63], v[108:111]
    v_cvt_pk_bf16_f32 v104, v104, v105
    v_cvt_pk_bf16_f32 v105, v106, v107
    s_nop 4
    v_cvt_pk_bf16_f32 v106, v108, v109
    v_cvt_pk_bf16_f32 v107, v110, v111
    buffer_store_dwordx4 v[104:107], v12, s[68:71], s8 offen offset:192 sc1
    s_mov_b32 s15, 1048576
    s_add_u32 s8, s21, 4096
    s_waitcnt lgkmcnt(0)
    s_nop 7
    s_nop 7
    s_nop 7
    s_nop 7
L_rp_55:
    buffer_load_dwordx4 v[16:19], v13, s[68:71], s21 offen offset:0 sc1
    buffer_load_dwordx4 v[20:23], v13, s[68:71], s21 offen offset:1024 sc1
    buffer_load_dwordx4 v[24:27], v13, s[68:71], s21 offen offset:2048 sc1
    buffer_load_dwordx4 v[28:31], v13, s[68:71], s21 offen offset:3072 sc1
    buffer_load_dwordx4 v[32:35], v13, s[68:71], s8 offen offset:0 sc1
    buffer_load_dwordx4 v[36:39], v13, s[68:71], s8 offen offset:1024 sc1
    buffer_load_dwordx4 v[40:43], v13, s[68:71], s8 offen offset:2048 sc1
    buffer_load_dwordx4 v[44:47], v13, s[68:71], s8 offen offset:3072 sc1
    s_waitcnt vmcnt(7)
    v_mfma_f32_16x16x32_bf16 v[72:75], v[68:71], v[16:19], 0
    s_waitcnt vmcnt(6)
    v_mfma_f32_16x16x32_bf16 v[72:75], v[68:71], v[20:23], v[72:75]
    s_waitcnt vmcnt(5)
    v_mfma_f32_16x16x32_bf16 v[72:75], v[68:71], v[24:27], v[72:75]
    s_waitcnt vmcnt(4)
    v_mfma_f32_16x16x32_bf16 v[72:75], v[68:71], v[28:31], v[72:75]
    s_waitcnt vmcnt(3)
    v_mfma_f32_16x16x32_bf16 v[72:75], v[68:71], v[32:35], v[72:75]
    s_waitcnt vmcnt(2)
    v_mfma_f32_16x16x32_bf16 v[72:75], v[68:71], v[36:39], v[72:75]
    s_waitcnt vmcnt(1)
    v_mfma_f32_16x16x32_bf16 v[72:75], v[68:71], v[40:43], v[72:75]
    s_waitcnt vmcnt(0)
    v_mfma_f32_16x16x32_bf16 v[72:75], v[68:71], v[44:47], v[72:75]
    s_nop 7
    v_cmp_u_f32 vcc, v72, v73
    v_cvt_pk_bf16_f32 v48, v72, v73
    v_cvt_pk_bf16_f32 v49, v74, v75
    s_cbranch_vccnz L_rr_57
L_rd_56:
    s_lshl_b32 s9, s14, 15
    s_mov_b64 exec, 0xffffffff
    buffer_store_dwordx2 v[48:49], v14, s[64:67], s9 offen
    s_mov_b64 exec, -1
    buffer_store_dwordx4 v[76:79], v13, s[68:71], s21 offen offset:0 sc1
    buffer_store_dwordx4 v[76:79], v13, s[68:71], s21 offen offset:1024 sc1
    buffer_store_dwordx4 v[76:79], v13, s[68:71], s21 offen offset:2048 sc1
    buffer_store_dwordx4 v[76:79], v13, s[68:71], s21 offen offset:3072 sc1
    buffer_store_dwordx4 v[76:79], v13, s[68:71], s8 offen offset:0 sc1
    buffer_store_dwordx4 v[76:79], v13, s[68:71], s8 offen offset:1024 sc1
    buffer_store_dwordx4 v[76:79], v13, s[68:71], s8 offen offset:2048 sc1
    buffer_store_dwordx4 v[76:79], v13, s[68:71], s8 offen offset:3072 sc1
    s_branch L_onext_51
    s_nop 0
L_rr_57:
    s_sub_u32 s15, s15, 1
    s_cmp_eq_u32 s15, 0
    s_cbranch_scc1 L_err_5
    s_and_b32 s7, s15, 7
    s_cmp_lg_u32 s7, 0
    s_cbranch_scc1 L_rp_55
    s_mov_b64 s[12:13], 0
    v_cmp_eq_u32 vcc, v76, v16
    s_nop 0
    s_or_b64 s[12:13], s[12:13], vcc
    v_cmp_eq_u32 vcc, v76, v17
    s_nop 0
    s_or_b64 s[12:13], s[12:13], vcc
    v_cmp_eq_u32 vcc, v76, v18
    s_nop 0
    s_or_b64 s[12:13], s[12:13], vcc
    v_cmp_eq_u32 vcc, v76, v19
    s_nop 0
    s_or_b64 s[12:13], s[12:13], vcc
    v_cmp_eq_u32 vcc, v76, v20
    s_nop 0
    s_or_b64 s[12:13], s[12:13], vcc
    v_cmp_eq_u32 vcc, v76, v21
    s_nop 0
    s_or_b64 s[12:13], s[12:13], vcc
    v_cmp_eq_u32 vcc, v76, v22
    s_nop 0
    s_or_b64 s[12:13], s[12:13], vcc
    v_cmp_eq_u32 vcc, v76, v23
    s_nop 0
    s_or_b64 s[12:13], s[12:13], vcc
    v_cmp_eq_u32 vcc, v76, v24
    s_nop 0
    s_or_b64 s[12:13], s[12:13], vcc
    v_cmp_eq_u32 vcc, v76, v25
    s_nop 0
    s_or_b64 s[12:13], s[12:13], vcc
    v_cmp_eq_u32 vcc, v76, v26
    s_nop 0
    s_or_b64 s[12:13], s[12:13], vcc
    v_cmp_eq_u32 vcc, v76, v27
    s_nop 0
    s_or_b64 s[12:13], s[12:13], vcc
    v_cmp_eq_u32 vcc, v76, v28
    s_nop 0
    s_or_b64 s[12:13], s[12:13], vcc
    v_cmp_eq_u32 vcc, v76, v29
    s_nop 0
    s_or_b64 s[12:13], s[12:13], vcc
    v_cmp_eq_u32 vcc, v76, v30
    s_nop 0
    s_or_b64 s[12:13], s[12:13], vcc
    v_cmp_eq_u32 vcc, v76, v31
    s_nop 0
    s_or_b64 s[12:13], s[12:13], vcc
    v_cmp_eq_u32 vcc, v76, v32
    s_nop 0
    s_or_b64 s[12:13], s[12:13], vcc
    v_cmp_eq_u32 vcc, v76, v33
    s_nop 0
    s_or_b64 s[12:13], s[12:13], vcc
    v_cmp_eq_u32 vcc, v76, v34
    s_nop 0
    s_or_b64 s[12:13], s[12:13], vcc
    v_cmp_eq_u32 vcc, v76, v35
    s_nop 0
    s_or_b64 s[12:13], s[12:13], vcc
    v_cmp_eq_u32 vcc, v76, v36
    s_nop 0
    s_or_b64 s[12:13], s[12:13], vcc
    v_cmp_eq_u32 vcc, v76, v37
    s_nop 0
    s_or_b64 s[12:13], s[12:13], vcc
    v_cmp_eq_u32 vcc, v76, v38
    s_nop 0
    s_or_b64 s[12:13], s[12:13], vcc
    v_cmp_eq_u32 vcc, v76, v39
    s_nop 0
    s_or_b64 s[12:13], s[12:13], vcc
    v_cmp_eq_u32 vcc, v76, v40
    s_nop 0
    s_or_b64 s[12:13], s[12:13], vcc
    v_cmp_eq_u32 vcc, v76, v41
    s_nop 0
    s_or_b64 s[12:13], s[12:13], vcc
    v_cmp_eq_u32 vcc, v76, v42
    s_nop 0
    s_or_b64 s[12:13], s[12:13], vcc
    v_cmp_eq_u32 vcc, v76, v43
    s_nop 0
    s_or_b64 s[12:13], s[12:13], vcc
    v_cmp_eq_u32 vcc, v76, v44
    s_nop 0
    s_or_b64 s[12:13], s[12:13], vcc
    v_cmp_eq_u32 vcc, v76, v45
    s_nop 0
    s_or_b64 s[12:13], s[12:13], vcc
    v_cmp_eq_u32 vcc, v76, v46
    s_nop 0
    s_or_b64 s[12:13], s[12:13], vcc
    v_cmp_eq_u32 vcc, v76, v47
    s_nop 0
    s_or_b64 s[12:13], s[12:13], vcc
    s_cmp_eq_u64 s[12:13], 0
    s_cbranch_scc1 L_rd_56
    s_branch L_rp_55
L_wslow_48:
    s_add_u32 s8, s20, 4096
    buffer_load_dwordx4 v[80:83], v1, s[68:71], s20 offen offset:0 sc1
    buffer_load_dwordx4 v[84:87], v1, s[68:71], s20 offen offset:1024 sc1
    buffer_load_dwordx4 v[88:91], v1, s[68:71], s20 offen offset:2048 sc1
    buffer_load_dwordx4 v[92:95], v1, s[68:71], s20 offen offset:3072 sc1
    buffer_load_dwordx4 v[96:99], v1, s[68:71], s8 offen offset:0 sc1
    buffer_load_dwordx4 v[100:103], v1, s[68:71], s8 offen offset:1024 sc1
    buffer_load_dwordx4 v[104:107], v1, s[68:71], s8 offen offset:2048 sc1
    buffer_load_dwordx4 v[108:111], v1, s[68:71], s8 offen offset:3072 sc1
    s_waitcnt vmcnt(0)
    v_mfma_f32_16x16x32_bf16 v[48:51], v[80:83], v[32:35], 0
    v_mfma_f32_16x16x32_bf16 v[48:51], v[84:87], v[36:39], v[48:51]
    v_mfma_f32_16x16x32_bf16 v[48:51], v[88:91], v[40:43], v[48:51]
    v_mfma_f32_16x16x32_bf16 v[48:51], v[92:95], v[44:47], v[48:51]
    v_mfma_f32_16x16x32_bf16 v[52:55], v[96:99], v[32:35], 0
    v_mfma_f32_16x16x32_bf16 v[52:55], v[100:103], v[36:39], v[52:55]
    v_mfma_f32_16x16x32_bf16 v[52:55], v[104:107], v[40:43], v[52:55]
    v_mfma_f32_16x16x32_bf16 v[52:55], v[108:111], v[44:47], v[52:55]
    buffer_load_dwordx4 v[80:83], v1, s[68:71], s9 offen offset:0 sc1
    buffer_load_dwordx4 v[84:87], v1, s[68:71], s9 offen offset:1024 sc1
    buffer_load_dwordx4 v[88:91], v1, s[68:71], s9 offen offset:2048 sc1
    buffer_load_dwordx4 v[92:95], v1, s[68:71], s9 offen offset:3072 sc1
    s_waitcnt vmcnt(3)
    v_mfma_f32_16x16x32_bf16 v[56:59], v[80:83], v[32:35], 0
    s_waitcnt vmcnt(2)
    v_mfma_f32_16x16x32_bf16 v[56:59], v[84:87], v[36:39], v[56:59]
    s_waitcnt vmcnt(1)
    v_mfma_f32_16x16x32_bf16 v[56:59], v[88:91], v[40:43], v[56:59]
    s_waitcnt vmcnt(0)
    v_mfma_f32_16x16x32_bf16 v[56:59], v[92:95], v[44:47], v[56:59]
    v_mov_b32 v72, 0xff7fffff
    v_cndmask_b32 v48, v72, v48, s[84:85]
    v_cndmask_b32 v49, v72, v49, s[86:87]
    v_cndmask_b32 v50, v72, v50, s[88:89]
    v_cndmask_b32 v51, v72, v51, s[90:91]
    v_cndmask_b32 v52, v72, v52, s[92:93]
    v_cndmask_b32 v53, v72, v53, s[94:95]
    v_cndmask_b32 v54, v72, v54, s[96:97]
    v_cndmask_b32 v55, v72, v55, s[98:99]
    v_max3_f32 v73, v48, v49, v50
    v_max3_f32 v73, v73, v51, v52
    v_max3_f32 v73, v73, v53, v54
    v_max3_f32 v73, v73, v55, v56
    v_max_f32 v73, v73, v57
    v_mov_b32 v74, v73
    s_nop 1
    v_permlane16_swap_b32 v73, v74
    v_max_f32 v73, v73, v74
    v_mov_b32 v74, v73
    s_nop 1
    v_permlane32_swap_b32 v73, v74
    v_max_f32 v73, v73, v74
    v_sub_f32 v48, v48, v73
    v_exp_f32 v48, v48
    v_sub_f32 v49, v49, v73
    v_exp_f32 v49, v49
    v_sub_f32 v50, v50, v73
    v_exp_f32 v50, v50
    v_sub_f32 v51, v51, v73
    v_exp_f32 v51, v51
    v_sub_f32 v52, v52, v73
    v_exp_f32 v52, v52
    v_sub_f32 v53, v53, v73
    v_exp_f32 v53, v53
    v_sub_f32 v54, v54, v73
    v_exp_f32 v54, v54
    v_sub_f32 v55, v55, v73
    v_exp_f32 v55, v55
    v_sub_f32 v96, v56, v73
    v_exp_f32 v96, v96
    v_sub_f32 v97, v57, v73
    v_exp_f32 v97, v97
    v_cvt_pk_bf16_f32 v72, v48, v49
    v_cvt_pk_bf16_f32 v73, v50, v51
    v_cvt_pk_bf16_f32 v74, v52, v53
    v_cvt_pk_bf16_f32 v75, v54, v55
    s_nop 1
    v_mfma_f32_16x16x32_bf16 v[56:59], v[60:63], v[72:75], 0
    v_mfma_f32_16x16x32_bf16 v[80:83], v[16:19], v[72:75], 0
    v_mfma_f32_16x16x32_bf16 v[84:87], v[20:23], v[72:75], 0
    v_mfma_f32_16x16x32_bf16 v[88:91], v[24:27], v[72:75], 0
    v_mfma_f32_16x16x32_bf16 v[92:95], v[28:31], v[72:75], 0
    v_cvt_pk_bf16_f32 v68, v96, v97
    v_cvt_pk_bf16_f32 v71, v96, v97
    s_nop 0
    v_mfma_f32_16x16x16_bf16 v[56:59], v[60:61], v[68:69], v[56:59]
    v_mfma_f32_16x16x16_bf16 v[80:83], v[76:77], v[68:69], v[80:83]
    v_mfma_f32_16x16x16_bf16 v[84:87], v[76:77], v[70:71], v[84:87]
    v_mfma_f32_16x16x16_bf16 v[88:91], v[78:79], v[68:69], v[88:91]
    v_mfma_f32_16x16x16_bf16 v[92:95], v[78:79], v[70:71], v[92:95]
    v_rcp_f32 v52, v56
    s_nop 4
    s_nop 7
    s_branch L_wback_49
L_onext_51:
    s_add_u32 s14, s14, 4
    s_xor_b32 s21, s21, 1048576
    s_xor_b32 s101, s101, 0x8000
    v_xor_b32 v10, 0x8000, v10
    s_nop 1
    s_branch L_p3
L_p3end_34:
    s_endpgm
L_chain:
    s_and_b32 s7, s3, 1
    s_lshl_b32 s7, s7, 2
    v_lshrrev_b32 v19, 4, v0
    v_add_u32 v20, s7, v19
    v_lshlrev_b32 v20, 1, v20
    v_and_b32 v16, 15, v0
    v_xor_b32 v16, v16, v20
    v_lshlrev_b32 v16, 4, v16
    v_bfe_u32 v19, v0, 4, 1
    s_mov_b32 s7, 131072
    v_mad_u32_u24 v16, v19, s7, v16
    v_bfe_u32 v19, v0, 5, 1
    s_mov_b32 s7, 32768
    v_mad_u32_u24 v16, v19, s7, v16
    s_and_b32 s7, s3, 1
    s_lshl_b32 s7, s7, 2
    v_lshrrev_b32 v19, 4, v0
    v_add_u32 v20, s7, v19
    v_lshlrev_b32 v20, 1, v20
    v_and_b32 v17, 15, v0
    v_xor_b32 v17, v17, v20
    v_lshlrev_b32 v17, 4, v17
    v_bfe_u32 v19, v0, 4, 1
    s_mov_b32 s7, 1024
    v_mad_u32_u24 v17, v19, s7, v17
    v_bfe_u32 v19, v0, 5, 1
    s_mov_b32 s7, 4096
    v_mad_u32_u24 v17, v19, s7, v17
    s_lshr_b32 s7, s3, 1
    s_lshl_b32 s7, s7, 16
    s_and_b32 s8, s3, 1
    s_lshl_b32 s9, s8, 14
    s_add_u32 s17, s7, s9
    s_lshl_b32 s7, s5, 8
    s_add_u32 s17, s17, s7
    s_lshl_b32 s34, s5, 17
    s_add_u32 s34, s34, s9
    s_lshr_b32 s7, s3, 1
    s_lshl_b32 s7, s7, 13
    s_add_u32 s34, s34, s7
    s_and_b32 s7, s5, 1
    s_lshl_b32 s7, s7, 9
    s_add_u32 s34, s34, s7
    s_and_b32 s99, s5, 3
    s_add_u32 m0, s16, 98304
    s_add_u32 s8, s17, 0
    buffer_load_dwordx4 v16, s[40:43], s8 offen lds
    s_add_u32 m0, s16, 99328
    s_add_u32 s8, s17, 8192
    buffer_load_dwordx4 v16, s[40:43], s8 offen lds
    s_add_u32 m0, s16, 106496
    s_add_u32 s8, s17, 262144
    buffer_load_dwordx4 v16, s[40:43], s8 offen lds
    s_add_u32 m0, s16, 107520
    s_add_u32 s8, s17, 270336
    buffer_load_dwordx4 v16, s[40:43], s8 offen lds
    s_add_u32 m0, s16, 114688
    s_add_u32 s8, s17, 524288
    buffer_load_dwordx4 v16, s[40:43], s8 offen lds
    s_add_u32 m0, s16, 115712
    s_add_u32 s8, s17, 532480
    buffer_load_dwordx4 v16, s[40:43], s8 offen lds
    s_add_u32 m0, s16, 122880
    s_add_u32 s8, s17, 786432
    buffer_load_dwordx4 v16, s[40:43], s8 offen lds
    s_add_u32 m0, s16, 123904
    s_add_u32 s8, s17, 794624
    buffer_load_dwordx4 v16, s[40:43], s8 offen lds
    s_add_u32 m0, s16, 131072
    s_add_u32 s8, s17, 1048576
    buffer_load_dwordx4 v16, s[40:43], s8 offen lds
    s_add_u32 m0, s16, 132096
    s_add_u32 s8, s17, 1056768
    buffer_load_dwordx4 v16, s[40:43], s8 offen lds
    s_add_u32 m0, s16, 139264
    s_add_u32 s8, s17, 1310720
    buffer_load_dwordx4 v16, s[40:43], s8 offen lds
    s_add_u32 m0, s16, 140288
    s_add_u32 s8, s17, 1318912
    buffer_load_dwordx4 v16, s[40:43], s8 offen lds
    s_add_u32 m0, s16, 147456
    s_add_u32 s8, s17, 1572864
    buffer_load_dwordx4 v16, s[40:43], s8 offen lds
    s_add_u32 m0, s16, 148480
    s_add_u32 s8, s17, 1581056
    buffer_load_dwordx4 v16, s[40:43], s8 offen lds
    s_add_u32 m0, s16, 155648
    s_add_u32 s8, s17, 1835008
    buffer_load_dwordx4 v16, s[40:43], s8 offen lds
    s_add_u32 m0, s16, 156672
    s_add_u32 s8, s17, 1843200
    buffer_load_dwordx4 v16, s[40:43], s8 offen lds
    s_add_u32 m0, s16, 0
    s_add_u32 s8, s17, 2097152
    buffer_load_dwordx4 v16, s[40:43], s8 offen lds
    s_add_u32 m0, s16, 1024
    s_add_u32 s8, s17, 2105344
    buffer_load_dwordx4 v16, s[40:43], s8 offen lds
    s_add_u32 m0, s16, 8192
    s_add_u32 s8, s17, 2359296
    buffer_load_dwordx4 v16, s[40:43], s8 offen lds
    s_add_u32 m0, s16, 9216
    s_add_u32 s8, s17, 2367488
    buffer_load_dwordx4 v16, s[40:43], s8 offen lds
    s_add_u32 m0, s16, 16384
    s_add_u32 s8, s17, 2621440
    buffer_load_dwordx4 v16, s[40:43], s8 offen lds
    s_add_u32 m0, s16, 17408
    s_add_u32 s8, s17, 2629632
    buffer_load_dwordx4 v16, s[40:43], s8 offen lds
    s_add_u32 m0, s16, 24576
    s_add_u32 s8, s17, 2883584
    buffer_load_dwordx4 v16, s[40:43], s8 offen lds
    s_add_u32 m0, s16, 25600
    s_add_u32 s8, s17, 2891776
    buffer_load_dwordx4 v16, s[40:43], s8 offen lds
    s_add_u32 m0, s16, 32768
    s_add_u32 s8, s17, 3145728
    buffer_load_dwordx4 v16, s[40:43], s8 offen lds
    s_add_u32 m0, s16, 33792
    s_add_u32 s8, s17, 3153920
    buffer_load_dwordx4 v16, s[40:43], s8 offen lds
    s_add_u32 m0, s16, 40960
    s_add_u32 s8, s17, 3407872
    buffer_load_dwordx4 v16, s[40:43], s8 offen lds
    s_add_u32 m0, s16, 41984
    s_add_u32 s8, s17, 3416064
    buffer_load_dwordx4 v16, s[40:43], s8 offen lds
    s_add_u32 m0, s16, 49152
    s_add_u32 s8, s17, 3670016
    buffer_load_dwordx4 v16, s[40:43], s8 offen lds
    s_add_u32 m0, s16, 50176
    s_add_u32 s8, s17, 3678208
    buffer_load_dwordx4 v16, s[40:43], s8 offen lds
    s_add_u32 m0, s16, 57344
    s_add_u32 s8, s17, 3932160
    buffer_load_dwordx4 v16, s[40:43], s8 offen lds
    s_add_u32 m0, s16, 58368
    s_add_u32 s8, s17, 3940352
    buffer_load_dwordx4 v16, s[40:43], s8 offen lds
    s_add_u32 m0, s16, 65536
    s_add_u32 s8, s17, 0
    buffer_load_dwordx4 v16, s[44:47], s8 offen lds
    s_add_u32 m0, s16, 66560
    s_add_u32 s8, s17, 8192
    buffer_load_dwordx4 v16, s[44:47], s8 offen lds
    s_add_u32 m0, s16, 73728
    s_add_u32 s8, s17, 262144
    buffer_load_dwordx4 v16, s[44:47], s8 offen lds
    s_add_u32 m0, s16, 74752
    s_add_u32 s8, s17, 270336
    buffer_load_dwordx4 v16, s[44:47], s8 offen lds
    s_add_u32 m0, s16, 81920
    s_add_u32 s8, s17, 524288
    buffer_load_dwordx4 v16, s[44:47], s8 offen lds
    s_add_u32 m0, s16, 82944
    s_add_u32 s8, s17, 532480
    buffer_load_dwordx4 v16, s[44:47], s8 offen lds
    s_add_u32 m0, s16, 90112
    s_add_u32 s8, s17, 786432
    buffer_load_dwordx4 v16, s[44:47], s8 offen lds
    s_add_u32 m0, s16, 91136
    s_add_u32 s8, s17, 794624
    buffer_load_dwordx4 v16, s[44:47], s8 offen lds
    s_lshl_b32 s9, s3, 1
    v_bfe_u32 v19, v0, 2, 2
    v_bfe_u32 v20, v0, 4, 1
    v_lshl_add_u32 v32, v20, 2, v19
    v_xor_b32 v32, s9, v32
    v_lshlrev_b32 v32, 5, v32
    v_lshl_add_u32 v32, v19, 8, v32
    v_lshrrev_b32 v19, 4, v0
    v_lshl_add_u32 v32, v19, 11, v32
    v_and_b32 v19, 3, v0
    v_lshl_add_u32 v32, v19, 3, v32
    v_xor_b32 v33, 32, v32
    v_lshrrev_b32 v21, 4, v0
    v_and_b32 v22, 15, v0
    v_bfe_u32 v19, v0, 1, 1
    v_mov_b32 v2, 0x4444
    s_mov_b32 s7, 0xaaaa
    v_mad_u32_u24 v2, v19, s7, v2
    s_lshl_b32 s7, s3, 6
    s_add_u32 s7, s7, 118784
    v_lshlrev_b32 v3, 2, v22
    v_add_u32 v3, s7, v3
    s_mov_b32 s8, 576
    v_mad_u32_u24 v3, v21, s8, v3
    s_mov_b32 s8, 288
    v_lshlrev_b32 v20, 4, v21
    v_and_b32 v19, 7, v0
    v_mad_u32_u24 v4, v19, s8, v20
    v_add_u32 v4, 118784, v4
    v_lshrrev_b32 v19, 2, v22
    v_lshlrev_b32 v19, 1, v19
    v_and_b32 v5, 1, v0
    v_or_b32 v19, v19, v5
    v_bfe_u32 v5, v0, 1, 1
    v_lshlrev_b32 v5, 4, v5
    v_xor_b32 v5, v5, v20
    v_mad_u32_u24 v5, v19, s8, v5
    v_add_u32 v5, 126976, v5
    s_lshl_b32 s7, s3, 9
    s_add_u32 s7, s7, 118784
    v_bfe_u32 v19, v0, 1, 2
    v_lshlrev_b32 v6, 6, v19
    v_and_b32 v19, 1, v0
    v_lshl_add_u32 v6, v19, 4, v6
    v_lshrrev_b32 v19, 1, v21
    v_lshl_add_u32 v6, v19, 8, v6
    v_and_b32 v19, 1, v21
    v_lshl_add_u32 v6, v19, 5, v6
    v_add_u32 v6, s7, v6
    v_and_b32 v9, 3, v0
    v_lshlrev_b32 v9, 4, v9
    v_bfe_u32 v19, v0, 2, 2
    v_lshl_add_u32 v9, v19, 11, v9
    v_lshl_add_u32 v9, v21, 13, v9
    s_lshr_b32 s7, s5, 4
    s_lshl_b32 s7, s7, 3
    s_bfe_u32 s8, s5, 0x20002
    s_add_u32 s7, s7, s8
    v_and_b32 v27, 1, v21
    v_lshlrev_b32 v27, 2, v27
    v_add_u32 v27, s7, v27
    s_and_b32 s8, s5, 3
    v_lshrrev_b32 v23, 1, v21
    v_and_b32 v10, 3, v0
    v_lshlrev_b32 v10, 2, v10
    v_lshl_add_u32 v10, v23, 4, v10
    s_and_b32 s9, s3, 1
    s_lshl_b32 s9, s9, 5
    s_lshr_b32 s10, s3, 1
    s_lshl_b32 s10, s10, 8
    s_add_u32 s9, s9, s10
    v_add_u32 v10, s9, v10
    v_lshl_add_u32 v10, v27, 9, v10
    s_lshl_b32 s9, s8, 6
    v_add_u32 v10, s9, v10
    s_lshl_b32 s9, s8, 1
    v_add_u32 v23, s9, v23
    v_and_b32 v24, 3, v0
    s_lshl_b32 s9, s3, 2
    v_add_u32 v24, s9, v24
    v_lshlrev_b32 v24, 1, v24
    v_lshl_add_u32 v24, v23, 10, v24
    v_lshl_add_u32 v24, v27, 6, v24
    buffer_load_ushort v25, v24, s[76:79], 0 offen
    buffer_load_ushort v26, v24, s[76:79], 0 offen offset:32
    v_add_u32 v13, 102400, v1
    v_lshlrev_b32 v12, 4, v22
    v_add_u32 v12, 121088, v12
    v_add_u32 v15, 131072, v1
    v_add_u32 v14, 8192, v3
    s_lshl_b32 s7, s3, 13
    v_add_u32 v7, s7, v1
    v_add_u32 v8, 0x10000, v7
    s_add_u32 s7, s5, 0
    s_and_b32 s7, s7, 1
    s_lshl_b32 s7, s7, 2
    s_add_u32 s7, s7, s3
    s_lshl_b32 s7, s7, 15
    s_lshr_b32 s8, s5, 1
    s_lshl_b32 s8, s8, 6
    s_add_u32 s7, s7, s8
    s_add_u32 s85, s7, 46661632
    s_add_u32 s7, s5, 1
    s_and_b32 s7, s7, 1
    s_lshl_b32 s7, s7, 2
    s_add_u32 s7, s7, s3
    s_lshl_b32 s7, s7, 15
    s_lshr_b32 s8, s5, 1
    s_lshl_b32 s8, s8, 6
    s_add_u32 s7, s7, s8
    s_add_u32 s86, s7, 46662656
    s_lshl_b32 s22, s5, 13
    s_add_u32 s22, s22, 46661632
    s_add_u32 s22, s22, s16
    s_mov_b32 s84, s22
    s_add_u32 s84, s84, 524288
    s_mov_b32 s21, 0
    s_mov_b32 s90, 0xfff80000
    s_mov_b32 s23, 46137344
    s_mov_b32 s24, 46145536
    s_mov_b32 s25, 46153728
    s_lshr_b32 s7, s3, 1
    s_mul_i32 s26, s7, 16777216
    s_lshl_b32 s8, s5, 13
    s_add_u32 s26, s26, s8
    s_and_b32 s7, s3, 1
    s_lshl_b32 s8, s7, 12
    s_add_u32 s26, s26, s8
    s_lshl_b32 s91, s3, 12
    s_add_u32 s91, s91, 131072
    s_lshl_b32 s9, s5, 2
    s_add_u32 s27, s9, 48234496
    s_add_u32 s33, s9, 48242688
    s_add_u32 s30, s9, 48259072
    s_lshl_b32 s18, s5, 12
    s_lshl_b32 s8, s3, 10
    s_add_u32 s18, s18, s8
    s_lshr_b32 s19, s18, 1
    s_add_u32 s18, s18, 33554432
    s_add_u32 s19, s19, 41943040
    s_mov_b32 s28, 48300032
    s_mov_b32 s29, 48301056
    s_mov_b32 s20, s30
    s_mov_b32 s36, 0x33333333
    s_mov_b32 s37, 0x33333333
    s_mov_b32 s88, 0x00ff00ff
    s_mov_b32 s89, 0x00ff00ff
    s_mov_b32 s31, 0x3e0293ee
    s_mov_b32 s32, 0x5d800000
    s_waitcnt vmcnt(34)
    s_barrier
    v_add_u32 v18, 98304, v32
    ds_read_b64_tr_b16 a[0:1], v18 offset:0
    ds_read_b64_tr_b16 a[2:3], v18 offset:1024
    ds_read_b64_tr_b16 a[4:5], v18 offset:8192
    ds_read_b64_tr_b16 a[6:7], v18 offset:9216
    ds_read_b64_tr_b16 a[8:9], v18 offset:16384
    ds_read_b64_tr_b16 a[10:11], v18 offset:17408
    ds_read_b64_tr_b16 a[12:13], v18 offset:24576
    ds_read_b64_tr_b16 a[14:15], v18 offset:25600
    v_add_u32 v18, 98304, v33
    ds_read_b64_tr_b16 a[64:65], v18 offset:0
    ds_read_b64_tr_b16 a[66:67], v18 offset:1024
    ds_read_b64_tr_b16 a[68:69], v18 offset:8192
    ds_read_b64_tr_b16 a[70:71], v18 offset:9216
    ds_read_b64_tr_b16 a[72:73], v18 offset:16384
    ds_read_b64_tr_b16 a[74:75], v18 offset:17408
    ds_read_b64_tr_b16 a[76:77], v18 offset:24576
    ds_read_b64_tr_b16 a[78:79], v18 offset:25600
    s_waitcnt lgkmcnt(0)
    s_waitcnt vmcnt(26)
    s_barrier
    buffer_load_dword v34, off, s[72:75], 0 sc1
    buffer_load_dword v36, off, s[72:75], 0 offset:8 sc1
    s_add_u32 m0, s16, 98304
    s_add_u32 s8, s17, 1048576
    buffer_load_dwordx4 v16, s[44:47], s8 offen lds
    s_add_u32 m0, s16, 99328
    s_add_u32 s8, s17, 1056768
    buffer_load_dwordx4 v16, s[44:47], s8 offen lds
    s_add_u32 m0, s16, 106496
    s_add_u32 s8, s17, 1310720
    buffer_load_dwordx4 v16, s[44:47], s8 offen lds
    s_add_u32 m0, s16, 107520
    s_add_u32 s8, s17, 1318912
    buffer_load_dwordx4 v16, s[44:47], s8 offen lds
    s_add_u32 m0, s16, 114688
    s_add_u32 s8, s17, 1572864
    buffer_load_dwordx4 v16, s[44:47], s8 offen lds
    s_add_u32 m0, s16, 115712
    s_add_u32 s8, s17, 1581056
    buffer_load_dwordx4 v16, s[44:47], s8 offen lds
    s_add_u32 m0, s16, 122880
    s_add_u32 s8, s17, 1835008
    buffer_load_dwordx4 v16, s[44:47], s8 offen lds
    s_add_u32 m0, s16, 123904
    s_add_u32 s8, s17, 1843200
    buffer_load_dwordx4 v16, s[44:47], s8 offen lds
    v_add_u32 v18, 131072, v32
    ds_read_b64_tr_b16 a[16:17], v18 offset:0
    ds_read_b64_tr_b16 a[18:19], v18 offset:1024
    ds_read_b64_tr_b16 a[20:21], v18 offset:8192
    ds_read_b64_tr_b16 a[22:23], v18 offset:9216
    ds_read_b64_tr_b16 a[24:25], v18 offset:16384
    ds_read_b64_tr_b16 a[26:27], v18 offset:17408
    ds_read_b64_tr_b16 a[28:29], v18 offset:24576
    ds_read_b64_tr_b16 a[30:31], v18 offset:25600
    v_add_u32 v18, 131072, v33
    ds_read_b64_tr_b16 a[80:81], v18 offset:0
    ds_read_b64_tr_b16 a[82:83], v18 offset:1024
    ds_read_b64_tr_b16 a[84:85], v18 offset:8192
    ds_read_b64_tr_b16 a[86:87], v18 offset:9216
    ds_read_b64_tr_b16 a[88:89], v18 offset:16384
    ds_read_b64_tr_b16 a[90:91], v18 offset:17408
    ds_read_b64_tr_b16 a[92:93], v18 offset:24576
    ds_read_b64_tr_b16 a[94:95], v18 offset:25600
    s_waitcnt lgkmcnt(0)
    s_waitcnt vmcnt(28)
    s_barrier
    s_add_u32 m0, s16, 131072
    s_add_u32 s8, s17, 2097152
    buffer_load_dwordx4 v16, s[44:47], s8 offen lds
    s_add_u32 m0, s16, 132096
    s_add_u32 s8, s17, 2105344
    buffer_load_dwordx4 v16, s[44:47], s8 offen lds
    s_add_u32 m0, s16, 139264
    s_add_u32 s8, s17, 2359296
    buffer_load_dwordx4 v16, s[44:47], s8 offen lds
    s_add_u32 m0, s16, 140288
    s_add_u32 s8, s17, 2367488
    buffer_load_dwordx4 v16, s[44:47], s8 offen lds
    s_add_u32 m0, s16, 147456
    s_add_u32 s8, s17, 2621440
    buffer_load_dwordx4 v16, s[44:47], s8 offen lds
    s_add_u32 m0, s16, 148480
    s_add_u32 s8, s17, 2629632
    buffer_load_dwordx4 v16, s[44:47], s8 offen lds
    s_add_u32 m0, s16, 155648
    s_add_u32 s8, s17, 2883584
    buffer_load_dwordx4 v16, s[44:47], s8 offen lds
    s_add_u32 m0, s16, 156672
    s_add_u32 s8, s17, 2891776
    buffer_load_dwordx4 v16, s[44:47], s8 offen lds
    v_add_u32 v18, 0, v32
    ds_read_b64_tr_b16 a[32:33], v18 offset:0
    ds_read_b64_tr_b16 a[34:35], v18 offset:1024
    ds_read_b64_tr_b16 a[36:37], v18 offset:8192
    ds_read_b64_tr_b16 a[38:39], v18 offset:9216
    ds_read_b64_tr_b16 a[40:41], v18 offset:16384
    ds_read_b64_tr_b16 a[42:43], v18 offset:17408
    ds_read_b64_tr_b16 a[44:45], v18 offset:24576
    ds_read_b64_tr_b16 a[46:47], v18 offset:25600
    v_add_u32 v18, 0, v33
    ds_read_b64_tr_b16 a[96:97], v18 offset:0
    ds_read_b64_tr_b16 a[98:99], v18 offset:1024
    ds_read_b64_tr_b16 a[100:101], v18 offset:8192
    ds_read_b64_tr_b16 a[102:103], v18 offset:9216
    ds_read_b64_tr_b16 a[104:105], v18 offset:16384
    ds_read_b64_tr_b16 a[106:107], v18 offset:17408
    ds_read_b64_tr_b16 a[108:109], v18 offset:24576
    ds_read_b64_tr_b16 a[110:111], v18 offset:25600
    s_waitcnt lgkmcnt(0)
    s_waitcnt vmcnt(28)
    s_barrier
    s_add_u32 m0, s16, 0
    s_add_u32 s8, s17, 3145728
    buffer_load_dwordx4 v16, s[44:47], s8 offen lds
    s_add_u32 m0, s16, 1024
    s_add_u32 s8, s17, 3153920
    buffer_load_dwordx4 v16, s[44:47], s8 offen lds
    s_add_u32 m0, s16, 8192
    s_add_u32 s8, s17, 3407872
    buffer_load_dwordx4 v16, s[44:47], s8 offen lds
    s_add_u32 m0, s16, 9216
    s_add_u32 s8, s17, 3416064
    buffer_load_dwordx4 v16, s[44:47], s8 offen lds
    s_add_u32 m0, s16, 16384
    s_add_u32 s8, s17, 3670016
    buffer_load_dwordx4 v16, s[44:47], s8 offen lds
    s_add_u32 m0, s16, 17408
    s_add_u32 s8, s17, 3678208
    buffer_load_dwordx4 v16, s[44:47], s8 offen lds
    s_add_u32 m0, s16, 24576
    s_add_u32 s8, s17, 3932160
    buffer_load_dwordx4 v16, s[44:47], s8 offen lds
    s_add_u32 m0, s16, 25600
    s_add_u32 s8, s17, 3940352
    buffer_load_dwordx4 v16, s[44:47], s8 offen lds
    v_add_u32 v18, 32768, v32
    ds_read_b64_tr_b16 a[48:49], v18 offset:0
    ds_read_b64_tr_b16 a[50:51], v18 offset:1024
    ds_read_b64_tr_b16 a[52:53], v18 offset:8192
    ds_read_b64_tr_b16 a[54:55], v18 offset:9216
    ds_read_b64_tr_b16 a[56:57], v18 offset:16384
    ds_read_b64_tr_b16 a[58:59], v18 offset:17408
    ds_read_b64_tr_b16 a[60:61], v18 offset:24576
    ds_read_b64_tr_b16 a[62:63], v18 offset:25600
    v_add_u32 v18, 32768, v33
    ds_read_b64_tr_b16 a[112:113], v18 offset:0
    ds_read_b64_tr_b16 a[114:115], v18 offset:1024
    ds_read_b64_tr_b16 a[116:117], v18 offset:8192
    ds_read_b64_tr_b16 a[118:119], v18 offset:9216
    ds_read_b64_tr_b16 a[120:121], v18 offset:16384
    ds_read_b64_tr_b16 a[122:123], v18 offset:17408
    ds_read_b64_tr_b16 a[124:125], v18 offset:24576
    ds_read_b64_tr_b16 a[126:127], v18 offset:25600
    s_waitcnt lgkmcnt(0)
    s_waitcnt vmcnt(28)
    s_barrier
    s_add_u32 m0, s16, 32768
    s_add_u32 s8, s17, 0
    buffer_load_dwordx4 v16, s[48:51], s8 offen lds
    s_add_u32 m0, s16, 33792
    s_add_u32 s8, s17, 8192
    buffer_load_dwordx4 v16, s[48:51], s8 offen lds
    s_add_u32 m0, s16, 40960
    s_add_u32 s8, s17, 262144
    buffer_load_dwordx4 v16, s[48:51], s8 offen lds
    s_add_u32 m0, s16, 41984
    s_add_u32 s8, s17, 270336
    buffer_load_dwordx4 v16, s[48:51], s8 offen lds
    s_add_u32 m0, s16, 49152
    s_add_u32 s8, s17, 524288
    buffer_load_dwordx4 v16, s[48:51], s8 offen lds
    s_add_u32 m0, s16, 50176
    s_add_u32 s8, s17, 532480
    buffer_load_dwordx4 v16, s[48:51], s8 offen lds
    s_add_u32 m0, s16, 57344
    s_add_u32 s8, s17, 786432
    buffer_load_dwordx4 v16, s[48:51], s8 offen lds
    s_add_u32 m0, s16, 58368
    s_add_u32 s8, s17, 794624
    buffer_load_dwordx4 v16, s[48:51], s8 offen lds
    v_add_u32 v18, 65536, v32
    ds_read_b64_tr_b16 a[128:129], v18 offset:0
    ds_read_b64_tr_b16 a[130:131], v18 offset:1024
    ds_read_b64_tr_b16 a[132:133], v18 offset:8192
    ds_read_b64_tr_b16 a[134:135], v18 offset:9216
    ds_read_b64_tr_b16 a[136:137], v18 offset:16384
    ds_read_b64_tr_b16 a[138:139], v18 offset:17408
    ds_read_b64_tr_b16 a[140:141], v18 offset:24576
    ds_read_b64_tr_b16 a[142:143], v18 offset:25600
    v_add_u32 v18, 65536, v33
    ds_read_b64_tr_b16 a[192:193], v18 offset:0
    ds_read_b64_tr_b16 a[194:195], v18 offset:1024
    ds_read_b64_tr_b16 a[196:197], v18 offset:8192
    ds_read_b64_tr_b16 a[198:199], v18 offset:9216
    ds_read_b64_tr_b16 a[200:201], v18 offset:16384
    ds_read_b64_tr_b16 a[202:203], v18 offset:17408
    ds_read_b64_tr_b16 a[204:205], v18 offset:24576
    ds_read_b64_tr_b16 a[206:207], v18 offset:25600
    s_waitcnt lgkmcnt(0)
    s_waitcnt vmcnt(24)
    s_barrier
    v_readfirstlane_b32 s7, v34
    s_mov_b32 s6, 0
    s_cmp_ge_u32 s7, 32
    s_cbranch_scc1 L_pure_58
    s_mov_b32 s15, 1048576
    s_nop 0
L_poll_59:
    buffer_load_dword v19, off, s[72:75], 0 offset:8 sc1
    s_waitcnt vmcnt(0)
    v_readfirstlane_b32 s7, v19
    s_nop 0
    s_cmp_eq_u32 s7, 256
    s_cbranch_scc1 L_polld_60
    s_sub_u32 s15, s15, 1
    s_cmp_eq_u32 s15, 0
    s_cbranch_scc1 L_err_1
    s_branch L_poll_59
L_polld_60:
    s_lshl_b32 s9, s4, 5
    buffer_load_dword v19, off, s[72:75], s9 sc1
    s_waitcnt vmcnt(0)
    v_readfirstlane_b32 s7, v19
    s_nop 0
    s_cmp_lt_u32 s7, 32
    s_cselect_b32 s6, 1, 0
    s_nop 1
L_pure_58:
    s_cmp_eq_u32 s6, 1
    s_cbranch_scc1 L_isafe_61
    v_mov_b32 v28, 0xffbfffbf
    v_mov_b32 v29, 0xffbfffbf
    v_mov_b32 v30, 0xffbfffbf
    v_mov_b32 v31, 0xffbfffbf
    s_sub_u32 s7, s84, 262144
    s_sub_u32 s9, s84, 524288
    buffer_store_dwordx4 v[28:31], v1, s[68:71], s7 offen offset:0
    buffer_store_dwordx4 v[28:31], v1, s[68:71], s7 offen offset:1024
    buffer_store_dwordx4 v[28:31], v1, s[68:71], s9 offen offset:0
    buffer_store_dwordx4 v[28:31], v1, s[68:71], s9 offen offset:1024
    buffer_store_dwordx4 v[28:31], v1, s[68:71], s84 offen offset:0
    buffer_store_dwordx4 v[28:31], v1, s[68:71], s84 offen offset:1024
    v_mov_b32 v27, -1
    buffer_store_dword v27, v10, s[68:71], s23 offen
    buffer_store_dword v27, v10, s[68:71], s24 offen
    buffer_store_dword v27, v10, s[68:71], s25 offen
    s_branch L_ij_62
L_isafe_61:
    v_mov_b32 v28, 0xffbfffbf
    v_mov_b32 v29, 0xffbfffbf
    v_mov_b32 v30, 0xffbfffbf
    v_mov_b32 v31, 0xffbfffbf
    s_sub_u32 s7, s84, 262144
    s_sub_u32 s9, s84, 524288
    buffer_store_dwordx4 v[28:31], v1, s[68:71], s7 offen offset:0 sc1
    buffer_store_dwordx4 v[28:31], v1, s[68:71], s7 offen offset:1024 sc1
    buffer_store_dwordx4 v[28:31], v1, s[68:71], s9 offen offset:0 sc1
    buffer_store_dwordx4 v[28:31], v1, s[68:71], s9 offen offset:1024 sc1
    buffer_store_dwordx4 v[28:31], v1, s[68:71], s84 offen offset:0 sc1
    buffer_store_dwordx4 v[28:31], v1, s[68:71], s84 offen offset:1024 sc1
    v_mov_b32 v27, -1
    buffer_store_dword v27, v10, s[68:71], s23 offen sc1
    buffer_store_dword v27, v10, s[68:71], s24 offen sc1
    buffer_store_dword v27, v10, s[68:71], s25 offen sc1
L_ij_62:
    s_add_u32 m0, s16, 65536
    s_add_u32 s8, s17, 1048576
    buffer_load_dwordx4 v16, s[48:51], s8 offen lds
    s_add_u32 m0, s16, 66560
    s_add_u32 s8, s17, 1056768
    buffer_load_dwordx4 v16, s[48:51], s8 offen lds
    s_add_u32 m0, s16, 73728
    s_add_u32 s8, s17, 1310720
    buffer_load_dwordx4 v16, s[48:51], s8 offen lds
    s_add_u32 m0, s16, 74752
    s_add_u32 s8, s17, 1318912
    buffer_load_dwordx4 v16, s[48:51], s8 offen lds
    s_add_u32 m0, s16, 81920
    s_add_u32 s8, s17, 1572864
    buffer_load_dwordx4 v16, s[48:51], s8 offen lds
    s_add_u32 m0, s16, 82944
    s_add_u32 s8, s17, 1581056
    buffer_load_dwordx4 v16, s[48:51], s8 offen lds
    s_add_u32 m0, s16, 90112
    s_add_u32 s8, s17, 1835008
    buffer_load_dwordx4 v16, s[48:51], s8 offen lds
    s_add_u32 m0, s16, 91136
    s_add_u32 s8, s17, 1843200
    buffer_load_dwordx4 v16, s[48:51], s8 offen lds
    v_add_u32 v18, 98304, v32
    ds_read_b64_tr_b16 a[144:145], v18 offset:0
    ds_read_b64_tr_b16 a[146:147], v18 offset:1024
    ds_read_b64_tr_b16 a[148:149], v18 offset:8192
    ds_read_b64_tr_b16 a[150:151], v18 offset:9216
    ds_read_b64_tr_b16 a[152:153], v18 offset:16384
    ds_read_b64_tr_b16 a[154:155], v18 offset:17408
    ds_read_b64_tr_b16 a[156:157], v18 offset:24576
    ds_read_b64_tr_b16 a[158:159], v18 offset:25600
    v_add_u32 v18, 98304, v33
    ds_read_b64_tr_b16 a[208:209], v18 offset:0
    ds_read_b64_tr_b16 a[210:211], v18 offset:1024
    ds_read_b64_tr_b16 a[212:213], v18 offset:8192
    ds_read_b64_tr_b16 a[214:215], v18 offset:9216
    ds_read_b64_tr_b16 a[216:217], v18 offset:16384
    ds_read_b64_tr_b16 a[218:219], v18 offset:17408
    ds_read_b64_tr_b16 a[220:221], v18 offset:24576
    ds_read_b64_tr_b16 a[222:223], v18 offset:25600
    s_waitcnt lgkmcnt(0)
    s_waitcnt vmcnt(42)
    s_barrier
    s_xor_b32 s9, s34, 0
    s_add_u32 m0, s16, 98304
    s_add_u32 s8, s9, 0
    buffer_load_dwordx4 v17, s[52:55], s8 offen lds
    s_add_u32 m0, s16, 99328
    s_add_u32 s8, s9, 2048
    buffer_load_dwordx4 v17, s[52:55], s8 offen lds
    s_add_u32 m0, s16, 106496
    s_add_u32 s8, s9, 32768
    buffer_load_dwordx4 v17, s[52:55], s8 offen lds
    s_add_u32 m0, s16, 107520
    s_add_u32 s8, s9, 34816
    buffer_load_dwordx4 v17, s[52:55], s8 offen lds
    s_add_u32 m0, s16, 114688
    s_add_u32 s8, s9, 65536
    buffer_load_dwordx4 v17, s[52:55], s8 offen lds
    s_add_u32 m0, s16, 115712
    s_add_u32 s8, s9, 67584
    buffer_load_dwordx4 v17, s[52:55], s8 offen lds
    s_add_u32 m0, s16, 122880
    s_add_u32 s8, s9, 98304
    buffer_load_dwordx4 v17, s[52:55], s8 offen lds
    s_add_u32 m0, s16, 123904
    s_add_u32 s8, s9, 100352
    buffer_load_dwordx4 v17, s[52:55], s8 offen lds
    v_add_u32 v18, 131072, v32
    ds_read_b64_tr_b16 a[160:161], v18 offset:0
    ds_read_b64_tr_b16 a[162:163], v18 offset:1024
    ds_read_b64_tr_b16 a[164:165], v18 offset:8192
    ds_read_b64_tr_b16 a[166:167], v18 offset:9216
    ds_read_b64_tr_b16 a[168:169], v18 offset:16384
    ds_read_b64_tr_b16 a[170:171], v18 offset:17408
    ds_read_b64_tr_b16 a[172:173], v18 offset:24576
    ds_read_b64_tr_b16 a[174:175], v18 offset:25600
    v_add_u32 v18, 131072, v33
    ds_read_b64_tr_b16 a[224:225], v18 offset:0
    ds_read_b64_tr_b16 a[226:227], v18 offset:1024
    ds_read_b64_tr_b16 a[228:229], v18 offset:8192
    ds_read_b64_tr_b16 a[230:231], v18 offset:9216
    ds_read_b64_tr_b16 a[232:233], v18 offset:16384
    ds_read_b64_tr_b16 a[234:235], v18 offset:17408
    ds_read_b64_tr_b16 a[236:237], v18 offset:24576
    ds_read_b64_tr_b16 a[238:239], v18 offset:25600
    s_waitcnt lgkmcnt(0)
    s_waitcnt vmcnt(42)
    s_barrier
    s_xor_b32 s9, s34, 256
    s_add_u32 m0, s16, 131072
    s_add_u32 s8, s9, 0
    buffer_load_dwordx4 v17, s[52:55], s8 offen lds
    s_add_u32 m0, s16, 132096
    s_add_u32 s8, s9, 2048
    buffer_load_dwordx4 v17, s[52:55], s8 offen lds
    s_add_u32 m0, s16, 139264
    s_add_u32 s8, s9, 32768
    buffer_load_dwordx4 v17, s[52:55], s8 offen lds
    s_add_u32 m0, s16, 140288
    s_add_u32 s8, s9, 34816
    buffer_load_dwordx4 v17, s[52:55], s8 offen lds
    s_add_u32 m0, s16, 147456
    s_add_u32 s8, s9, 65536
    buffer_load_dwordx4 v17, s[52:55], s8 offen lds
    s_add_u32 m0, s16, 148480
    s_add_u32 s8, s9, 67584
    buffer_load_dwordx4 v17, s[52:55], s8 offen lds
    s_add_u32 m0, s16, 155648
    s_add_u32 s8, s9, 98304
    buffer_load_dwordx4 v17, s[52:55], s8 offen lds
    s_add_u32 m0, s16, 156672
    s_add_u32 s8, s9, 100352
    buffer_load_dwordx4 v17, s[52:55], s8 offen lds
    v_add_u32 v18, 0, v32
    ds_read_b64_tr_b16 a[176:177], v18 offset:0
    ds_read_b64_tr_b16 a[178:179], v18 offset:1024
    ds_read_b64_tr_b16 a[180:181], v18 offset:8192
    ds_read_b64_tr_b16 a[182:183], v18 offset:9216
    ds_read_b64_tr_b16 a[184:185], v18 offset:16384
    ds_read_b64_tr_b16 a[186:187], v18 offset:17408
    ds_read_b64_tr_b16 a[188:189], v18 offset:24576
    ds_read_b64_tr_b16 a[190:191], v18 offset:25600
    v_add_u32 v18, 0, v33
    ds_read_b64_tr_b16 a[240:241], v18 offset:0
    ds_read_b64_tr_b16 a[242:243], v18 offset:1024
    ds_read_b64_tr_b16 a[244:245], v18 offset:8192
    ds_read_b64_tr_b16 a[246:247], v18 offset:9216
    ds_read_b64_tr_b16 a[248:249], v18 offset:16384
    ds_read_b64_tr_b16 a[250:251], v18 offset:17408
    ds_read_b64_tr_b16 a[252:253], v18 offset:24576
    ds_read_b64_tr_b16 a[254:255], v18 offset:25600
    s_waitcnt lgkmcnt(0)
    s_waitcnt vmcnt(42)
    s_barrier
    s_add_u32 m0, s16, 0
    s_add_u32 s8, s17, 2097152
    buffer_load_dwordx4 v16, s[48:51], s8 offen lds
    s_add_u32 m0, s16, 1024
    s_add_u32 s8, s17, 2105344
    buffer_load_dwordx4 v16, s[48:51], s8 offen lds
    s_add_u32 m0, s16, 8192
    s_add_u32 s8, s17, 2359296
    buffer_load_dwordx4 v16, s[48:51], s8 offen lds
    s_add_u32 m0, s16, 9216
    s_add_u32 s8, s17, 2367488
    buffer_load_dwordx4 v16, s[48:51], s8 offen lds
    s_add_u32 m0, s16, 16384
    s_add_u32 s8, s17, 2621440
    buffer_load_dwordx4 v16, s[48:51], s8 offen lds
    s_add_u32 m0, s16, 17408
    s_add_u32 s8, s17, 2629632
    buffer_load_dwordx4 v16, s[48:51], s8 offen lds
    s_add_u32 m0, s16, 24576
    s_add_u32 s8, s17, 2883584
    buffer_load_dwordx4 v16, s[48:51], s8 offen lds
    s_add_u32 m0, s16, 25600
    s_add_u32 s8, s17, 2891776
    buffer_load_dwordx4 v16, s[48:51], s8 offen lds
    v_add_u32 v18, 32768, v32
    ds_read_b64_tr_b16 v[128:129], v18 offset:0
    ds_read_b64_tr_b16 v[130:131], v18 offset:1024
    ds_read_b64_tr_b16 v[132:133], v18 offset:8192
    ds_read_b64_tr_b16 v[134:135], v18 offset:9216
    ds_read_b64_tr_b16 v[144:145], v18 offset:16384
    ds_read_b64_tr_b16 v[146:147], v18 offset:17408
    ds_read_b64_tr_b16 v[148:149], v18 offset:24576
    ds_read_b64_tr_b16 v[150:151], v18 offset:25600
    v_add_u32 v18, 32768, v33
    ds_read_b64_tr_b16 v[136:137], v18 offset:0
    ds_read_b64_tr_b16 v[138:139], v18 offset:1024
    ds_read_b64_tr_b16 v[140:141], v18 offset:8192
    ds_read_b64_tr_b16 v[142:143], v18 offset:9216
    ds_read_b64_tr_b16 v[152:153], v18 offset:16384
    ds_read_b64_tr_b16 v[154:155], v18 offset:17408
    ds_read_b64_tr_b16 v[156:157], v18 offset:24576
    ds_read_b64_tr_b16 v[158:159], v18 offset:25600
    s_waitcnt lgkmcnt(0)
    s_waitcnt vmcnt(24)
    s_barrier
    s_barrier
    s_cmp_eq_u32 s3, 0
    s_cbranch_scc0 L_im2_63
    v_mov_b32 v27, 1
    s_mov_b64 exec, 1
    buffer_atomic_add v27, off, s[72:75], 0 offset:12
    s_mov_b64 exec, -1
L_im2_63:
    s_add_u32 m0, s16, 32768
    s_add_u32 s8, s17, 3145728
    buffer_load_dwordx4 v16, s[48:51], s8 offen lds
    s_add_u32 m0, s16, 33792
    s_add_u32 s8, s17, 3153920
    buffer_load_dwordx4 v16, s[48:51], s8 offen lds
    s_add_u32 m0, s16, 40960
    s_add_u32 s8, s17, 3407872
    buffer_load_dwordx4 v16, s[48:51], s8 offen lds
    s_add_u32 m0, s16, 41984
    s_add_u32 s8, s17, 3416064
    buffer_load_dwordx4 v16, s[48:51], s8 offen lds
    s_add_u32 m0, s16, 49152
    s_add_u32 s8, s17, 3670016
    buffer_load_dwordx4 v16, s[48:51], s8 offen lds
    s_add_u32 m0, s16, 50176
    s_add_u32 s8, s17, 3678208
    buffer_load_dwordx4 v16, s[48:51], s8 offen lds
    s_add_u32 m0, s16, 57344
    s_add_u32 s8, s17, 3932160
    buffer_load_dwordx4 v16, s[48:51], s8 offen lds
    s_add_u32 m0, s16, 58368
    s_add_u32 s8, s17, 3940352
    buffer_load_dwordx4 v16, s[48:51], s8 offen lds
    v_add_u32 v18, 65536, v32
    ds_read_b64_tr_b16 v[160:161], v18 offset:0
    ds_read_b64_tr_b16 v[162:163], v18 offset:1024
    ds_read_b64_tr_b16 v[164:165], v18 offset:8192
    ds_read_b64_tr_b16 v[166:167], v18 offset:9216
    ds_read_b64_tr_b16 v[176:177], v18 offset:16384
    ds_read_b64_tr_b16 v[178:179], v18 offset:17408
    ds_read_b64_tr_b16 v[180:181], v18 offset:24576
    ds_read_b64_tr_b16 v[182:183], v18 offset:25600
    v_add_u32 v18, 65536, v33
    ds_read_b64_tr_b16 v[168:169], v18 offset:0
    ds_read_b64_tr_b16 v[170:171], v18 offset:1024
    ds_read_b64_tr_b16 v[172:173], v18 offset:8192
    ds_read_b64_tr_b16 v[174:175], v18 offset:9216
    ds_read_b64_tr_b16 v[184:185], v18 offset:16384
    ds_read_b64_tr_b16 v[186:187], v18 offset:17408
    ds_read_b64_tr_b16 v[188:189], v18 offset:24576
    ds_read_b64_tr_b16 v[190:191], v18 offset:25600
    s_waitcnt lgkmcnt(0)
    s_waitcnt vmcnt(24)
    s_barrier
    s_xor_b32 s9, s34, 512
    s_add_u32 m0, s16, 65536
    s_add_u32 s8, s9, 0
    buffer_load_dwordx4 v17, s[52:55], s8 offen lds
    s_add_u32 m0, s16, 66560
    s_add_u32 s8, s9, 2048
    buffer_load_dwordx4 v17, s[52:55], s8 offen lds
    s_add_u32 m0, s16, 73728
    s_add_u32 s8, s9, 32768
    buffer_load_dwordx4 v17, s[52:55], s8 offen lds
    s_add_u32 m0, s16, 74752
    s_add_u32 s8, s9, 34816
    buffer_load_dwordx4 v17, s[52:55], s8 offen lds
    s_add_u32 m0, s16, 81920
    s_add_u32 s8, s9, 65536
    buffer_load_dwordx4 v17, s[52:55], s8 offen lds
    s_add_u32 m0, s16, 82944
    s_add_u32 s8, s9, 67584
    buffer_load_dwordx4 v17, s[52:55], s8 offen lds
    s_add_u32 m0, s16, 90112
    s_add_u32 s8, s9, 98304
    buffer_load_dwordx4 v17, s[52:55], s8 offen lds
    s_add_u32 m0, s16, 91136
    s_add_u32 s8, s9, 100352
    buffer_load_dwordx4 v17, s[52:55], s8 offen lds
    v_add_u32 v18, 98304, v32
    ds_read_b64_tr_b16 v[192:193], v18 offset:0
    ds_read_b64_tr_b16 v[194:195], v18 offset:1024
    ds_read_b64_tr_b16 v[196:197], v18 offset:8192
    ds_read_b64_tr_b16 v[198:199], v18 offset:9216
    ds_read_b64_tr_b16 v[200:201], v18 offset:16384
    ds_read_b64_tr_b16 v[202:203], v18 offset:17408
    ds_read_b64_tr_b16 v[204:205], v18 offset:24576
    ds_read_b64_tr_b16 v[206:207], v18 offset:25600
    v_add_u32 v18, 98304, v33
    ds_read_b64_tr_b16 v[208:209], v18 offset:0
    ds_read_b64_tr_b16 v[210:211], v18 offset:1024
    ds_read_b64_tr_b16 v[212:213], v18 offset:8192
    ds_read_b64_tr_b16 v[214:215], v18 offset:9216
    ds_read_b64_tr_b16 v[216:217], v18 offset:16384
    ds_read_b64_tr_b16 v[218:219], v18 offset:17408
    ds_read_b64_tr_b16 v[220:221], v18 offset:24576
    ds_read_b64_tr_b16 v[222:223], v18 offset:25600
    s_waitcnt lgkmcnt(0)
    s_waitcnt vmcnt(24)
    s_barrier
    s_xor_b32 s9, s34, 768
    s_add_u32 m0, s16, 98304
    s_add_u32 s8, s9, 0
    buffer_load_dwordx4 v17, s[52:55], s8 offen lds
    s_add_u32 m0, s16, 99328
    s_add_u32 s8, s9, 2048
    buffer_load_dwordx4 v17, s[52:55], s8 offen lds
    s_add_u32 m0, s16, 106496
    s_add_u32 s8, s9, 32768
    buffer_load_dwordx4 v17, s[52:55], s8 offen lds
    s_add_u32 m0, s16, 107520
    s_add_u32 s8, s9, 34816
    buffer_load_dwordx4 v17, s[52:55], s8 offen lds
    s_add_u32 m0, s16, 114688
    s_add_u32 s8, s9, 65536
    buffer_load_dwordx4 v17, s[52:55], s8 offen lds
    s_add_u32 m0, s16, 115712
    s_add_u32 s8, s9, 67584
    buffer_load_dwordx4 v17, s[52:55], s8 offen lds
    s_add_u32 m0, s16, 122880
    s_add_u32 s8, s9, 98304
    buffer_load_dwordx4 v17, s[52:55], s8 offen lds
    s_add_u32 m0, s16, 123904
    s_add_u32 s8, s9, 100352
    buffer_load_dwordx4 v17, s[52:55], s8 offen lds
    v_add_u32 v18, 131072, v32
    ds_read_b64_tr_b16 v[224:225], v18 offset:0
    ds_read_b64_tr_b16 v[226:227], v18 offset:1024
    ds_read_b64_tr_b16 v[228:229], v18 offset:8192
    ds_read_b64_tr_b16 v[230:231], v18 offset:9216
    ds_read_b64_tr_b16 v[232:233], v18 offset:16384
    ds_read_b64_tr_b16 v[234:235], v18 offset:17408
    ds_read_b64_tr_b16 v[236:237], v18 offset:24576
    ds_read_b64_tr_b16 v[238:239], v18 offset:25600
    v_add_u32 v18, 131072, v33
    ds_read_b64_tr_b16 v[240:241], v18 offset:0
    ds_read_b64_tr_b16 v[242:243], v18 offset:1024
    ds_read_b64_tr_b16 v[244:245], v18 offset:8192
    ds_read_b64_tr_b16 v[246:247], v18 offset:9216
    ds_read_b64_tr_b16 v[248:249], v18 offset:16384
    ds_read_b64_tr_b16 v[250:251], v18 offset:17408
    ds_read_b64_tr_b16 v[252:253], v18 offset:24576
    ds_read_b64_tr_b16 v[254:255], v18 offset:25600
    s_waitcnt lgkmcnt(0)
    s_waitcnt vmcnt(24)
    s_barrier
    v_add_u32 v18, 0, v32
    ds_read_b64_tr_b16 v[40:41], v18 offset:0
    ds_read_b64_tr_b16 v[42:43], v18 offset:1024
    ds_read_b64_tr_b16 v[44:45], v18 offset:8192
    ds_read_b64_tr_b16 v[46:47], v18 offset:9216
    ds_read_b64_tr_b16 v[48:49], v18 offset:16384
    ds_read_b64_tr_b16 v[50:51], v18 offset:17408
    ds_read_b64_tr_b16 v[52:53], v18 offset:24576
    ds_read_b64_tr_b16 v[54:55], v18 offset:25600
    v_add_u32 v18, 0, v33
    ds_read_b64_tr_b16 v[56:57], v18 offset:0
    ds_read_b64_tr_b16 v[58:59], v18 offset:1024
    ds_read_b64_tr_b16 v[60:61], v18 offset:8192
    ds_read_b64_tr_b16 v[62:63], v18 offset:9216
    ds_read_b64_tr_b16 v[64:65], v18 offset:16384
    ds_read_b64_tr_b16 v[66:67], v18 offset:17408
    ds_read_b64_tr_b16 v[68:69], v18 offset:24576
    ds_read_b64_tr_b16 v[70:71], v18 offset:25600
    s_waitcnt lgkmcnt(0)
    s_waitcnt vmcnt(16)
    s_barrier
    v_readfirstlane_b32 s7, v36
    s_nop 0
    s_cmp_eq_u32 s7, 256
    s_cbranch_scc1 L_ck_64
    s_mov_b32 s15, 1048576
    s_nop 0
L_poll_65:
    buffer_load_dword v19, off, s[72:75], 0 offset:8 sc1
    s_waitcnt vmcnt(0)
    v_readfirstlane_b32 s7, v19
    s_nop 0
    s_cmp_eq_u32 s7, 256
    s_cbranch_scc1 L_polld_66
    s_sub_u32 s15, s15, 1
    s_cmp_eq_u32 s15, 0
    s_cbranch_scc1 L_err_1
    s_branch L_poll_65
L_polld_66:
L_ck_64:
    buffer_load_dword v35, off, s[72:75], 0 offset:12 sc1
    buffer_load_dword v37, off, s[68:71], s27 sc1
    buffer_load_dword v38, off, s[68:71], s27 offset:128 sc1
    ds_write_b128 v7, v[40:43] offset:0
    ds_write_b128 v7, v[44:47] offset:1024
    ds_write_b128 v7, v[48:51] offset:4096
    ds_write_b128 v7, v[52:55] offset:5120
    ds_write_b128 v7, v[56:59] offset:2048
    ds_write_b128 v7, v[60:63] offset:3072
    ds_write_b128 v7, v[64:67] offset:6144
    ds_write_b128 v7, v[68:71] offset:7168
    v_add_u32 v18, 32768, v32
    ds_read_b64_tr_b16 v[72:73], v18 offset:0
    ds_read_b64_tr_b16 v[74:75], v18 offset:1024
    ds_read_b64_tr_b16 v[76:77], v18 offset:8192
    ds_read_b64_tr_b16 v[78:79], v18 offset:9216
    ds_read_b64_tr_b16 v[80:81], v18 offset:16384
    ds_read_b64_tr_b16 v[82:83], v18 offset:17408
    ds_read_b64_tr_b16 v[84:85], v18 offset:24576
    ds_read_b64_tr_b16 v[86:87], v18 offset:25600
    v_add_u32 v18, 32768, v33
    ds_read_b64_tr_b16 v[88:89], v18 offset:0
    ds_read_b64_tr_b16 v[90:91], v18 offset:1024
    ds_read_b64_tr_b16 v[92:93], v18 offset:8192
    ds_read_b64_tr_b16 v[94:95], v18 offset:9216
    ds_read_b64_tr_b16 v[96:97], v18 offset:16384
    ds_read_b64_tr_b16 v[98:99], v18 offset:17408
    ds_read_b64_tr_b16 v[100:101], v18 offset:24576
    ds_read_b64_tr_b16 v[102:103], v18 offset:25600
    s_waitcnt lgkmcnt(0)
    s_waitcnt vmcnt(11)
    s_barrier
    ds_write_b128 v7, v[72:75] offset:32768
    ds_write_b128 v7, v[76:79] offset:33792
    ds_write_b128 v7, v[80:83] offset:36864
    ds_write_b128 v7, v[84:87] offset:37888
    ds_write_b128 v7, v[88:91] offset:34816
    ds_write_b128 v7, v[92:95] offset:35840
    ds_write_b128 v7, v[96:99] offset:38912
    ds_write_b128 v7, v[100:103] offset:39936
    v_add_u32 v18, 65536, v32
    ds_read_b64_tr_b16 v[40:41], v18 offset:0
    ds_read_b64_tr_b16 v[42:43], v18 offset:1024
    ds_read_b64_tr_b16 v[44:45], v18 offset:8192
    ds_read_b64_tr_b16 v[46:47], v18 offset:9216
    ds_read_b64_tr_b16 v[48:49], v18 offset:16384
    ds_read_b64_tr_b16 v[50:51], v18 offset:17408
    ds_read_b64_tr_b16 v[52:53], v18 offset:24576
    ds_read_b64_tr_b16 v[54:55], v18 offset:25600
    v_add_u32 v18, 65536, v33
    ds_read_b64_tr_b16 v[56:57], v18 offset:0
    ds_read_b64_tr_b16 v[58:59], v18 offset:1024
    ds_read_b64_tr_b16 v[60:61], v18 offset:8192
    ds_read_b64_tr_b16 v[62:63], v18 offset:9216
    ds_read_b64_tr_b16 v[64:65], v18 offset:16384
    ds_read_b64_tr_b16 v[66:67], v18 offset:17408
    ds_read_b64_tr_b16 v[68:69], v18 offset:24576
    ds_read_b64_tr_b16 v[70:71], v18 offset:25600
    s_waitcnt lgkmcnt(0)
    s_waitcnt vmcnt(3)
    s_barrier
    ds_write_b128 v8, v[40:43] offset:0
    ds_write_b128 v8, v[44:47] offset:1024
    ds_write_b128 v8, v[48:51] offset:2048
    ds_write_b128 v8, v[52:55] offset:3072
    ds_write_b128 v8, v[56:59] offset:4096
    ds_write_b128 v8, v[60:63] offset:5120
    ds_write_b128 v8, v[64:67] offset:6144
    ds_write_b128 v8, v[68:71] offset:7168
    v_add_u32 v18, 98304, v32
    ds_read_b64_tr_b16 v[112:113], v18 offset:0
    ds_read_b64_tr_b16 v[114:115], v18 offset:1024
    ds_read_b64_tr_b16 v[116:117], v18 offset:8192
    ds_read_b64_tr_b16 v[118:119], v18 offset:9216
    ds_read_b64_tr_b16 v[80:81], v18 offset:16384
    ds_read_b64_tr_b16 v[82:83], v18 offset:17408
    ds_read_b64_tr_b16 v[84:85], v18 offset:24576
    ds_read_b64_tr_b16 v[86:87], v18 offset:25600
    v_add_u32 v18, 98304, v33
    ds_read_b64_tr_b16 v[120:121], v18 offset:0
    ds_read_b64_tr_b16 v[122:123], v18 offset:1024
    ds_read_b64_tr_b16 v[124:125], v18 offset:8192
    ds_read_b64_tr_b16 v[126:127], v18 offset:9216
    ds_read_b64_tr_b16 v[96:97], v18 offset:16384
    ds_read_b64_tr_b16 v[98:99], v18 offset:17408
    ds_read_b64_tr_b16 v[100:101], v18 offset:24576
    ds_read_b64_tr_b16 v[102:103], v18 offset:25600
    s_waitcnt lgkmcnt(0)
    s_waitcnt vmcnt(0)
    v_readfirstlane_b32 s7, v37
    s_nop 0
    s_cmp_eq_u32 s7, 1
    s_cbranch_scc1 L_ck_67
    s_mov_b32 s15, 1048576
    s_nop 0
L_poll_68:
    buffer_load_dword v19, off, s[68:71], s27 offset:0 sc1
    s_waitcnt vmcnt(0)
    v_readfirstlane_b32 s7, v19
    s_nop 0
    s_cmp_eq_u32 s7, 1
    s_cbranch_scc1 L_polld_69
    s_sub_u32 s15, s15, 1
    s_cmp_eq_u32 s15, 0
    s_cbranch_scc1 L_err_7
    s_branch L_poll_68
L_polld_69:
L_ck_67:
    s_mov_b32 m0, s91
    s_nop 0
    buffer_load_dwordx4 v1, s[68:71], s26 offen offset:0 sc1 lds
    buffer_load_dwordx4 v1, s[68:71], s26 offen offset:1024 sc1 lds
    buffer_load_dwordx4 v1, s[68:71], s26 offen offset:2048 sc1 lds
    buffer_load_dwordx4 v1, s[68:71], s26 offen offset:3072 sc1 lds
    v_readfirstlane_b32 s7, v35
    s_nop 0
    s_cmp_eq_u32 s7, 32
    s_cbranch_scc1 L_ck_70
    s_mov_b32 s15, 1048576
    s_nop 0
L_poll_71:
    buffer_load_dword v19, off, s[72:75], 0 offset:12 sc1
    s_waitcnt vmcnt(0)
    v_readfirstlane_b32 s7, v19
    s_nop 0
    s_cmp_eq_u32 s7, 32
    s_cbranch_scc1 L_polld_72
    s_sub_u32 s15, s15, 1
    s_cmp_eq_u32 s15, 0
    s_cbranch_scc1 L_err_6
    s_branch L_poll_71
L_polld_72:
L_ck_70:
    v_lshl_or_b32 v25, v26, 16, v25
    v_min_u32 v25, 0xfffffffe, v25
    s_cmp_eq_u32 s6, 1
    s_cbranch_scc1 L_ps_74
    buffer_store_dword v25, v10, s[68:71], s23 offen
    s_branch L_nopub_73
L_ps_74:
    buffer_store_dword v25, v10, s[68:71], s23 offen sc1
L_nopub_73:
    s_barrier
    ds_write_b128 v8, v[80:83] offset:32768
    ds_write_b128 v8, v[84:87] offset:33792
    ds_write_b128 v8, v[96:99] offset:34816
    ds_write_b128 v8, v[100:103] offset:35840
    s_xor_b32 s91, s91, 16384
    s_add_u32 s26, s26, 262144
    v_readfirstlane_b32 s7, v38
    s_nop 0
    s_cmp_eq_u32 s7, 1
    s_cbranch_scc1 L_ck_75
    s_mov_b32 s15, 1048576
    s_nop 0
L_poll_76:
    buffer_load_dword v19, off, s[68:71], s27 offset:128 sc1
    s_waitcnt vmcnt(0)
    v_readfirstlane_b32 s7, v19
    s_nop 0
    s_cmp_eq_u32 s7, 1
    s_cbranch_scc1 L_polld_77
    s_sub_u32 s15, s15, 1
    s_cmp_eq_u32 s15, 0
    s_cbranch_scc1 L_err_7
    s_branch L_poll_76
L_polld_77:
L_ck_75:
    s_add_u32 s27, s27, 256
    v_and_b32 v19, 15, v0
    v_and_b32 v20, 7, v0
    v_lshrrev_b32 v19, 3, v19
    v_lshlrev_b32 v19, 1, v19
    v_xor_b32 v19, v19, v20
    v_and_b32 v20, 1, v19
    v_lshlrev_b32 v20, 4, v20
    v_mov_b32 v21, 0x3f80
    v_lshlrev_b32 v20, v20, v21
    v_lshrrev_b32 v19, 1, v19
    v_cmp_eq_u32 vcc, 0, v19
    s_nop 1
    v_cndmask_b32 v28, 0, v20, vcc
    v_cmp_eq_u32 vcc, 1, v19
    s_nop 1
    v_cndmask_b32 v29, 0, v20, vcc
    v_cmp_eq_u32 vcc, 2, v19
    s_nop 1
    v_cndmask_b32 v30, 0, v20, vcc
    v_cmp_eq_u32 vcc, 3, v19
    s_nop 1
    v_cndmask_b32 v31, 0, v20, vcc
    v_add_u32 v21, 129280, v1
    ds_write_b128 v21, v[28:31]
    v_mov_b32 v28, 0x3f803f80
    v_mov_b32 v29, 0x3f803f80
    v_mov_b32 v30, 0x3f803f80
    v_mov_b32 v31, 0x3f803f80
    ds_write_b128 v12, v[28:31] offset:0
    v_mov_b32 v28, 0x0
    v_mov_b32 v29, 0x0
    v_mov_b32 v30, 0x0
    v_mov_b32 v31, 0x0
    ds_write_b128 v12, v[28:31] offset:256
    v_mov_b32 v28, 0xffbfffbf
    v_mov_b32 v29, 0xffbfffbf
    v_mov_b32 v30, 0xffbfffbf
    v_mov_b32 v31, 0xffbfffbf
    ds_write_b128 v12, v[28:31] offset:512
    v_lshlrev_b32 v0, 3, v0
    v_mov_b32 v105, 0
    v_mov_b32 v108, 0
    v_mov_b32 v106, 0
    v_mov_b32 v107, 0
    s_mov_b32 s14, 0
    s_add_u32 s17, s23, s16
    s_waitcnt vmcnt(0) lgkmcnt(0)
    s_barrier
    s_lshl_b32 s7, s6, 2
    s_add_u32 s7, s7, s3
    s_cmp_eq_u32 s7, 1
    s_cbranch_scc1 L_cl_1
    s_cmp_eq_u32 s7, 2
    s_cbranch_scc1 L_cl_2
    s_cmp_eq_u32 s7, 3
    s_cbranch_scc1 L_cl_3
    s_cmp_eq_u32 s7, 4
    s_cbranch_scc1 L_cl_4
    s_cmp_eq_u32 s7, 5
    s_cbranch_scc1 L_cl_5
    s_cmp_eq_u32 s7, 6
    s_cbranch_scc1 L_cl_6
    s_cmp_eq_u32 s7, 7
    s_cbranch_scc1 L_cl_7
L_cl_0:
    ds_read_b128 v[56:59], v7 offset:0
    ds_read_b128 v[60:63], v7 offset:1024
    ds_read_b128 v[64:67], v7 offset:2048
    ds_read_b128 v[68:71], v7 offset:3072
    ds_read_b128 v[72:75], v7 offset:4096
    ds_read_b128 v[76:79], v7 offset:5120
    ds_read_b128 v[80:83], v7 offset:6144
    ds_read_b128 v[84:87], v7 offset:7168
    ds_read_b128 v[16:19], v12 offset:256
    ds_read_b128 v[20:23], v12 offset:256
    ds_read_b128 v[32:35], v12 offset:256
    ds_read_b128 v[36:39], v12 offset:256
    v_mov_b32 v104, 1
    s_mov_b32 m0, s91
    s_mov_b32 s15, 1048576
    buffer_load_dwordx4 v[24:27], v1, s[68:71], s17 offen offset:0 sc1
    buffer_load_dwordx4 v[28:31], v1, s[68:71], s17 offen offset:1024 sc1
L_chk_f0:
    buffer_load_dwordx4 v[88:91], v1, s[68:71], s17 offen offset:0 sc1
    buffer_load_dwordx4 v[92:95], v1, s[68:71], s17 offen offset:1024 sc1
    s_waitcnt vmcnt(2)
    ds_write_b128 v13, v[24:27] offset:0
    ds_write_b128 v13, v[28:31] offset:1024
    v_max3_u32 v111, v24, v25, v26
    v_max3_u32 v110, v27, v28, v29
    v_max3_u32 v111, v111, v30, v31
    v_max_u32 v111, v111, v110
    v_cmp_eq_u32 vcc, -1, v111
    s_cbranch_vccz L_bar1_f0
    buffer_load_dwordx4 v[24:27], v1, s[68:71], s17 offen offset:0 sc1
    buffer_load_dwordx4 v[28:31], v1, s[68:71], s17 offen offset:1024 sc1
    s_waitcnt vmcnt(2)
    ds_write_b128 v13, v[88:91] offset:0
    ds_write_b128 v13, v[92:95] offset:1024
    v_max3_u32 v111, v88, v89, v90
    v_max3_u32 v110, v91, v92, v93
    v_max3_u32 v111, v111, v94, v95
    v_max_u32 v111, v111, v110
    v_cmp_eq_u32 vcc, -1, v111
    s_cbranch_vccnz L_mre_78
L_bar1_f0:
    s_cmp_eq_u32 s14, 63
    s_waitcnt lgkmcnt(0)
    s_barrier
    ds_read_b128 v[40:43], v13 offset:0
    ds_read_b128 v[44:47], v13 offset:1024
    ds_read_b128 v[48:51], v13 offset:2048
    ds_read_b128 v[52:55], v13 offset:3072
    s_cbranch_scc1 L_last_f0
    buffer_store_dwordx2 v[106:107], v0, s[68:71], s29 offen sc1
    s_waitcnt lgkmcnt(3)
    v_smfmac_f32_16x16x64_bf16 v[16:19], v[40:43], a[0:7], v2
    buffer_load_dwordx4 v1, s[68:71], s26 offen offset:0 sc1 lds
    v_smfmac_f32_16x16x64_bf16 v[20:23], v[40:43], a[64:71], v2
    ds_read_b128 v[40:43], v13 offset:8192
    s_waitcnt lgkmcnt(3)
    v_smfmac_f32_16x16x64_bf16 v[16:19], v[44:47], a[8:15], v2
    v_smfmac_f32_16x16x64_bf16 v[20:23], v[44:47], a[72:79], v2
    ds_read_b128 v[44:47], v13 offset:9216
    s_waitcnt lgkmcnt(3)
    v_smfmac_f32_16x16x64_bf16 v[16:19], v[48:51], a[16:23], v2
    buffer_load_dwordx4 v1, s[68:71], s26 offen offset:1024 sc1 lds
    v_smfmac_f32_16x16x64_bf16 v[20:23], v[48:51], a[80:87], v2
    ds_read_b128 v[48:51], v13 offset:10240
    s_waitcnt lgkmcnt(3)
    v_smfmac_f32_16x16x64_bf16 v[16:19], v[52:55], a[24:31], v2
    s_waitcnt vmcnt(3)
    s_nop 0
    ds_read_b128 v[24:27], v5 offset:0
    v_smfmac_f32_16x16x64_bf16 v[20:23], v[52:55], a[88:95], v2
    ds_read_b128 v[28:31], v12 offset:512
    s_waitcnt lgkmcnt(4)
    v_smfmac_f32_16x16x64_bf16 v[16:19], v[40:43], a[32:39], v2
    buffer_load_dwordx4 v1, s[68:71], s26 offen offset:2048 sc1 lds
    ds_read_b128 v[88:91], v7 offset:32768
    v_smfmac_f32_16x16x64_bf16 v[20:23], v[40:43], a[96:103], v2
    ds_read_b128 v[92:95], v7 offset:33792
    v_smfmac_f32_16x16x64_bf16 v[32:35], v[40:43], v[56:63], v2
    ds_read_b128 v[52:55], v13 offset:11264
    v_smfmac_f32_16x16x64_bf16 v[36:39], v[40:43], v[64:71], v2
    s_waitcnt lgkmcnt(3)
    buffer_store_dwordx4 v[28:31], v1, s[68:71], s84 offen
    v_smfmac_f32_16x16x64_bf16 v[16:19], v[44:47], a[40:47], v2
    buffer_load_dwordx4 v1, s[68:71], s26 offen offset:3072 sc1 lds
    ds_read_b128 v[96:99], v7 offset:34816
    v_smfmac_f32_16x16x64_bf16 v[20:23], v[44:47], a[104:111], v2
    ds_read_b128 v[56:59], v7 offset:36864
    v_smfmac_f32_16x16x64_bf16 v[32:35], v[44:47], v[72:79], v2
    ds_read_b128 v[100:103], v7 offset:35840
    v_smfmac_f32_16x16x64_bf16 v[36:39], v[44:47], v[80:87], v2
    buffer_store_dwordx4 v[24:27], v1, s[68:71], s28 offen sc1
    s_nop 1
    ds_read_b128 v[24:27], v12 offset:256
    v_smfmac_f32_16x16x64_bf16 v[16:19], v[48:51], a[48:55], v2
    ds_read_b128 v[60:63], v7 offset:37888
    buffer_store_dwordx4 v[28:31], v1, s[68:71], s84 offen offset:1024
    s_nop 1
    ds_read_b128 v[28:31], v12 offset:256
    v_smfmac_f32_16x16x64_bf16 v[20:23], v[48:51], a[112:119], v2
    ds_read_b128 v[64:67], v7 offset:38912
    s_waitcnt lgkmcnt(7)
    v_smfmac_f32_16x16x64_bf16 v[16:19], v[52:55], a[56:63], v2
    ds_read_b128 v[68:71], v7 offset:39936
    v_smfmac_f32_16x16x64_bf16 v[20:23], v[52:55], a[120:127], v2
    ds_read_b128 v[72:75], v15 offset:0
    s_waitcnt lgkmcnt(3)
    v_smfmac_f32_16x16x64_bf16 v[24:27], v[40:43], a[160:167], v2
    ds_read_b128 v[76:79], v15 offset:1024
    v_smfmac_f32_16x16x64_bf16 v[28:31], v[40:43], a[224:231], v2
    ds_read_b128 v[40:43], v13 offset:0
    v_add_f32 v16, v16, v18
    v_smfmac_f32_16x16x64_bf16 v[24:27], v[44:47], a[168:175], v2
    ds_read_b128 v[80:83], v15 offset:2048
    v_add_f32 v20, v20, v22
    v_smfmac_f32_16x16x64_bf16 v[28:31], v[44:47], a[232:239], v2
    ds_read_b128 v[44:47], v13 offset:1024
    v_add_f32 v17, v17, v19
    v_smfmac_f32_16x16x64_bf16 v[24:27], v[48:51], a[176:183], v2
    ds_read_b128 v[84:87], v15 offset:3072
    v_add_f32 v21, v21, v23
    v_smfmac_f32_16x16x64_bf16 v[28:31], v[48:51], a[240:247], v2
    v_mul_f32 v16, s31, v16
    v_smfmac_f32_16x16x64_bf16 v[32:35], v[48:51], v[88:95], v2
    v_mul_f32 v20, s31, v20
    v_smfmac_f32_16x16x64_bf16 v[36:39], v[48:51], v[96:103], v2
    ds_read_b128 v[88:91], v15 offset:4096
    v_cvt_pk_bf16_f32 v16, v16, v20
    v_smfmac_f32_16x16x64_bf16 v[24:27], v[52:55], a[184:191], v2
    ds_read_b128 v[48:51], v13 offset:2048
    v_mul_f32 v17, s31, v17
    v_smfmac_f32_16x16x64_bf16 v[28:31], v[52:55], a[248:255], v2
    ds_read_b128 v[92:95], v15 offset:5120
    v_mul_f32 v21, s31, v21
    v_smfmac_f32_16x16x64_bf16 v[32:35], v[52:55], v[56:63], v2
    ds_read_b128 v[96:99], v15 offset:6144
    s_waitcnt lgkmcnt(4)
    v_cvt_pk_bf16_f32 v17, v17, v21
    v_smfmac_f32_16x16x64_bf16 v[36:39], v[52:55], v[64:71], v2
    ds_write2_b32 v3, v16, v17 offset0:0 offset1:72
    ds_read_b128 v[52:55], v13 offset:3072
    v_smfmac_f32_16x16x64_bf16 v[24:27], v[40:43], a[128:135], v2
    ds_read_b128 v[100:103], v15 offset:7168
    v_smfmac_f32_16x16x64_bf16 v[28:31], v[40:43], a[192:199], v2
    v_smfmac_f32_16x16x64_bf16 v[24:27], v[44:47], a[136:143], v2
    s_waitcnt lgkmcnt(2)
    s_barrier
    ds_read_b128 v[56:59], v4 offset:0
    v_smfmac_f32_16x16x64_bf16 v[28:31], v[44:47], a[200:207], v2
    ds_read_b128 v[60:63], v4 offset:64
    v_smfmac_f32_16x16x64_bf16 v[24:27], v[48:51], a[144:151], v2
    ds_read_b128 v[64:67], v4 offset:128
    v_smfmac_f32_16x16x64_bf16 v[28:31], v[48:51], a[208:215], v2
    ds_read_b128 v[68:71], v4 offset:192
    s_waitcnt lgkmcnt(5)
    v_smfmac_f32_16x16x64_bf16 v[24:27], v[52:55], a[152:159], v2
    v_smfmac_f32_16x16x64_bf16 v[28:31], v[52:55], a[216:223], v2
    v_smfmac_f32_16x16x64_bf16 v[32:35], v[40:43], v[128:135], v2
    s_waitcnt lgkmcnt(3)
    v_mfma_f32_16x16x32_bf16 v[16:19], v[72:75], v[56:59], 0
    s_waitcnt lgkmcnt(2)
    v_add_f32 v24, v24, v26
    v_add_f32 v28, v28, v30
    v_mfma_f32_16x16x32_bf16 v[16:19], v[76:79], v[60:63], v[16:19]
    s_waitcnt lgkmcnt(1)
    v_add_f32 v25, v25, v27
    v_add_f32 v29, v29, v31
    v_mfma_f32_16x16x32_bf16 v[16:19], v[80:83], v[64:67], v[16:19]
    s_waitcnt lgkmcnt(0)
    v_cvt_pk_bf16_f32 v24, v24, v28
    v_cvt_pk_bf16_f32 v25, v25, v29
    v_mfma_f32_16x16x32_bf16 v[16:19], v[84:87], v[68:71], v[16:19]
    ds_write2_b32 v14, v24, v25 offset0:0 offset1:72
    v_mfma_f32_16x16x32_bf16 v[20:23], v[88:91], v[56:59], 0
    v_mfma_f32_16x16x32_bf16 v[20:23], v[92:95], v[60:63], v[20:23]
    v_exp_f32 v16, v16
    v_mfma_f32_16x16x32_bf16 v[20:23], v[96:99], v[64:67], v[20:23]
    s_waitcnt lgkmcnt(0)
    s_barrier
    ds_read_b128 v[72:75], v5 offset:0
    ds_read_b128 v[76:79], v5 offset:64
    ds_read_b128 v[80:83], v5 offset:128
    ds_read_b128 v[84:87], v5 offset:192
    v_exp_f32 v17, v17
    v_mfma_f32_16x16x32_bf16 v[20:23], v[100:103], v[68:71], v[20:23]
    ds_read_b128 v[88:91], v15 offset:8192
    v_exp_f32 v18, v18
    v_smfmac_f32_16x16x64_bf16 v[36:39], v[40:43], v[136:143], v2
    ds_read_b128 v[92:95], v15 offset:9216
    v_exp_f32 v19, v19
    v_smfmac_f32_16x16x64_bf16 v[32:35], v[44:47], v[144:151], v2
    ds_read_b128 v[100:103], v12 offset:0
    v_exp_f32 v20, v20
    v_smfmac_f32_16x16x64_bf16 v[36:39], v[44:47], v[152:159], v2
    v_exp_f32 v21, v21
    v_smfmac_f32_16x16x64_bf16 v[32:35], v[48:51], v[160:167], v2
    v_exp_f32 v22, v22
    v_smfmac_f32_16x16x64_bf16 v[36:39], v[48:51], v[168:175], v2
    v_exp_f32 v23, v23
    v_smfmac_f32_16x16x64_bf16 v[32:35], v[52:55], v[176:183], v2
    v_cvt_pk_bf16_f32 v16, v16, v17
    v_smfmac_f32_16x16x64_bf16 v[36:39], v[52:55], v[184:191], v2
    ds_read_b128 v[40:43], v12 offset:256
    s_waitcnt lgkmcnt(1)
    v_cvt_pk_bf16_f32 v17, v18, v19
    v_mfma_f32_16x16x32_bf16 v[96:99], v[72:75], v[56:59], 0
    v_cvt_pk_bf16_f32 v18, v20, v21
    v_cvt_pk_bf16_f32 v19, v22, v23
    v_mfma_f32_16x16x32_bf16 v[96:99], v[76:79], v[60:63], v[96:99]
    v_add_f32 v32, v32, v34
    v_add_f32 v33, v33, v35
    v_mfma_f32_16x16x32_bf16 v[96:99], v[80:83], v[64:67], v[96:99]
    v_cvt_pk_bf16_f32 v106, v32, v33
    v_add_f32 v36, v36, v38
    v_mfma_f32_16x16x32_bf16 v[96:99], v[84:87], v[68:71], v[96:99]
    v_add_f32 v37, v37, v39
    v_cvt_pk_bf16_f32 v107, v36, v37
    v_mfma_f32_16x16x32_bf16 v[20:23], v[100:103], v[16:19], 0
    ds_read_b128 v[44:47], v12 offset:256
    v_mfma_f32_16x16x32_bf16 v[24:27], v[88:91], v[16:19], 0
    v_exp_f32 v96, v96
    v_exp_f32 v97, v97
    v_mfma_f32_16x16x32_bf16 v[28:31], v[92:95], v[16:19], 0
    ds_read_b128 v[48:51], v12 offset:256
    v_cvt_pk_bf16_f32 v104, v96, v97
    v_cvt_pk_bf16_f32 v109, v96, v97
    s_nop 0
    v_mfma_f32_16x16x16_bf16 v[20:23], v[100:101], v[104:105], v[20:23]
    ds_read_b128 v[52:55], v12 offset:256
    v_mfma_f32_16x16x16_bf16 v[24:27], v[106:107], v[104:105], v[24:27]
    ds_read_b128 v[72:75], v8 offset:0
    v_mfma_f32_16x16x16_bf16 v[28:31], v[106:107], v[108:109], v[28:31]
    ds_read_b128 v[76:79], v8 offset:1024
    v_rcp_f32 v110, v20
    s_nop 0
    v_max_f32 v21, v20, v110
    v_cmp_ngt_f32 vcc, s32, v21
L_smback_80:
    v_pk_mul_f32 v[24:25], v[24:25], v[110:111] op_sel_hi:[1,0]
    v_pk_mul_f32 v[26:27], v[26:27], v[110:111] op_sel_hi:[1,0]
    v_pk_mul_f32 v[28:29], v[28:29], v[110:111] op_sel_hi:[1,0]
    v_pk_mul_f32 v[30:31], v[30:31], v[110:111] op_sel_hi:[1,0]
    s_mov_b64 exec, s[88:89]
    v_cvt_pk_bf16_f32 v24, v24, v25
    v_cvt_pk_bf16_f32 v25, v26, v27
    v_cvt_pk_bf16_f32 v26, v28, v29
    v_cvt_pk_bf16_f32 v27, v30, v31
    ds_write_b128 v6, v[24:27]
    s_mov_b64 exec, -1
    s_cbranch_vccnz L_slowsm_79
    ds_read_b128 v[80:83], v8 offset:4096
    ds_read_b128 v[84:87], v8 offset:5120
    s_waitcnt lgkmcnt(2)
    s_barrier
    ds_read_b128 v[24:27], v13 offset:16384
    ds_read_b128 v[28:31], v13 offset:17408
    ds_read_b128 v[56:59], v12 offset:256
    ds_read_b128 v[60:63], v12 offset:256
    ds_read_b128 v[88:91], v8 offset:2048
    s_waitcnt lgkmcnt(4)
    v_smfmac_f32_16x16x64_bf16 v[40:43], v[24:27], v[192:199], v2
    ds_read_b128 v[92:95], v8 offset:3072
    v_smfmac_f32_16x16x64_bf16 v[44:47], v[24:27], v[208:215], v2
    ds_read_b128 v[96:99], v8 offset:6144
    s_waitcnt lgkmcnt(5)
    v_smfmac_f32_16x16x64_bf16 v[40:43], v[28:31], v[200:207], v2
    ds_read_b128 v[100:103], v8 offset:7168
    s_mov_b32 s11, s24
    v_smfmac_f32_16x16x64_bf16 v[44:47], v[28:31], v[216:223], v2
    ds_read_b128 v[64:67], v12 offset:256
    s_mov_b32 s12, s23
    v_smfmac_f32_16x16x64_bf16 v[48:51], v[24:27], v[224:231], v2
    ds_read_b128 v[68:71], v12 offset:256
    v_add_f32 v40, v40, v42
    v_add_f32 v41, v41, v43
    v_smfmac_f32_16x16x64_bf16 v[52:55], v[24:27], v[240:247], v2
    ds_read_b128 v[32:35], v8 offset:32768
    v_add_f32 v44, v44, v46
    v_smfmac_f32_16x16x64_bf16 v[48:51], v[28:31], v[232:239], v2
    ds_read_b128 v[36:39], v8 offset:33792
    v_add_f32 v45, v45, v47
    v_smfmac_f32_16x16x64_bf16 v[52:55], v[28:31], v[248:255], v2
    ds_read_b128 v[16:19], v8 offset:34816
    s_waitcnt lgkmcnt(9)
    v_cvt_pk_bf16_f32 v40, v40, v44
    v_smfmac_f32_16x16x64_bf16 v[56:59], v[24:27], v[72:79], v2
    ds_read_b128 v[20:23], v8 offset:35840
    v_cvt_pk_bf16_f32 v41, v41, v45
    v_add_f32 v48, v48, v50
    v_add_f32 v49, v49, v51
    v_smfmac_f32_16x16x64_bf16 v[60:63], v[24:27], v[80:87], v2
    s_waitcnt lgkmcnt(8)
    v_add_f32 v52, v52, v54
    v_add_f32 v53, v53, v55
    v_smfmac_f32_16x16x64_bf16 v[56:59], v[28:31], v[88:95], v2
    v_cvt_pk_bf16_f32 v42, v48, v52
    v_cvt_pk_bf16_f32 v43, v49, v53
    buffer_store_dwordx4 v[40:43], v9, s[68:71], s85 offen
    s_waitcnt lgkmcnt(6)
    v_smfmac_f32_16x16x64_bf16 v[60:63], v[28:31], v[96:103], v2
    s_mov_b32 s13, s22
    s_mov_b32 s15, 1048576
    s_waitcnt lgkmcnt(4)
    v_smfmac_f32_16x16x64_bf16 v[64:67], v[24:27], v[112:119], v2
    s_waitcnt lgkmcnt(2)
    v_add_f32 v56, v56, v58
    v_add_f32 v57, v57, v59
    v_smfmac_f32_16x16x64_bf16 v[64:67], v[28:31], v[32:39], v2
    ds_read_b128 v[88:91], v13 offset:26880
    v_add_f32 v60, v60, v62
    v_smfmac_f32_16x16x64_bf16 v[68:71], v[24:27], v[120:127], v2
    s_mov_b32 s10, s27
    s_waitcnt lgkmcnt(1)
    v_add_f32 v61, v61, v63
    v_smfmac_f32_16x16x64_bf16 v[68:71], v[28:31], v[16:23], v2
    v_cvt_pk_bf16_f32 v56, v56, v60
    v_cvt_pk_bf16_f32 v57, v57, v61
    v_pk_add_f32 v[64:65], v[64:65], v[66:67]
    s_nop 2
    v_pk_add_f32 v[68:69], v[68:69], v[70:71]
    v_cvt_pk_bf16_f32 v58, v64, v68
    v_cvt_pk_bf16_f32 v59, v65, v69
    buffer_store_dwordx4 v[56:59], v9, s[68:71], s86 offen
    s_nop 1
    ds_read_b128 v[56:59], v7 offset:0
    ds_read_b128 v[60:63], v7 offset:1024
    ds_read_b128 v[64:67], v7 offset:2048
    ds_read_b128 v[68:71], v7 offset:3072
    ds_read_b128 v[72:75], v7 offset:4096
    ds_read_b128 v[76:79], v7 offset:5120
    ds_read_b128 v[80:83], v7 offset:6144
    ds_read_b128 v[84:87], v7 offset:7168
    ds_read_b128 v[16:19], v12 offset:256
    ds_read_b128 v[20:23], v12 offset:256
    ds_read_b128 v[32:35], v12 offset:256
    ds_read_b128 v[36:39], v12 offset:256
    s_mov_b32 s7, s23
    s_mov_b32 s23, s24
    s_mov_b32 s24, s25
    s_mov_b32 s25, s7
    s_add_u32 s17, s23, s16
    s_add_u32 s21, s21, 1
    s_mov_b32 s87, 262144
    s_cmp_eq_u32 s21, 3
    s_cselect_b32 s87, 0xfff80000, s87
    s_cselect_b32 s21, 0, s21
    s_add_u32 s85, s85, s87
    s_add_u32 s86, s86, s87
    s_add_u32 s22, s22, s87
    s_add_u32 s84, s84, s90
    s_mov_b32 s90, s87
    s_add_u32 s14, s14, 1
    s_mov_b32 s28, s18
    s_mov_b32 s29, s19
    s_add_u32 s18, s18, 131072
    s_add_u32 s19, s19, 65536
    s_mov_b32 s30, s20
    s_mov_b32 s20, s33
    s_add_u32 s33, s33, 128
    v_mov_b32 v104, 1
    s_add_u32 s27, s27, 128
    s_xor_b32 s91, s91, 16384
    s_add_u32 s26, s26, 262144
    s_mov_b32 m0, s91
    buffer_load_dwordx4 v[40:43], v1, s[68:71], s13 offen sc1
    buffer_load_dwordx4 v[44:47], v1, s[68:71], s13 offen offset:1024 sc1
    s_nop 7
    s_nop 7
    v_xor_b32 v15, 0x4000, v15
    s_nop 7
    s_nop 7
    v_mov_b32 v111, -1
    s_waitcnt lgkmcnt(12)
L_ra_81:
    buffer_load_dwordx4 v[48:51], v1, s[68:71], s13 offen sc1
    buffer_load_dwordx4 v[52:55], v1, s[68:71], s13 offen offset:1024 sc1
    s_waitcnt vmcnt(3)
    v_mfma_f32_16x16x32_bf16 v[92:95], v[88:91], v[40:43], 0
    s_waitcnt vmcnt(2)
    v_mfma_f32_16x16x32_bf16 v[92:95], v[88:91], v[44:47], v[92:95]
    s_nop 7
    v_cmp_u_f32 vcc, v92, v93
    v_add_f32_dpp v92, v92, v92 row_ror:4 row_mask:0xf bank_mask:0xf
    v_add_f32_dpp v93, v93, v93 row_ror:4 row_mask:0xf bank_mask:0xf
    s_cbranch_vccz L_rdone_83
    buffer_load_dwordx4 v[40:43], v1, s[68:71], s13 offen sc1
    buffer_load_dwordx4 v[44:47], v1, s[68:71], s13 offen offset:1024 sc1
    s_waitcnt vmcnt(3)
    v_mfma_f32_16x16x32_bf16 v[92:95], v[88:91], v[48:51], 0
    s_waitcnt vmcnt(2)
    v_mfma_f32_16x16x32_bf16 v[92:95], v[88:91], v[52:55], v[92:95]
    s_nop 7
    v_cmp_u_f32 vcc, v92, v93
    v_add_f32_dpp v92, v92, v92 row_ror:4 row_mask:0xf bank_mask:0xf
    v_add_f32_dpp v93, v93, v93 row_ror:4 row_mask:0xf bank_mask:0xf
    s_cbranch_vccnz L_rslow_82
L_rdone_83:
    v_add_f32_dpp v92, v92, v92 row_ror:8 row_mask:0xf bank_mask:0xf
    v_add_f32_dpp v93, v93, v93 row_ror:8 row_mask:0xf bank_mask:0xf
    v_cvt_pk_bf16_f32 v110, v92, v93
    v_min_u32 v110, 0xfffffffe, v110
    buffer_store_dword v110, v10, s[68:71], s11 offen
    buffer_store_dword v111, v10, s[68:71], s12 offen
L_kvok_84:
    s_mov_b32 s15, 1048576
    s_nop 7
    s_nop 7
    s_nop 7
    s_nop 7
    s_nop 7
    s_nop 7
    buffer_load_dwordx4 v[24:27], v1, s[68:71], s17 offen offset:0 sc1
    buffer_load_dwordx4 v[28:31], v1, s[68:71], s17 offen offset:1024 sc1
    s_nop 7
    s_nop 7
    s_nop 7
    s_nop 7
    s_branch L_chk_f0
L_mre_78:
    s_sub_u32 s15, s15, 1
    s_cmp_lg_u32 s15, 0
    s_cbranch_scc1 L_chk_f0
    s_branch L_err_8
L_rslow_82:
    s_sub_u32 s15, s15, 1
    s_cmp_eq_u32 s15, 0
    s_cbranch_scc1 L_err_10
    s_and_b32 s7, s15, 3
    s_cmp_lg_u32 s7, 0
    s_cbranch_scc1 L_ra_81
    s_mov_b64 s[98:99], 0
    v_mov_b32 v110, 0xffbfffbf
    v_cmp_eq_u32 vcc, v110, v48
    s_nop 0
    s_or_b64 s[98:99], s[98:99], vcc
    v_cmp_eq_u32 vcc, v110, v49
    s_nop 0
    s_or_b64 s[98:99], s[98:99], vcc
    v_cmp_eq_u32 vcc, v110, v50
    s_nop 0
    s_or_b64 s[98:99], s[98:99], vcc
    v_cmp_eq_u32 vcc, v110, v51
    s_nop 0
    s_or_b64 s[98:99], s[98:99], vcc
    v_cmp_eq_u32 vcc, v110, v52
    s_nop 0
    s_or_b64 s[98:99], s[98:99], vcc
    v_cmp_eq_u32 vcc, v110, v53
    s_nop 0
    s_or_b64 s[98:99], s[98:99], vcc
    v_cmp_eq_u32 vcc, v110, v54
    s_nop 0
    s_or_b64 s[98:99], s[98:99], vcc
    v_cmp_eq_u32 vcc, v110, v55
    s_nop 0
    s_or_b64 s[98:99], s[98:99], vcc
    s_cmp_eq_u64 s[98:99], 0
    s_cbranch_scc1 L_rdone_83
    s_branch L_ra_81
L_slowsm_79:
    s_waitcnt lgkmcnt(0)
    ds_read_b128 v[72:75], v15 offset:0
    ds_read_b128 v[88:91], v15 offset:4096
    ds_read_b128 v[76:79], v15 offset:1024
    ds_read_b128 v[92:95], v15 offset:5120
    ds_read_b128 v[80:83], v15 offset:2048
    ds_read_b128 v[96:99], v15 offset:6144
    ds_read_b128 v[84:87], v15 offset:3072
    ds_read_b128 v[100:103], v15 offset:7168
    s_waitcnt lgkmcnt(0)
    v_mfma_f32_16x16x32_bf16 v[16:19], v[72:75], v[56:59], 0
    v_mfma_f32_16x16x32_bf16 v[16:19], v[76:79], v[60:63], v[16:19]
    v_mfma_f32_16x16x32_bf16 v[16:19], v[80:83], v[64:67], v[16:19]
    v_mfma_f32_16x16x32_bf16 v[16:19], v[84:87], v[68:71], v[16:19]
    v_mfma_f32_16x16x32_bf16 v[20:23], v[88:91], v[56:59], 0
    v_mfma_f32_16x16x32_bf16 v[20:23], v[92:95], v[60:63], v[20:23]
    v_mfma_f32_16x16x32_bf16 v[20:23], v[96:99], v[64:67], v[20:23]
    v_mfma_f32_16x16x32_bf16 v[20:23], v[100:103], v[68:71], v[20:23]
    ds_read_b128 v[72:75], v5 offset:0
    ds_read_b128 v[76:79], v5 offset:64
    ds_read_b128 v[80:83], v5 offset:128
    ds_read_b128 v[84:87], v5 offset:192
    ds_read_b128 v[88:91], v15 offset:8192
    ds_read_b128 v[92:95], v15 offset:9216
    ds_read_b128 v[100:103], v12 offset:0
    s_waitcnt lgkmcnt(0)
    v_mfma_f32_16x16x32_bf16 v[96:99], v[72:75], v[56:59], 0
    v_mfma_f32_16x16x32_bf16 v[96:99], v[76:79], v[60:63], v[96:99]
    v_mfma_f32_16x16x32_bf16 v[96:99], v[80:83], v[64:67], v[96:99]
    v_mfma_f32_16x16x32_bf16 v[96:99], v[84:87], v[68:71], v[96:99]
    v_max3_f32 v110, v16, v17, v18
    v_max3_f32 v110, v110, v19, v20
    v_max3_f32 v110, v110, v21, v22
    v_max_f32 v110, v110, v23
    s_nop 2
    v_max3_f32 v110, v110, v96, v97
    v_mov_b32 v98, v110
    s_nop 1
    v_permlane16_swap_b32 v110, v98
    v_max_f32 v110, v110, v98
    v_mov_b32 v98, v110
    s_nop 1
    v_permlane32_swap_b32 v110, v98
    v_max_f32 v110, v110, v98
    v_sub_f32 v16, v16, v110
    v_exp_f32 v16, v16
    v_sub_f32 v17, v17, v110
    v_exp_f32 v17, v17
    v_sub_f32 v18, v18, v110
    v_exp_f32 v18, v18
    v_sub_f32 v19, v19, v110
    v_exp_f32 v19, v19
    v_sub_f32 v20, v20, v110
    v_exp_f32 v20, v20
    v_sub_f32 v21, v21, v110
    v_exp_f32 v21, v21
    v_sub_f32 v22, v22, v110
    v_exp_f32 v22, v22
    v_sub_f32 v23, v23, v110
    v_exp_f32 v23, v23
    v_sub_f32 v96, v96, v110
    v_exp_f32 v96, v96
    v_sub_f32 v97, v97, v110
    v_exp_f32 v97, v97
    v_cvt_pk_bf16_f32 v16, v16, v17
    v_cvt_pk_bf16_f32 v17, v18, v19
    v_cvt_pk_bf16_f32 v18, v20, v21
    v_cvt_pk_bf16_f32 v19, v22, v23
    v_cvt_pk_bf16_f32 v104, v96, v97
    v_cvt_pk_bf16_f32 v109, v96, v97
    v_mfma_f32_16x16x32_bf16 v[20:23], v[100:103], v[16:19], 0
    v_mfma_f32_16x16x32_bf16 v[24:27], v[88:91], v[16:19], 0
    v_mfma_f32_16x16x32_bf16 v[28:31], v[92:95], v[16:19], 0
    v_mfma_f32_16x16x16_bf16 v[20:23], v[100:101], v[104:105], v[20:23]
    v_mfma_f32_16x16x16_bf16 v[24:27], v[106:107], v[104:105], v[24:27]
    v_mfma_f32_16x16x16_bf16 v[28:31], v[106:107], v[108:109], v[28:31]
    ds_read_b128 v[72:75], v8 offset:0
    ds_read_b128 v[76:79], v8 offset:1024
    ds_read_b128 v[80:83], v8 offset:4096
    ds_read_b128 v[84:87], v8 offset:5120
    ds_read_b128 v[88:91], v8 offset:2048
    ds_read_b128 v[92:95], v8 offset:3072
    ds_read_b128 v[96:99], v8 offset:6144
    ds_read_b128 v[100:103], v8 offset:7168
    v_rcp_f32 v110, v20
    s_waitcnt lgkmcnt(0)
    s_mov_b64 vcc, 0
    s_nop 7
    s_branch L_smback_80
L_last_f0:
    buffer_store_dwordx2 v[106:107], v0, s[68:71], s29 offen sc1
    ds_read_b128 v[16:19], v5 offset:0
    s_waitcnt vmcnt(1)
    ds_read_b128 v[88:91], v7 offset:32768
    ds_read_b128 v[92:95], v7 offset:33792
    ds_read_b128 v[96:99], v7 offset:34816
    ds_read_b128 v[100:103], v7 offset:35840
    ds_read_b128 v[24:27], v12 offset:256
    ds_read_b128 v[28:31], v12 offset:256
    s_waitcnt lgkmcnt(0)
    buffer_store_dwordx4 v[16:19], v1, s[68:71], s28 offen sc1
    s_barrier
    v_smfmac_f32_16x16x64_bf16 v[24:27], v[40:43], a[128:135], v2
    v_smfmac_f32_16x16x64_bf16 v[28:31], v[40:43], a[192:199], v2
    v_smfmac_f32_16x16x64_bf16 v[32:35], v[40:43], v[128:135], v2
    v_smfmac_f32_16x16x64_bf16 v[36:39], v[40:43], v[136:143], v2
    ds_read_b128 v[40:43], v13 offset:8192
    v_smfmac_f32_16x16x64_bf16 v[24:27], v[44:47], a[136:143], v2
    v_smfmac_f32_16x16x64_bf16 v[28:31], v[44:47], a[200:207], v2
    v_smfmac_f32_16x16x64_bf16 v[32:35], v[44:47], v[144:151], v2
    v_smfmac_f32_16x16x64_bf16 v[36:39], v[44:47], v[152:159], v2
    ds_read_b128 v[44:47], v13 offset:9216
    v_smfmac_f32_16x16x64_bf16 v[24:27], v[48:51], a[144:151], v2
    v_smfmac_f32_16x16x64_bf16 v[28:31], v[48:51], a[208:215], v2
    v_smfmac_f32_16x16x64_bf16 v[32:35], v[48:51], v[160:167], v2
    v_smfmac_f32_16x16x64_bf16 v[36:39], v[48:51], v[168:175], v2
    ds_read_b128 v[48:51], v13 offset:10240
    v_smfmac_f32_16x16x64_bf16 v[24:27], v[52:55], a[152:159], v2
    v_smfmac_f32_16x16x64_bf16 v[28:31], v[52:55], a[216:223], v2
    v_smfmac_f32_16x16x64_bf16 v[32:35], v[52:55], v[176:183], v2
    v_smfmac_f32_16x16x64_bf16 v[36:39], v[52:55], v[184:191], v2
    ds_read_b128 v[52:55], v13 offset:11264
    s_waitcnt lgkmcnt(3)
    v_smfmac_f32_16x16x64_bf16 v[24:27], v[40:43], a[160:167], v2
    v_smfmac_f32_16x16x64_bf16 v[28:31], v[40:43], a[224:231], v2
    v_smfmac_f32_16x16x64_bf16 v[32:35], v[40:43], v[56:63], v2
    v_smfmac_f32_16x16x64_bf16 v[36:39], v[40:43], v[64:71], v2
    ds_read_b128 v[56:59], v7 offset:36864
    ds_read_b128 v[60:63], v7 offset:37888
    ds_read_b128 v[64:67], v7 offset:38912
    ds_read_b128 v[68:71], v7 offset:39936
    s_waitcnt lgkmcnt(6)
    v_smfmac_f32_16x16x64_bf16 v[24:27], v[44:47], a[168:175], v2
    v_smfmac_f32_16x16x64_bf16 v[28:31], v[44:47], a[232:239], v2
    v_smfmac_f32_16x16x64_bf16 v[32:35], v[44:47], v[72:79], v2
    v_smfmac_f32_16x16x64_bf16 v[36:39], v[44:47], v[80:87], v2
    s_waitcnt lgkmcnt(5)
    v_smfmac_f32_16x16x64_bf16 v[24:27], v[48:51], a[176:183], v2
    v_smfmac_f32_16x16x64_bf16 v[28:31], v[48:51], a[240:247], v2
    v_smfmac_f32_16x16x64_bf16 v[32:35], v[48:51], v[88:95], v2
    v_smfmac_f32_16x16x64_bf16 v[36:39], v[48:51], v[96:103], v2
    s_waitcnt lgkmcnt(4)
    v_smfmac_f32_16x16x64_bf16 v[24:27], v[52:55], a[184:191], v2
    v_smfmac_f32_16x16x64_bf16 v[28:31], v[52:55], a[248:255], v2
    s_waitcnt lgkmcnt(2)
    v_smfmac_f32_16x16x64_bf16 v[32:35], v[52:55], v[56:63], v2
    s_waitcnt lgkmcnt(0)
    v_smfmac_f32_16x16x64_bf16 v[36:39], v[52:55], v[64:71], v2
    v_add_f32 v24, v24, v26
    v_add_f32 v28, v28, v30
    v_add_f32 v25, v25, v27
    v_add_f32 v29, v29, v31
    v_cvt_pk_bf16_f32 v24, v24, v28
    v_cvt_pk_bf16_f32 v25, v25, v29
    ds_write2_b32 v14, v24, v25 offset0:0 offset1:72
    v_add_f32 v32, v32, v34
    v_add_f32 v33, v33, v35
    v_cvt_pk_bf16_f32 v106, v32, v33
    v_add_f32 v36, v36, v38
    v_add_f32 v37, v37, v39
    v_cvt_pk_bf16_f32 v107, v36, v37
    buffer_store_dwordx2 v[106:107], v0, s[68:71], s19 offen sc1
    s_waitcnt lgkmcnt(0)
    s_barrier
    ds_read_b128 v[72:75], v5 offset:0
    s_waitcnt lgkmcnt(0)
    buffer_store_dwordx4 v[72:75], v1, s[68:71], s18 offen sc1
    s_waitcnt vmcnt(0)
    s_barrier
    s_endpgm
L_cl_1:
    ds_read_b128 v[56:59], v7 offset:0
    ds_read_b128 v[60:63], v7 offset:1024
    ds_read_b128 v[64:67], v7 offset:2048
    ds_read_b128 v[68:71], v7 offset:3072
    ds_read_b128 v[72:75], v7 offset:4096
    ds_read_b128 v[76:79], v7 offset:5120
    ds_read_b128 v[80:83], v7 offset:6144
    ds_read_b128 v[84:87], v7 offset:7168
    ds_read_b128 v[16:19], v12 offset:256
    ds_read_b128 v[20:23], v12 offset:256
    ds_read_b128 v[32:35], v12 offset:256
    ds_read_b128 v[36:39], v12 offset:256
    v_mov_b32 v104, 1
    s_mov_b32 m0, s91
    s_mov_b32 s15, 1048576
    buffer_load_dwordx4 v[24:27], v1, s[68:71], s17 offen offset:0 sc1
    buffer_load_dwordx4 v[28:31], v1, s[68:71], s17 offen offset:1024 sc1
L_chk_f1:
    buffer_load_dwordx4 v[88:91], v1, s[68:71], s17 offen offset:0 sc1
    buffer_load_dwordx4 v[92:95], v1, s[68:71], s17 offen offset:1024 sc1
    s_waitcnt vmcnt(2)
    ds_write_b128 v13, v[24:27] offset:2048
    ds_write_b128 v13, v[28:31] offset:3072
    v_max3_u32 v111, v24, v25, v26
    v_max3_u32 v110, v27, v28, v29
    v_max3_u32 v111, v111, v30, v31
    v_max_u32 v111, v111, v110
    v_cmp_eq_u32 vcc, -1, v111
    s_cbranch_vccz L_bar1_f1
    buffer_load_dwordx4 v[24:27], v1, s[68:71], s17 offen offset:0 sc1
    buffer_load_dwordx4 v[28:31], v1, s[68:71], s17 offen offset:1024 sc1
    s_waitcnt vmcnt(2)
    ds_write_b128 v13, v[88:91] offset:2048
    ds_write_b128 v13, v[92:95] offset:3072
    v_max3_u32 v111, v88, v89, v90
    v_max3_u32 v110, v91, v92, v93
    v_max3_u32 v111, v111, v94, v95
    v_max_u32 v111, v111, v110
    v_cmp_eq_u32 vcc, -1, v111
    s_cbranch_vccnz L_mre_86
L_bar1_f1:
    s_cmp_eq_u32 s14, 63
    s_waitcnt lgkmcnt(0)
    s_barrier
    ds_read_b128 v[40:43], v13 offset:0
    ds_read_b128 v[44:47], v13 offset:1024
    ds_read_b128 v[48:51], v13 offset:2048
    ds_read_b128 v[52:55], v13 offset:3072
    s_cbranch_scc1 L_last_f1
    buffer_store_dwordx2 v[106:107], v0, s[68:71], s29 offen sc1
    s_waitcnt lgkmcnt(3)
    v_smfmac_f32_16x16x64_bf16 v[16:19], v[40:43], a[0:7], v2
    v_smfmac_f32_16x16x64_bf16 v[20:23], v[40:43], a[64:71], v2
    buffer_load_dwordx4 v1, s[68:71], s26 offen offset:0 sc1 lds
    s_waitcnt lgkmcnt(2)
    v_smfmac_f32_16x16x64_bf16 v[16:19], v[44:47], a[8:15], v2
    ds_read_b128 v[40:43], v13 offset:8192
    v_smfmac_f32_16x16x64_bf16 v[20:23], v[44:47], a[72:79], v2
    buffer_load_dword v111, off, s[68:71], s27 sc1
    s_waitcnt lgkmcnt(2)
    v_smfmac_f32_16x16x64_bf16 v[16:19], v[48:51], a[16:23], v2
    ds_read_b128 v[44:47], v13 offset:9216
    v_smfmac_f32_16x16x64_bf16 v[20:23], v[48:51], a[80:87], v2
    buffer_load_dwordx4 v1, s[68:71], s26 offen offset:1024 sc1 lds
    s_waitcnt lgkmcnt(2)
    v_smfmac_f32_16x16x64_bf16 v[16:19], v[52:55], a[24:31], v2
    s_waitcnt vmcnt(4)
    s_nop 0
    ds_read_b128 v[24:27], v5 offset:64
    v_smfmac_f32_16x16x64_bf16 v[20:23], v[52:55], a[88:95], v2
    ds_read_b128 v[28:31], v12 offset:512
    s_waitcnt lgkmcnt(3)
    v_smfmac_f32_16x16x64_bf16 v[16:19], v[40:43], a[32:39], v2
    ds_read_b128 v[88:91], v7 offset:32768
    v_smfmac_f32_16x16x64_bf16 v[20:23], v[40:43], a[96:103], v2
    buffer_load_dwordx4 v1, s[68:71], s26 offen offset:2048 sc1 lds
    v_smfmac_f32_16x16x64_bf16 v[32:35], v[40:43], v[56:63], v2
    ds_read_b128 v[48:51], v13 offset:10240
    v_smfmac_f32_16x16x64_bf16 v[36:39], v[40:43], v[64:71], v2
    ds_read_b128 v[92:95], v7 offset:33792
    s_waitcnt lgkmcnt(5)
    v_smfmac_f32_16x16x64_bf16 v[16:19], v[44:47], a[40:47], v2
    ds_read_b128 v[52:55], v13 offset:11264
    s_waitcnt lgkmcnt(4)
    buffer_store_dwordx4 v[28:31], v1, s[68:71], s84 offen
    v_smfmac_f32_16x16x64_bf16 v[20:23], v[44:47], a[104:111], v2
    buffer_load_dwordx4 v1, s[68:71], s26 offen offset:3072 sc1 lds
    ds_read_b128 v[96:99], v7 offset:34816
    v_smfmac_f32_16x16x64_bf16 v[32:35], v[44:47], v[72:79], v2
    ds_read_b128 v[56:59], v7 offset:36864
    v_smfmac_f32_16x16x64_bf16 v[36:39], v[44:47], v[80:87], v2
    ds_read_b128 v[100:103], v7 offset:35840
    s_waitcnt lgkmcnt(5)
    v_smfmac_f32_16x16x64_bf16 v[16:19], v[48:51], a[48:55], v2
    ds_read_b128 v[60:63], v7 offset:37888
    buffer_store_dwordx4 v[24:27], v1, s[68:71], s28 offen sc1
    s_nop 1
    ds_read_b128 v[24:27], v12 offset:256
    v_smfmac_f32_16x16x64_bf16 v[20:23], v[48:51], a[112:119], v2
    ds_read_b128 v[64:67], v7 offset:38912
    s_waitcnt lgkmcnt(6)
    v_smfmac_f32_16x16x64_bf16 v[16:19], v[52:55], a[56:63], v2
    buffer_store_dwordx4 v[28:31], v1, s[68:71], s84 offen offset:1024
    s_nop 1
    ds_read_b128 v[28:31], v12 offset:256
    v_smfmac_f32_16x16x64_bf16 v[20:23], v[52:55], a[120:127], v2
    ds_read_b128 v[68:71], v7 offset:39936
    s_waitcnt lgkmcnt(1)
    v_smfmac_f32_16x16x64_bf16 v[24:27], v[40:43], a[160:167], v2
    ds_read_b128 v[72:75], v15 offset:0
    v_smfmac_f32_16x16x64_bf16 v[28:31], v[40:43], a[224:231], v2
    ds_read_b128 v[76:79], v15 offset:1024
    v_add_f32 v16, v16, v18
    v_smfmac_f32_16x16x64_bf16 v[24:27], v[44:47], a[168:175], v2
    ds_read_b128 v[40:43], v13 offset:0
    v_add_f32 v20, v20, v22
    v_smfmac_f32_16x16x64_bf16 v[28:31], v[44:47], a[232:239], v2
    ds_read_b128 v[80:83], v15 offset:2048
    v_add_f32 v17, v17, v19
    v_smfmac_f32_16x16x64_bf16 v[24:27], v[48:51], a[176:183], v2
    ds_read_b128 v[44:47], v13 offset:1024
    v_add_f32 v21, v21, v23
    v_smfmac_f32_16x16x64_bf16 v[28:31], v[48:51], a[240:247], v2
    ds_read_b128 v[84:87], v15 offset:3072
    v_mul_f32 v16, s31, v16
    v_smfmac_f32_16x16x64_bf16 v[32:35], v[48:51], v[88:95], v2
    v_mul_f32 v20, s31, v20
    v_smfmac_f32_16x16x64_bf16 v[36:39], v[48:51], v[96:103], v2
    ds_read_b128 v[88:91], v15 offset:4096
    v_cvt_pk_bf16_f32 v16, v16, v20
    v_smfmac_f32_16x16x64_bf16 v[24:27], v[52:55], a[184:191], v2
    ds_read_b128 v[48:51], v13 offset:2048
    v_mul_f32 v17, s31, v17
    v_smfmac_f32_16x16x64_bf16 v[28:31], v[52:55], a[248:255], v2
    ds_read_b128 v[92:95], v15 offset:5120
    v_mul_f32 v21, s31, v21
    v_smfmac_f32_16x16x64_bf16 v[32:35], v[52:55], v[56:63], v2
    ds_read_b128 v[96:99], v15 offset:6144
    s_waitcnt lgkmcnt(5)
    v_cvt_pk_bf16_f32 v17, v17, v21
    v_smfmac_f32_16x16x64_bf16 v[36:39], v[52:55], v[64:71], v2
    ds_write2_b32 v3, v16, v17 offset0:0 offset1:72
    ds_read_b128 v[52:55], v13 offset:3072
    v_smfmac_f32_16x16x64_bf16 v[24:27], v[40:43], a[128:135], v2
    ds_read_b128 v[100:103], v15 offset:7168
    v_smfmac_f32_16x16x64_bf16 v[28:31], v[40:43], a[192:199], v2
    v_smfmac_f32_16x16x64_bf16 v[24:27], v[44:47], a[136:143], v2
    s_waitcnt lgkmcnt(2)
    s_barrier
    ds_read_b128 v[56:59], v4 offset:0
    v_smfmac_f32_16x16x64_bf16 v[28:31], v[44:47], a[200:207], v2
    ds_read_b128 v[60:63], v4 offset:64
    v_smfmac_f32_16x16x64_bf16 v[24:27], v[48:51], a[144:151], v2
    ds_read_b128 v[64:67], v4 offset:128
    v_smfmac_f32_16x16x64_bf16 v[28:31], v[48:51], a[208:215], v2
    ds_read_b128 v[68:71], v4 offset:192
    s_waitcnt lgkmcnt(5)
    v_smfmac_f32_16x16x64_bf16 v[24:27], v[52:55], a[152:159], v2
    v_smfmac_f32_16x16x64_bf16 v[28:31], v[52:55], a[216:223], v2
    v_smfmac_f32_16x16x64_bf16 v[32:35], v[40:43], v[128:135], v2
    s_waitcnt lgkmcnt(3)
    v_mfma_f32_16x16x32_bf16 v[16:19], v[72:75], v[56:59], 0
    s_waitcnt lgkmcnt(2)
    v_add_f32 v24, v24, v26
    v_add_f32 v28, v28, v30
    v_mfma_f32_16x16x32_bf16 v[16:19], v[76:79], v[60:63], v[16:19]
    s_waitcnt lgkmcnt(1)
    v_add_f32 v25, v25, v27
    v_add_f32 v29, v29, v31
    v_mfma_f32_16x16x32_bf16 v[16:19], v[80:83], v[64:67], v[16:19]
    s_waitcnt lgkmcnt(0)
    v_cvt_pk_bf16_f32 v24, v24, v28
    v_cvt_pk_bf16_f32 v25, v25, v29
    v_mfma_f32_16x16x32_bf16 v[16:19], v[84:87], v[68:71], v[16:19]
    ds_write2_b32 v14, v24, v25 offset0:0 offset1:72
    v_mfma_f32_16x16x32_bf16 v[20:23], v[88:91], v[56:59], 0
    v_mfma_f32_16x16x32_bf16 v[20:23], v[92:95], v[60:63], v[20:23]
    v_exp_f32 v16, v16
    v_mfma_f32_16x16x32_bf16 v[20:23], v[96:99], v[64:67], v[20:23]
    s_waitcnt lgkmcnt(0)
    s_barrier
    ds_read_b128 v[72:75], v5 offset:0
    ds_read_b128 v[76:79], v5 offset:64
    ds_read_b128 v[80:83], v5 offset:128
    ds_read_b128 v[84:87], v5 offset:192
    v_exp_f32 v17, v17
    v_mfma_f32_16x16x32_bf16 v[20:23], v[100:103], v[68:71], v[20:23]
    ds_read_b128 v[88:91], v15 offset:10240
    v_exp_f32 v18, v18
    v_smfmac_f32_16x16x64_bf16 v[36:39], v[40:43], v[136:143], v2
    ds_read_b128 v[92:95], v15 offset:11264
    v_exp_f32 v19, v19
    v_smfmac_f32_16x16x64_bf16 v[32:35], v[44:47], v[144:151], v2
    ds_read_b128 v[100:103], v12 offset:0
    v_exp_f32 v20, v20
    v_smfmac_f32_16x16x64_bf16 v[36:39], v[44:47], v[152:159], v2
    v_exp_f32 v21, v21
    v_smfmac_f32_16x16x64_bf16 v[32:35], v[48:51], v[160:167], v2
    v_exp_f32 v22, v22
    v_smfmac_f32_16x16x64_bf16 v[36:39], v[48:51], v[168:175], v2
    v_exp_f32 v23, v23
    v_smfmac_f32_16x16x64_bf16 v[32:35], v[52:55], v[176:183], v2
    v_cvt_pk_bf16_f32 v16, v16, v17
    v_smfmac_f32_16x16x64_bf16 v[36:39], v[52:55], v[184:191], v2
    ds_read_b128 v[40:43], v12 offset:256
    s_waitcnt lgkmcnt(1)
    v_cvt_pk_bf16_f32 v17, v18, v19
    v_mfma_f32_16x16x32_bf16 v[96:99], v[72:75], v[56:59], 0
    v_cvt_pk_bf16_f32 v18, v20, v21
    v_cvt_pk_bf16_f32 v19, v22, v23
    v_mfma_f32_16x16x32_bf16 v[96:99], v[76:79], v[60:63], v[96:99]
    v_add_f32 v32, v32, v34
    v_add_f32 v33, v33, v35
    v_mfma_f32_16x16x32_bf16 v[96:99], v[80:83], v[64:67], v[96:99]
    v_cvt_pk_bf16_f32 v106, v32, v33
    v_add_f32 v36, v36, v38
    v_mfma_f32_16x16x32_bf16 v[96:99], v[84:87], v[68:71], v[96:99]
    v_add_f32 v37, v37, v39
    v_cvt_pk_bf16_f32 v107, v36, v37
    v_mfma_f32_16x16x32_bf16 v[20:23], v[100:103], v[16:19], 0
    ds_read_b128 v[44:47], v12 offset:256
    v_mfma_f32_16x16x32_bf16 v[24:27], v[88:91], v[16:19], 0
    v_exp_f32 v96, v96
    v_exp_f32 v97, v97
    v_mfma_f32_16x16x32_bf16 v[28:31], v[92:95], v[16:19], 0
    ds_read_b128 v[48:51], v12 offset:256
    v_cvt_pk_bf16_f32 v104, v96, v97
    v_cvt_pk_bf16_f32 v109, v96, v97
    s_nop 0
    v_mfma_f32_16x16x16_bf16 v[20:23], v[100:101], v[104:105], v[20:23]
    ds_read_b128 v[52:55], v12 offset:256
    v_mfma_f32_16x16x16_bf16 v[24:27], v[106:107], v[104:105], v[24:27]
    ds_read_b128 v[72:75], v8 offset:0
    v_mfma_f32_16x16x16_bf16 v[28:31], v[106:107], v[108:109], v[28:31]
    ds_read_b128 v[76:79], v8 offset:1024
    v_rcp_f32 v110, v20
    s_nop 0
    v_max_f32 v21, v20, v110
    v_cmp_ngt_f32 vcc, s32, v21
L_smback_88:
    v_pk_mul_f32 v[24:25], v[24:25], v[110:111] op_sel_hi:[1,0]
    v_pk_mul_f32 v[26:27], v[26:27], v[110:111] op_sel_hi:[1,0]
    v_pk_mul_f32 v[28:29], v[28:29], v[110:111] op_sel_hi:[1,0]
    v_pk_mul_f32 v[30:31], v[30:31], v[110:111] op_sel_hi:[1,0]
    s_mov_b64 exec, s[88:89]
    v_cvt_pk_bf16_f32 v24, v24, v25
    v_cvt_pk_bf16_f32 v25, v26, v27
    v_cvt_pk_bf16_f32 v26, v28, v29
    v_cvt_pk_bf16_f32 v27, v30, v31
    ds_write_b128 v6, v[24:27]
    s_mov_b64 exec, -1
    s_cbranch_vccnz L_slowsm_87
    ds_read_b128 v[80:83], v8 offset:4096
    ds_read_b128 v[84:87], v8 offset:5120
    s_waitcnt lgkmcnt(2)
    s_barrier
    ds_read_b128 v[24:27], v13 offset:16384
    ds_read_b128 v[28:31], v13 offset:17408
    ds_read_b128 v[56:59], v12 offset:256
    ds_read_b128 v[60:63], v12 offset:256
    ds_read_b128 v[88:91], v8 offset:2048
    s_waitcnt lgkmcnt(4)
    v_smfmac_f32_16x16x64_bf16 v[40:43], v[24:27], v[192:199], v2
    ds_read_b128 v[92:95], v8 offset:3072
    v_smfmac_f32_16x16x64_bf16 v[44:47], v[24:27], v[208:215], v2
    ds_read_b128 v[96:99], v8 offset:6144
    s_waitcnt lgkmcnt(5)
    v_smfmac_f32_16x16x64_bf16 v[40:43], v[28:31], v[200:207], v2
    ds_read_b128 v[100:103], v8 offset:7168
    s_mov_b32 s11, s24
    v_smfmac_f32_16x16x64_bf16 v[44:47], v[28:31], v[216:223], v2
    ds_read_b128 v[64:67], v12 offset:256
    s_mov_b32 s12, s23
    v_smfmac_f32_16x16x64_bf16 v[48:51], v[24:27], v[224:231], v2
    ds_read_b128 v[68:71], v12 offset:256
    v_add_f32 v40, v40, v42
    v_add_f32 v41, v41, v43
    v_smfmac_f32_16x16x64_bf16 v[52:55], v[24:27], v[240:247], v2
    ds_read_b128 v[32:35], v8 offset:32768
    v_add_f32 v44, v44, v46
    v_smfmac_f32_16x16x64_bf16 v[48:51], v[28:31], v[232:239], v2
    ds_read_b128 v[36:39], v8 offset:33792
    v_add_f32 v45, v45, v47
    v_smfmac_f32_16x16x64_bf16 v[52:55], v[28:31], v[248:255], v2
    ds_read_b128 v[16:19], v8 offset:34816
    s_waitcnt lgkmcnt(9)
    v_cvt_pk_bf16_f32 v40, v40, v44
    v_smfmac_f32_16x16x64_bf16 v[56:59], v[24:27], v[72:79], v2
    ds_read_b128 v[20:23], v8 offset:35840
    v_cvt_pk_bf16_f32 v41, v41, v45
    v_add_f32 v48, v48, v50
    v_add_f32 v49, v49, v51
    v_smfmac_f32_16x16x64_bf16 v[60:63], v[24:27], v[80:87], v2
    s_waitcnt lgkmcnt(8)
    v_add_f32 v52, v52, v54
    v_add_f32 v53, v53, v55
    v_smfmac_f32_16x16x64_bf16 v[56:59], v[28:31], v[88:95], v2
    v_cvt_pk_bf16_f32 v42, v48, v52
    v_cvt_pk_bf16_f32 v43, v49, v53
    buffer_store_dwordx4 v[40:43], v9, s[68:71], s85 offen
    s_waitcnt lgkmcnt(6)
    v_smfmac_f32_16x16x64_bf16 v[60:63], v[28:31], v[96:103], v2
    s_mov_b32 s13, s22
    s_mov_b32 s15, 1048576
    s_waitcnt lgkmcnt(4)
    v_smfmac_f32_16x16x64_bf16 v[64:67], v[24:27], v[112:119], v2
    s_waitcnt lgkmcnt(2)
    v_add_f32 v56, v56, v58
    v_add_f32 v57, v57, v59
    v_smfmac_f32_16x16x64_bf16 v[64:67], v[28:31], v[32:39], v2
    ds_read_b128 v[88:91], v13 offset:26880
    v_add_f32 v60, v60, v62
    v_smfmac_f32_16x16x64_bf16 v[68:71], v[24:27], v[120:127], v2
    s_mov_b32 s10, s27
    s_waitcnt lgkmcnt(1)
    v_add_f32 v61, v61, v63
    v_smfmac_f32_16x16x64_bf16 v[68:71], v[28:31], v[16:23], v2
    v_cvt_pk_bf16_f32 v56, v56, v60
    v_cvt_pk_bf16_f32 v57, v57, v61
    v_pk_add_f32 v[64:65], v[64:65], v[66:67]
    s_nop 2
    v_pk_add_f32 v[68:69], v[68:69], v[70:71]
    v_cvt_pk_bf16_f32 v58, v64, v68
    v_cvt_pk_bf16_f32 v59, v65, v69
    buffer_store_dwordx4 v[56:59], v9, s[68:71], s86 offen
    s_waitcnt vmcnt(8)
    v_readfirstlane_b32 s9, v111
    ds_read_b128 v[56:59], v7 offset:0
    ds_read_b128 v[60:63], v7 offset:1024
    ds_read_b128 v[64:67], v7 offset:2048
    ds_read_b128 v[68:71], v7 offset:3072
    ds_read_b128 v[72:75], v7 offset:4096
    ds_read_b128 v[76:79], v7 offset:5120
    ds_read_b128 v[80:83], v7 offset:6144
    ds_read_b128 v[84:87], v7 offset:7168
    ds_read_b128 v[16:19], v12 offset:256
    ds_read_b128 v[20:23], v12 offset:256
    ds_read_b128 v[32:35], v12 offset:256
    ds_read_b128 v[36:39], v12 offset:256
    s_mov_b32 s7, s23
    s_mov_b32 s23, s24
    s_mov_b32 s24, s25
    s_mov_b32 s25, s7
    s_add_u32 s17, s23, s16
    s_add_u32 s21, s21, 1
    s_mov_b32 s87, 262144
    s_cmp_eq_u32 s21, 3
    s_cselect_b32 s87, 0xfff80000, s87
    s_cselect_b32 s21, 0, s21
    s_add_u32 s85, s85, s87
    s_add_u32 s86, s86, s87
    s_add_u32 s22, s22, s87
    s_add_u32 s84, s84, s90
    s_mov_b32 s90, s87
    s_add_u32 s14, s14, 1
    s_mov_b32 s28, s18
    s_mov_b32 s29, s19
    s_add_u32 s18, s18, 131072
    s_add_u32 s19, s19, 65536
    s_mov_b32 s30, s20
    s_mov_b32 s20, s33
    s_add_u32 s33, s33, 128
    v_mov_b32 v104, 1
    s_add_u32 s27, s27, 128
    s_xor_b32 s91, s91, 16384
    s_add_u32 s26, s26, 262144
    s_mov_b32 m0, s91
    buffer_load_dwordx4 v[40:43], v1, s[68:71], s13 offen sc1
    buffer_load_dwordx4 v[44:47], v1, s[68:71], s13 offen offset:1024 sc1
    s_nop 7
    s_nop 7
    v_xor_b32 v15, 0x4000, v15
    s_nop 7
    s_nop 7
    v_mov_b32 v111, -1
    s_waitcnt lgkmcnt(12)
L_ra_89:
    buffer_load_dwordx4 v[48:51], v1, s[68:71], s13 offen sc1
    buffer_load_dwordx4 v[52:55], v1, s[68:71], s13 offen offset:1024 sc1
    s_waitcnt vmcnt(3)
    v_mfma_f32_16x16x32_bf16 v[92:95], v[88:91], v[40:43], 0
    s_waitcnt vmcnt(2)
    v_mfma_f32_16x16x32_bf16 v[92:95], v[88:91], v[44:47], v[92:95]
    s_nop 7
    v_cmp_u_f32 vcc, v92, v93
    v_add_f32_dpp v92, v92, v92 row_ror:4 row_mask:0xf bank_mask:0xf
    v_add_f32_dpp v93, v93, v93 row_ror:4 row_mask:0xf bank_mask:0xf
    s_cbranch_vccz L_rdone_91
    buffer_load_dwordx4 v[40:43], v1, s[68:71], s13 offen sc1
    buffer_load_dwordx4 v[44:47], v1, s[68:71], s13 offen offset:1024 sc1
    s_waitcnt vmcnt(3)
    v_mfma_f32_16x16x32_bf16 v[92:95], v[88:91], v[48:51], 0
    s_waitcnt vmcnt(2)
    v_mfma_f32_16x16x32_bf16 v[92:95], v[88:91], v[52:55], v[92:95]
    s_nop 7
    v_cmp_u_f32 vcc, v92, v93
    v_add_f32_dpp v92, v92, v92 row_ror:4 row_mask:0xf bank_mask:0xf
    v_add_f32_dpp v93, v93, v93 row_ror:4 row_mask:0xf bank_mask:0xf
    s_cbranch_vccnz L_rslow_90
L_rdone_91:
    v_add_f32_dpp v92, v92, v92 row_ror:8 row_mask:0xf bank_mask:0xf
    v_add_f32_dpp v93, v93, v93 row_ror:8 row_mask:0xf bank_mask:0xf
    v_cvt_pk_bf16_f32 v110, v92, v93
    v_min_u32 v110, 0xfffffffe, v110
    buffer_store_dword v110, v10, s[68:71], s11 offen
    buffer_store_dword v111, v10, s[68:71], s12 offen
    s_cmp_lg_u32 s9, 1
    s_cbranch_scc1 L_kvpoll_93
L_kvok_92:
    s_mov_b32 s15, 1048576
    s_nop 7
    s_nop 7
    s_nop 7
    s_nop 7
    s_nop 7
    s_nop 7
    buffer_load_dwordx4 v[24:27], v1, s[68:71], s17 offen offset:0 sc1
    buffer_load_dwordx4 v[28:31], v1, s[68:71], s17 offen offset:1024 sc1
    s_nop 7
    s_nop 7
    s_nop 7
    s_nop 7
    s_branch L_chk_f1
L_kvpoll_93:
    s_cmp_ge_u32 s14, 63
    s_cbranch_scc1 L_kvok_92
    s_mov_b32 s15, 1048576
L_poll_94:
    buffer_load_dword v111, off, s[68:71], s10 offset:0 sc1
    s_waitcnt vmcnt(0)
    v_readfirstlane_b32 s7, v111
    s_nop 0
    s_cmp_eq_u32 s7, 1
    s_cbranch_scc1 L_polld_95
    s_sub_u32 s15, s15, 1
    s_cmp_eq_u32 s15, 0
    s_cbranch_scc1 L_err_9
    s_branch L_poll_94
L_polld_95:
    s_branch L_kvok_92
L_mre_86:
    s_sub_u32 s15, s15, 1
    s_cmp_lg_u32 s15, 0
    s_cbranch_scc1 L_chk_f1
    s_branch L_err_8
L_rslow_90:
    s_sub_u32 s15, s15, 1
    s_cmp_eq_u32 s15, 0
    s_cbranch_scc1 L_err_10
    s_and_b32 s7, s15, 3
    s_cmp_lg_u32 s7, 0
    s_cbranch_scc1 L_ra_89
    s_mov_b64 s[98:99], 0
    v_mov_b32 v110, 0xffbfffbf
    v_cmp_eq_u32 vcc, v110, v48
    s_nop 0
    s_or_b64 s[98:99], s[98:99], vcc
    v_cmp_eq_u32 vcc, v110, v49
    s_nop 0
    s_or_b64 s[98:99], s[98:99], vcc
    v_cmp_eq_u32 vcc, v110, v50
    s_nop 0
    s_or_b64 s[98:99], s[98:99], vcc
    v_cmp_eq_u32 vcc, v110, v51
    s_nop 0
    s_or_b64 s[98:99], s[98:99], vcc
    v_cmp_eq_u32 vcc, v110, v52
    s_nop 0
    s_or_b64 s[98:99], s[98:99], vcc
    v_cmp_eq_u32 vcc, v110, v53
    s_nop 0
    s_or_b64 s[98:99], s[98:99], vcc
    v_cmp_eq_u32 vcc, v110, v54
    s_nop 0
    s_or_b64 s[98:99], s[98:99], vcc
    v_cmp_eq_u32 vcc, v110, v55
    s_nop 0
    s_or_b64 s[98:99], s[98:99], vcc
    s_cmp_eq_u64 s[98:99], 0
    s_cbranch_scc1 L_rdone_91
    s_branch L_ra_89
L_slowsm_87:
    s_waitcnt lgkmcnt(0)
    ds_read_b128 v[72:75], v15 offset:0
    ds_read_b128 v[88:91], v15 offset:4096
    ds_read_b128 v[76:79], v15 offset:1024
    ds_read_b128 v[92:95], v15 offset:5120
    ds_read_b128 v[80:83], v15 offset:2048
    ds_read_b128 v[96:99], v15 offset:6144
    ds_read_b128 v[84:87], v15 offset:3072
    ds_read_b128 v[100:103], v15 offset:7168
    s_waitcnt lgkmcnt(0)
    v_mfma_f32_16x16x32_bf16 v[16:19], v[72:75], v[56:59], 0
    v_mfma_f32_16x16x32_bf16 v[16:19], v[76:79], v[60:63], v[16:19]
    v_mfma_f32_16x16x32_bf16 v[16:19], v[80:83], v[64:67], v[16:19]
    v_mfma_f32_16x16x32_bf16 v[16:19], v[84:87], v[68:71], v[16:19]
    v_mfma_f32_16x16x32_bf16 v[20:23], v[88:91], v[56:59], 0
    v_mfma_f32_16x16x32_bf16 v[20:23], v[92:95], v[60:63], v[20:23]
    v_mfma_f32_16x16x32_bf16 v[20:23], v[96:99], v[64:67], v[20:23]
    v_mfma_f32_16x16x32_bf16 v[20:23], v[100:103], v[68:71], v[20:23]
    ds_read_b128 v[72:75], v5 offset:0
    ds_read_b128 v[76:79], v5 offset:64
    ds_read_b128 v[80:83], v5 offset:128
    ds_read_b128 v[84:87], v5 offset:192
    ds_read_b128 v[88:91], v15 offset:10240
    ds_read_b128 v[92:95], v15 offset:11264
    ds_read_b128 v[100:103], v12 offset:0
    s_waitcnt lgkmcnt(0)
    v_mfma_f32_16x16x32_bf16 v[96:99], v[72:75], v[56:59], 0
    v_mfma_f32_16x16x32_bf16 v[96:99], v[76:79], v[60:63], v[96:99]
    v_mfma_f32_16x16x32_bf16 v[96:99], v[80:83], v[64:67], v[96:99]
    v_mfma_f32_16x16x32_bf16 v[96:99], v[84:87], v[68:71], v[96:99]
    v_max3_f32 v110, v16, v17, v18
    v_max3_f32 v110, v110, v19, v20
    v_max3_f32 v110, v110, v21, v22
    v_max_f32 v110, v110, v23
    s_nop 2
    v_max3_f32 v110, v110, v96, v97
    v_mov_b32 v98, v110
    s_nop 1
    v_permlane16_swap_b32 v110, v98
    v_max_f32 v110, v110, v98
    v_mov_b32 v98, v110
    s_nop 1
    v_permlane32_swap_b32 v110, v98
    v_max_f32 v110, v110, v98
    v_sub_f32 v16, v16, v110
    v_exp_f32 v16, v16
    v_sub_f32 v17, v17, v110
    v_exp_f32 v17, v17
    v_sub_f32 v18, v18, v110
    v_exp_f32 v18, v18
    v_sub_f32 v19, v19, v110
    v_exp_f32 v19, v19
    v_sub_f32 v20, v20, v110
    v_exp_f32 v20, v20
    v_sub_f32 v21, v21, v110
    v_exp_f32 v21, v21
    v_sub_f32 v22, v22, v110
    v_exp_f32 v22, v22
    v_sub_f32 v23, v23, v110
    v_exp_f32 v23, v23
    v_sub_f32 v96, v96, v110
    v_exp_f32 v96, v96
    v_sub_f32 v97, v97, v110
    v_exp_f32 v97, v97
    v_cvt_pk_bf16_f32 v16, v16, v17
    v_cvt_pk_bf16_f32 v17, v18, v19
    v_cvt_pk_bf16_f32 v18, v20, v21
    v_cvt_pk_bf16_f32 v19, v22, v23
    v_cvt_pk_bf16_f32 v104, v96, v97
    v_cvt_pk_bf16_f32 v109, v96, v97
    v_mfma_f32_16x16x32_bf16 v[20:23], v[100:103], v[16:19], 0
    v_mfma_f32_16x16x32_bf16 v[24:27], v[88:91], v[16:19], 0
    v_mfma_f32_16x16x32_bf16 v[28:31], v[92:95], v[16:19], 0
    v_mfma_f32_16x16x16_bf16 v[20:23], v[100:101], v[104:105], v[20:23]
    v_mfma_f32_16x16x16_bf16 v[24:27], v[106:107], v[104:105], v[24:27]
    v_mfma_f32_16x16x16_bf16 v[28:31], v[106:107], v[108:109], v[28:31]
    ds_read_b128 v[72:75], v8 offset:0
    ds_read_b128 v[76:79], v8 offset:1024
    ds_read_b128 v[80:83], v8 offset:4096
    ds_read_b128 v[84:87], v8 offset:5120
    ds_read_b128 v[88:91], v8 offset:2048
    ds_read_b128 v[92:95], v8 offset:3072
    ds_read_b128 v[96:99], v8 offset:6144
    ds_read_b128 v[100:103], v8 offset:7168
    v_rcp_f32 v110, v20
    s_waitcnt lgkmcnt(0)
    s_mov_b64 vcc, 0
    s_nop 7
    s_branch L_smback_88
L_last_f1:
    buffer_store_dwordx2 v[106:107], v0, s[68:71], s29 offen sc1
    ds_read_b128 v[16:19], v5 offset:64
    s_waitcnt vmcnt(1)
    ds_read_b128 v[88:91], v7 offset:32768
    ds_read_b128 v[92:95], v7 offset:33792
    ds_read_b128 v[96:99], v7 offset:34816
    ds_read_b128 v[100:103], v7 offset:35840
    ds_read_b128 v[24:27], v12 offset:256
    ds_read_b128 v[28:31], v12 offset:256
    s_waitcnt lgkmcnt(0)
    buffer_store_dwordx4 v[16:19], v1, s[68:71], s28 offen sc1
    s_barrier
    v_smfmac_f32_16x16x64_bf16 v[24:27], v[40:43], a[128:135], v2
    v_smfmac_f32_16x16x64_bf16 v[28:31], v[40:43], a[192:199], v2
    v_smfmac_f32_16x16x64_bf16 v[32:35], v[40:43], v[128:135], v2
    v_smfmac_f32_16x16x64_bf16 v[36:39], v[40:43], v[136:143], v2
    ds_read_b128 v[40:43], v13 offset:8192
    v_smfmac_f32_16x16x64_bf16 v[24:27], v[44:47], a[136:143], v2
    v_smfmac_f32_16x16x64_bf16 v[28:31], v[44:47], a[200:207], v2
    v_smfmac_f32_16x16x64_bf16 v[32:35], v[44:47], v[144:151], v2
    v_smfmac_f32_16x16x64_bf16 v[36:39], v[44:47], v[152:159], v2
    ds_read_b128 v[44:47], v13 offset:9216
    v_smfmac_f32_16x16x64_bf16 v[24:27], v[48:51], a[144:151], v2
    v_smfmac_f32_16x16x64_bf16 v[28:31], v[48:51], a[208:215], v2
    v_smfmac_f32_16x16x64_bf16 v[32:35], v[48:51], v[160:167], v2
    v_smfmac_f32_16x16x64_bf16 v[36:39], v[48:51], v[168:175], v2
    ds_read_b128 v[48:51], v13 offset:10240
    v_smfmac_f32_16x16x64_bf16 v[24:27], v[52:55], a[152:159], v2
    v_smfmac_f32_16x16x64_bf16 v[28:31], v[52:55], a[216:223], v2
    v_smfmac_f32_16x16x64_bf16 v[32:35], v[52:55], v[176:183], v2
    v_smfmac_f32_16x16x64_bf16 v[36:39], v[52:55], v[184:191], v2
    ds_read_b128 v[52:55], v13 offset:11264
    s_waitcnt lgkmcnt(3)
    v_smfmac_f32_16x16x64_bf16 v[24:27], v[40:43], a[160:167], v2
    v_smfmac_f32_16x16x64_bf16 v[28:31], v[40:43], a[224:231], v2
    v_smfmac_f32_16x16x64_bf16 v[32:35], v[40:43], v[56:63], v2
    v_smfmac_f32_16x16x64_bf16 v[36:39], v[40:43], v[64:71], v2
    ds_read_b128 v[56:59], v7 offset:36864
    ds_read_b128 v[60:63], v7 offset:37888
    ds_read_b128 v[64:67], v7 offset:38912
    ds_read_b128 v[68:71], v7 offset:39936
    s_waitcnt lgkmcnt(6)
    v_smfmac_f32_16x16x64_bf16 v[24:27], v[44:47], a[168:175], v2
    v_smfmac_f32_16x16x64_bf16 v[28:31], v[44:47], a[232:239], v2
    v_smfmac_f32_16x16x64_bf16 v[32:35], v[44:47], v[72:79], v2
    v_smfmac_f32_16x16x64_bf16 v[36:39], v[44:47], v[80:87], v2
    s_waitcnt lgkmcnt(5)
    v_smfmac_f32_16x16x64_bf16 v[24:27], v[48:51], a[176:183], v2
    v_smfmac_f32_16x16x64_bf16 v[28:31], v[48:51], a[240:247], v2
    v_smfmac_f32_16x16x64_bf16 v[32:35], v[48:51], v[88:95], v2
    v_smfmac_f32_16x16x64_bf16 v[36:39], v[48:51], v[96:103], v2
    s_waitcnt lgkmcnt(4)
    v_smfmac_f32_16x16x64_bf16 v[24:27], v[52:55], a[184:191], v2
    v_smfmac_f32_16x16x64_bf16 v[28:31], v[52:55], a[248:255], v2
    s_waitcnt lgkmcnt(2)
    v_smfmac_f32_16x16x64_bf16 v[32:35], v[52:55], v[56:63], v2
    s_waitcnt lgkmcnt(0)
    v_smfmac_f32_16x16x64_bf16 v[36:39], v[52:55], v[64:71], v2
    v_add_f32 v24, v24, v26
    v_add_f32 v28, v28, v30
    v_add_f32 v25, v25, v27
    v_add_f32 v29, v29, v31
    v_cvt_pk_bf16_f32 v24, v24, v28
    v_cvt_pk_bf16_f32 v25, v25, v29
    ds_write2_b32 v14, v24, v25 offset0:0 offset1:72
    v_add_f32 v32, v32, v34
    v_add_f32 v33, v33, v35
    v_cvt_pk_bf16_f32 v106, v32, v33
    v_add_f32 v36, v36, v38
    v_add_f32 v37, v37, v39
    v_cvt_pk_bf16_f32 v107, v36, v37
    buffer_store_dwordx2 v[106:107], v0, s[68:71], s19 offen sc1
    s_waitcnt lgkmcnt(0)
    s_barrier
    ds_read_b128 v[72:75], v5 offset:64
    s_waitcnt lgkmcnt(0)
    buffer_store_dwordx4 v[72:75], v1, s[68:71], s18 offen sc1
    s_waitcnt vmcnt(0)
    s_barrier
    s_endpgm
L_cl_2:
    ds_read_b128 v[56:59], v7 offset:0
    ds_read_b128 v[60:63], v7 offset:1024
    ds_read_b128 v[64:67], v7 offset:2048
    ds_read_b128 v[68:71], v7 offset:3072
    ds_read_b128 v[72:75], v7 offset:4096
    ds_read_b128 v[76:79], v7 offset:5120
    ds_read_b128 v[80:83], v7 offset:6144
    ds_read_b128 v[84:87], v7 offset:7168
    ds_read_b128 v[16:19], v12 offset:256
    ds_read_b128 v[20:23], v12 offset:256
    ds_read_b128 v[32:35], v12 offset:256
    ds_read_b128 v[36:39], v12 offset:256
    v_mov_b32 v104, 1
    s_mov_b32 m0, s91
    s_mov_b32 s15, 1048576
    buffer_load_dwordx4 v[24:27], v1, s[68:71], s17 offen offset:0 sc1
    buffer_load_dwordx4 v[28:31], v1, s[68:71], s17 offen offset:1024 sc1
L_chk_f2:
    buffer_load_dwordx4 v[88:91], v1, s[68:71], s17 offen offset:0 sc1
    buffer_load_dwordx4 v[92:95], v1, s[68:71], s17 offen offset:1024 sc1
    s_waitcnt vmcnt(2)
    ds_write_b128 v13, v[24:27] offset:8192
    ds_write_b128 v13, v[28:31] offset:9216
    v_max3_u32 v111, v24, v25, v26
    v_max3_u32 v110, v27, v28, v29
    v_max3_u32 v111, v111, v30, v31
    v_max_u32 v111, v111, v110
    v_cmp_eq_u32 vcc, -1, v111
    s_cbranch_vccz L_bar1_f2
    buffer_load_dwordx4 v[24:27], v1, s[68:71], s17 offen offset:0 sc1
    buffer_load_dwordx4 v[28:31], v1, s[68:71], s17 offen offset:1024 sc1
    s_waitcnt vmcnt(2)
    ds_write_b128 v13, v[88:91] offset:8192
    ds_write_b128 v13, v[92:95] offset:9216
    v_max3_u32 v111, v88, v89, v90
    v_max3_u32 v110, v91, v92, v93
    v_max3_u32 v111, v111, v94, v95
    v_max_u32 v111, v111, v110
    v_cmp_eq_u32 vcc, -1, v111
    s_cbranch_vccnz L_mre_96
L_bar1_f2:
    s_cmp_eq_u32 s14, 63
    s_waitcnt lgkmcnt(0)
    s_barrier
    ds_read_b128 v[40:43], v13 offset:0
    ds_read_b128 v[44:47], v13 offset:1024
    ds_read_b128 v[48:51], v13 offset:2048
    ds_read_b128 v[52:55], v13 offset:3072
    s_cbranch_scc1 L_last_f2
    buffer_store_dwordx2 v[106:107], v0, s[68:71], s29 offen sc1
    s_waitcnt lgkmcnt(3)
    v_smfmac_f32_16x16x64_bf16 v[16:19], v[40:43], a[0:7], v2
    v_smfmac_f32_16x16x64_bf16 v[20:23], v[40:43], a[64:71], v2
    ds_read_b128 v[40:43], v13 offset:8192
    s_waitcnt lgkmcnt(3)
    v_smfmac_f32_16x16x64_bf16 v[16:19], v[44:47], a[8:15], v2
    buffer_load_dwordx4 v1, s[68:71], s26 offen offset:0 sc1 lds
    v_smfmac_f32_16x16x64_bf16 v[20:23], v[44:47], a[72:79], v2
    ds_read_b128 v[44:47], v13 offset:9216
    s_waitcnt lgkmcnt(3)
    v_smfmac_f32_16x16x64_bf16 v[16:19], v[48:51], a[16:23], v2
    v_smfmac_f32_16x16x64_bf16 v[20:23], v[48:51], a[80:87], v2
    ds_read_b128 v[48:51], v13 offset:10240
    s_waitcnt lgkmcnt(3)
    v_smfmac_f32_16x16x64_bf16 v[16:19], v[52:55], a[24:31], v2
    buffer_load_dwordx4 v1, s[68:71], s26 offen offset:1024 sc1 lds
    s_waitcnt vmcnt(3)
    s_nop 0
    v_smfmac_f32_16x16x64_bf16 v[20:23], v[52:55], a[88:95], v2
    ds_read_b128 v[24:27], v5 offset:128
    s_waitcnt lgkmcnt(3)
    v_smfmac_f32_16x16x64_bf16 v[16:19], v[40:43], a[32:39], v2
    ds_read_b128 v[28:31], v12 offset:512
    v_smfmac_f32_16x16x64_bf16 v[20:23], v[40:43], a[96:103], v2
    ds_read_b128 v[88:91], v7 offset:32768
    v_smfmac_f32_16x16x64_bf16 v[32:35], v[40:43], v[56:63], v2
    buffer_load_dwordx4 v1, s[68:71], s26 offen offset:2048 sc1 lds
    s_waitcnt lgkmcnt(1)
    buffer_store_dwordx4 v[28:31], v1, s[68:71], s84 offen
    v_smfmac_f32_16x16x64_bf16 v[36:39], v[40:43], v[64:71], v2
    ds_read_b128 v[92:95], v7 offset:33792
    v_smfmac_f32_16x16x64_bf16 v[16:19], v[44:47], a[40:47], v2
    ds_read_b128 v[52:55], v13 offset:11264
    buffer_store_dwordx4 v[24:27], v1, s[68:71], s28 offen sc1
    v_smfmac_f32_16x16x64_bf16 v[20:23], v[44:47], a[104:111], v2
    ds_read_b128 v[96:99], v7 offset:34816
    v_smfmac_f32_16x16x64_bf16 v[32:35], v[44:47], v[72:79], v2
    buffer_load_dwordx4 v1, s[68:71], s26 offen offset:3072 sc1 lds
    ds_read_b128 v[56:59], v7 offset:36864
    v_smfmac_f32_16x16x64_bf16 v[36:39], v[44:47], v[80:87], v2
    ds_read_b128 v[100:103], v7 offset:35840
    buffer_store_dwordx4 v[28:31], v1, s[68:71], s84 offen offset:1024
    ds_read_b128 v[24:27], v12 offset:256
    v_smfmac_f32_16x16x64_bf16 v[16:19], v[48:51], a[48:55], v2
    ds_read_b128 v[60:63], v7 offset:37888
    ds_read_b128 v[28:31], v12 offset:256
    v_smfmac_f32_16x16x64_bf16 v[20:23], v[48:51], a[112:119], v2
    ds_read_b128 v[64:67], v7 offset:38912
    s_waitcnt lgkmcnt(7)
    v_smfmac_f32_16x16x64_bf16 v[16:19], v[52:55], a[56:63], v2
    ds_read_b128 v[68:71], v7 offset:39936
    v_smfmac_f32_16x16x64_bf16 v[20:23], v[52:55], a[120:127], v2
    ds_read_b128 v[72:75], v15 offset:0
    s_waitcnt lgkmcnt(3)
    v_smfmac_f32_16x16x64_bf16 v[24:27], v[40:43], a[160:167], v2
    ds_read_b128 v[76:79], v15 offset:1024
    v_smfmac_f32_16x16x64_bf16 v[28:31], v[40:43], a[224:231], v2
    ds_read_b128 v[40:43], v13 offset:0
    v_add_f32 v16, v16, v18
    v_smfmac_f32_16x16x64_bf16 v[24:27], v[44:47], a[168:175], v2
    ds_read_b128 v[80:83], v15 offset:2048
    v_add_f32 v20, v20, v22
    v_smfmac_f32_16x16x64_bf16 v[28:31], v[44:47], a[232:239], v2
    ds_read_b128 v[44:47], v13 offset:1024
    v_add_f32 v17, v17, v19
    v_smfmac_f32_16x16x64_bf16 v[24:27], v[48:51], a[176:183], v2
    ds_read_b128 v[84:87], v15 offset:3072
    v_add_f32 v21, v21, v23
    v_smfmac_f32_16x16x64_bf16 v[28:31], v[48:51], a[240:247], v2
    v_mul_f32 v16, s31, v16
    v_smfmac_f32_16x16x64_bf16 v[32:35], v[48:51], v[88:95], v2
    v_mul_f32 v20, s31, v20
    v_smfmac_f32_16x16x64_bf16 v[36:39], v[48:51], v[96:103], v2
    ds_read_b128 v[88:91], v15 offset:4096
    v_cvt_pk_bf16_f32 v16, v16, v20
    v_smfmac_f32_16x16x64_bf16 v[24:27], v[52:55], a[184:191], v2
    ds_read_b128 v[48:51], v13 offset:2048
    v_mul_f32 v17, s31, v17
    v_smfmac_f32_16x16x64_bf16 v[28:31], v[52:55], a[248:255], v2
    ds_read_b128 v[92:95], v15 offset:5120
    v_mul_f32 v21, s31, v21
    v_smfmac_f32_16x16x64_bf16 v[32:35], v[52:55], v[56:63], v2
    ds_read_b128 v[96:99], v15 offset:6144
    s_waitcnt lgkmcnt(4)
    v_cvt_pk_bf16_f32 v17, v17, v21
    v_smfmac_f32_16x16x64_bf16 v[36:39], v[52:55], v[64:71], v2
    ds_write2_b32 v3, v16, v17 offset0:0 offset1:72
    ds_read_b128 v[52:55], v13 offset:3072
    v_smfmac_f32_16x16x64_bf16 v[24:27], v[40:43], a[128:135], v2
    ds_read_b128 v[100:103], v15 offset:7168
    v_smfmac_f32_16x16x64_bf16 v[28:31], v[40:43], a[192:199], v2
    v_smfmac_f32_16x16x64_bf16 v[24:27], v[44:47], a[136:143], v2
    s_waitcnt lgkmcnt(2)
    s_barrier
    ds_read_b128 v[56:59], v4 offset:0
    v_smfmac_f32_16x16x64_bf16 v[28:31], v[44:47], a[200:207], v2
    ds_read_b128 v[60:63], v4 offset:64
    v_smfmac_f32_16x16x64_bf16 v[24:27], v[48:51], a[144:151], v2
    ds_read_b128 v[64:67], v4 offset:128
    v_smfmac_f32_16x16x64_bf16 v[28:31], v[48:51], a[208:215], v2
    ds_read_b128 v[68:71], v4 offset:192
    s_waitcnt lgkmcnt(5)
    v_smfmac_f32_16x16x64_bf16 v[24:27], v[52:55], a[152:159], v2
    v_smfmac_f32_16x16x64_bf16 v[28:31], v[52:55], a[216:223], v2
    v_smfmac_f32_16x16x64_bf16 v[32:35], v[40:43], v[128:135], v2
    s_waitcnt lgkmcnt(3)
    v_mfma_f32_16x16x32_bf16 v[16:19], v[72:75], v[56:59], 0
    s_waitcnt lgkmcnt(2)
    v_add_f32 v24, v24, v26
    v_add_f32 v28, v28, v30
    v_mfma_f32_16x16x32_bf16 v[16:19], v[76:79], v[60:63], v[16:19]
    s_waitcnt lgkmcnt(1)
    v_add_f32 v25, v25, v27
    v_add_f32 v29, v29, v31
    v_mfma_f32_16x16x32_bf16 v[16:19], v[80:83], v[64:67], v[16:19]
    s_waitcnt lgkmcnt(0)
    v_cvt_pk_bf16_f32 v24, v24, v28
    v_cvt_pk_bf16_f32 v25, v25, v29
    v_mfma_f32_16x16x32_bf16 v[16:19], v[84:87], v[68:71], v[16:19]
    ds_write2_b32 v14, v24, v25 offset0:0 offset1:72
    v_mfma_f32_16x16x32_bf16 v[20:23], v[88:91], v[56:59], 0
    v_mfma_f32_16x16x32_bf16 v[20:23], v[92:95], v[60:63], v[20:23]
    v_exp_f32 v16, v16
    v_mfma_f32_16x16x32_bf16 v[20:23], v[96:99], v[64:67], v[20:23]
    s_waitcnt lgkmcnt(0)
    s_barrier
    ds_read_b128 v[72:75], v5 offset:0
    ds_read_b128 v[76:79], v5 offset:64
    ds_read_b128 v[80:83], v5 offset:128
    ds_read_b128 v[84:87], v5 offset:192
    v_exp_f32 v17, v17
    v_mfma_f32_16x16x32_bf16 v[20:23], v[100:103], v[68:71], v[20:23]
    ds_read_b128 v[88:91], v15 offset:12288
    v_exp_f32 v18, v18
    v_smfmac_f32_16x16x64_bf16 v[36:39], v[40:43], v[136:143], v2
    ds_read_b128 v[92:95], v15 offset:13312
    v_exp_f32 v19, v19
    v_smfmac_f32_16x16x64_bf16 v[32:35], v[44:47], v[144:151], v2
    ds_read_b128 v[100:103], v12 offset:0
    v_exp_f32 v20, v20
    v_smfmac_f32_16x16x64_bf16 v[36:39], v[44:47], v[152:159], v2
    v_exp_f32 v21, v21
    v_smfmac_f32_16x16x64_bf16 v[32:35], v[48:51], v[160:167], v2
    v_exp_f32 v22, v22
    v_smfmac_f32_16x16x64_bf16 v[36:39], v[48:51], v[168:175], v2
    v_exp_f32 v23, v23
    v_smfmac_f32_16x16x64_bf16 v[32:35], v[52:55], v[176:183], v2
    v_cvt_pk_bf16_f32 v16, v16, v17
    v_smfmac_f32_16x16x64_bf16 v[36:39], v[52:55], v[184:191], v2
    ds_read_b128 v[40:43], v12 offset:256
    s_waitcnt lgkmcnt(1)
    v_cvt_pk_bf16_f32 v17, v18, v19
    v_mfma_f32_16x16x32_bf16 v[96:99], v[72:75], v[56:59], 0
    v_cvt_pk_bf16_f32 v18, v20, v21
    v_cvt_pk_bf16_f32 v19, v22, v23
    v_mfma_f32_16x16x32_bf16 v[96:99], v[76:79], v[60:63], v[96:99]
    v_add_f32 v32, v32, v34
    v_add_f32 v33, v33, v35
    v_mfma_f32_16x16x32_bf16 v[96:99], v[80:83], v[64:67], v[96:99]
    v_cvt_pk_bf16_f32 v106, v32, v33
    v_add_f32 v36, v36, v38
    v_mfma_f32_16x16x32_bf16 v[96:99], v[84:87], v[68:71], v[96:99]
    v_add_f32 v37, v37, v39
    v_cvt_pk_bf16_f32 v107, v36, v37
    v_mfma_f32_16x16x32_bf16 v[20:23], v[100:103], v[16:19], 0
    ds_read_b128 v[44:47], v12 offset:256
    v_mfma_f32_16x16x32_bf16 v[24:27], v[88:91], v[16:19], 0
    v_exp_f32 v96, v96
    v_exp_f32 v97, v97
    v_mfma_f32_16x16x32_bf16 v[28:31], v[92:95], v[16:19], 0
    ds_read_b128 v[48:51], v12 offset:256
    v_cvt_pk_bf16_f32 v104, v96, v97
    v_cvt_pk_bf16_f32 v109, v96, v97
    s_nop 0
    v_mfma_f32_16x16x16_bf16 v[20:23], v[100:101], v[104:105], v[20:23]
    ds_read_b128 v[52:55], v12 offset:256
    v_mfma_f32_16x16x16_bf16 v[24:27], v[106:107], v[104:105], v[24:27]
    ds_read_b128 v[72:75], v8 offset:0
    v_mfma_f32_16x16x16_bf16 v[28:31], v[106:107], v[108:109], v[28:31]
    ds_read_b128 v[76:79], v8 offset:1024
    v_rcp_f32 v110, v20
    s_nop 0
    v_max_f32 v21, v20, v110
    v_cmp_ngt_f32 vcc, s32, v21
L_smback_98:
    v_pk_mul_f32 v[24:25], v[24:25], v[110:111] op_sel_hi:[1,0]
    v_pk_mul_f32 v[26:27], v[26:27], v[110:111] op_sel_hi:[1,0]
    v_pk_mul_f32 v[28:29], v[28:29], v[110:111] op_sel_hi:[1,0]
    v_pk_mul_f32 v[30:31], v[30:31], v[110:111] op_sel_hi:[1,0]
    s_mov_b64 exec, s[88:89]
    v_cvt_pk_bf16_f32 v24, v24, v25
    v_cvt_pk_bf16_f32 v25, v26, v27
    v_cvt_pk_bf16_f32 v26, v28, v29
    v_cvt_pk_bf16_f32 v27, v30, v31
    ds_write_b128 v6, v[24:27]
    s_mov_b64 exec, -1
    s_cbranch_vccnz L_slowsm_97
    ds_read_b128 v[80:83], v8 offset:4096
    ds_read_b128 v[84:87], v8 offset:5120
    s_waitcnt lgkmcnt(2)
    s_barrier
    ds_read_b128 v[24:27], v13 offset:16384
    ds_read_b128 v[28:31], v13 offset:17408
    ds_read_b128 v[56:59], v12 offset:256
    ds_read_b128 v[60:63], v12 offset:256
    ds_read_b128 v[88:91], v8 offset:2048
    s_waitcnt lgkmcnt(4)
    v_smfmac_f32_16x16x64_bf16 v[40:43], v[24:27], v[192:199], v2
    ds_read_b128 v[92:95], v8 offset:3072
    v_smfmac_f32_16x16x64_bf16 v[44:47], v[24:27], v[208:215], v2
    ds_read_b128 v[96:99], v8 offset:6144
    s_waitcnt lgkmcnt(5)
    v_smfmac_f32_16x16x64_bf16 v[40:43], v[28:31], v[200:207], v2
    ds_read_b128 v[100:103], v8 offset:7168
    s_mov_b32 s11, s24
    v_smfmac_f32_16x16x64_bf16 v[44:47], v[28:31], v[216:223], v2
    ds_read_b128 v[64:67], v12 offset:256
    s_mov_b32 s12, s23
    v_smfmac_f32_16x16x64_bf16 v[48:51], v[24:27], v[224:231], v2
    ds_read_b128 v[68:71], v12 offset:256
    v_add_f32 v40, v40, v42
    v_add_f32 v41, v41, v43
    v_smfmac_f32_16x16x64_bf16 v[52:55], v[24:27], v[240:247], v2
    ds_read_b128 v[32:35], v8 offset:32768
    v_add_f32 v44, v44, v46
    v_smfmac_f32_16x16x64_bf16 v[48:51], v[28:31], v[232:239], v2
    ds_read_b128 v[36:39], v8 offset:33792
    v_add_f32 v45, v45, v47
    v_smfmac_f32_16x16x64_bf16 v[52:55], v[28:31], v[248:255], v2
    ds_read_b128 v[16:19], v8 offset:34816
    s_waitcnt lgkmcnt(9)
    v_cvt_pk_bf16_f32 v40, v40, v44
    v_smfmac_f32_16x16x64_bf16 v[56:59], v[24:27], v[72:79], v2
    ds_read_b128 v[20:23], v8 offset:35840
    v_cvt_pk_bf16_f32 v41, v41, v45
    v_add_f32 v48, v48, v50
    v_add_f32 v49, v49, v51
    v_smfmac_f32_16x16x64_bf16 v[60:63], v[24:27], v[80:87], v2
    s_waitcnt lgkmcnt(8)
    v_add_f32 v52, v52, v54
    v_add_f32 v53, v53, v55
    v_smfmac_f32_16x16x64_bf16 v[56:59], v[28:31], v[88:95], v2
    v_cvt_pk_bf16_f32 v42, v48, v52
    v_cvt_pk_bf16_f32 v43, v49, v53
    buffer_store_dwordx4 v[40:43], v9, s[68:71], s85 offen
    s_waitcnt lgkmcnt(6)
    v_smfmac_f32_16x16x64_bf16 v[60:63], v[28:31], v[96:103], v2
    s_mov_b32 s13, s22
    s_mov_b32 s15, 1048576
    s_waitcnt lgkmcnt(4)
    v_smfmac_f32_16x16x64_bf16 v[64:67], v[24:27], v[112:119], v2
    s_waitcnt lgkmcnt(2)
    v_add_f32 v56, v56, v58
    v_add_f32 v57, v57, v59
    v_smfmac_f32_16x16x64_bf16 v[64:67], v[28:31], v[32:39], v2
    ds_read_b128 v[88:91], v13 offset:26880
    v_add_f32 v60, v60, v62
    v_smfmac_f32_16x16x64_bf16 v[68:71], v[24:27], v[120:127], v2
    s_mov_b32 s10, s27
    s_waitcnt lgkmcnt(1)
    v_add_f32 v61, v61, v63
    v_smfmac_f32_16x16x64_bf16 v[68:71], v[28:31], v[16:23], v2
    v_cvt_pk_bf16_f32 v56, v56, v60
    v_cvt_pk_bf16_f32 v57, v57, v61
    v_pk_add_f32 v[64:65], v[64:65], v[66:67]
    s_nop 2
    v_pk_add_f32 v[68:69], v[68:69], v[70:71]
    v_cvt_pk_bf16_f32 v58, v64, v68
    v_cvt_pk_bf16_f32 v59, v65, v69
    buffer_store_dwordx4 v[56:59], v9, s[68:71], s86 offen
    s_nop 1
    ds_read_b128 v[56:59], v7 offset:0
    ds_read_b128 v[60:63], v7 offset:1024
    ds_read_b128 v[64:67], v7 offset:2048
    ds_read_b128 v[68:71], v7 offset:3072
    ds_read_b128 v[72:75], v7 offset:4096
    ds_read_b128 v[76:79], v7 offset:5120
    ds_read_b128 v[80:83], v7 offset:6144
    ds_read_b128 v[84:87], v7 offset:7168
    ds_read_b128 v[16:19], v12 offset:256
    ds_read_b128 v[20:23], v12 offset:256
    ds_read_b128 v[32:35], v12 offset:256
    ds_read_b128 v[36:39], v12 offset:256
    s_mov_b32 s7, s23
    s_mov_b32 s23, s24
    s_mov_b32 s24, s25
    s_mov_b32 s25, s7
    s_add_u32 s17, s23, s16
    s_add_u32 s21, s21, 1
    s_mov_b32 s87, 262144
    s_cmp_eq_u32 s21, 3
    s_cselect_b32 s87, 0xfff80000, s87
    s_cselect_b32 s21, 0, s21
    s_add_u32 s85, s85, s87
    s_add_u32 s86, s86, s87
    s_add_u32 s22, s22, s87
    s_add_u32 s84, s84, s90
    s_mov_b32 s90, s87
    s_add_u32 s14, s14, 1
    s_mov_b32 s28, s18
    s_mov_b32 s29, s19
    s_add_u32 s18, s18, 131072
    s_add_u32 s19, s19, 65536
    s_mov_b32 s30, s20
    s_mov_b32 s20, s33
    s_add_u32 s33, s33, 128
    v_mov_b32 v104, 1
    s_add_u32 s27, s27, 128
    s_xor_b32 s91, s91, 16384
    s_add_u32 s26, s26, 262144
    s_mov_b32 m0, s91
    buffer_load_dwordx4 v[40:43], v1, s[68:71], s13 offen sc1
    buffer_load_dwordx4 v[44:47], v1, s[68:71], s13 offen offset:1024 sc1
    s_nop 7
    s_nop 7
    v_xor_b32 v15, 0x4000, v15
    s_nop 7
    s_nop 7
    v_mov_b32 v111, -1
    s_waitcnt lgkmcnt(12)
L_ra_99:
    buffer_load_dwordx4 v[48:51], v1, s[68:71], s13 offen sc1
    buffer_load_dwordx4 v[52:55], v1, s[68:71], s13 offen offset:1024 sc1
    s_waitcnt vmcnt(3)
    v_mfma_f32_16x16x32_bf16 v[92:95], v[88:91], v[40:43], 0
    s_waitcnt vmcnt(2)
    v_mfma_f32_16x16x32_bf16 v[92:95], v[88:91], v[44:47], v[92:95]
    s_nop 7
    v_cmp_u_f32 vcc, v92, v93
    v_add_f32_dpp v92, v92, v92 row_ror:4 row_mask:0xf bank_mask:0xf
    v_add_f32_dpp v93, v93, v93 row_ror:4 row_mask:0xf bank_mask:0xf
    s_cbranch_vccz L_rdone_101
    buffer_load_dwordx4 v[40:43], v1, s[68:71], s13 offen sc1
    buffer_load_dwordx4 v[44:47], v1, s[68:71], s13 offen offset:1024 sc1
    s_waitcnt vmcnt(3)
    v_mfma_f32_16x16x32_bf16 v[92:95], v[88:91], v[48:51], 0
    s_waitcnt vmcnt(2)
    v_mfma_f32_16x16x32_bf16 v[92:95], v[88:91], v[52:55], v[92:95]
    s_nop 7
    v_cmp_u_f32 vcc, v92, v93
    v_add_f32_dpp v92, v92, v92 row_ror:4 row_mask:0xf bank_mask:0xf
    v_add_f32_dpp v93, v93, v93 row_ror:4 row_mask:0xf bank_mask:0xf
    s_cbranch_vccnz L_rslow_100
L_rdone_101:
    v_add_f32_dpp v92, v92, v92 row_ror:8 row_mask:0xf bank_mask:0xf
    v_add_f32_dpp v93, v93, v93 row_ror:8 row_mask:0xf bank_mask:0xf
    v_cvt_pk_bf16_f32 v110, v92, v93
    v_min_u32 v110, 0xfffffffe, v110
    buffer_store_dword v110, v10, s[68:71], s11 offen
    buffer_store_dword v111, v10, s[68:71], s12 offen
L_kvok_102:
    s_mov_b32 s15, 1048576
    s_nop 7
    s_nop 7
    s_nop 7
    s_nop 7
    s_nop 7
    s_nop 7
    buffer_load_dwordx4 v[24:27], v1, s[68:71], s17 offen offset:0 sc1
    buffer_load_dwordx4 v[28:31], v1, s[68:71], s17 offen offset:1024 sc1
    s_nop 7
    s_nop 7
    s_nop 7
    s_nop 7
    s_branch L_chk_f2
L_mre_96:
    s_sub_u32 s15, s15, 1
    s_cmp_lg_u32 s15, 0
    s_cbranch_scc1 L_chk_f2
    s_branch L_err_8
L_rslow_100:
    s_sub_u32 s15, s15, 1
    s_cmp_eq_u32 s15, 0
    s_cbranch_scc1 L_err_10
    s_and_b32 s7, s15, 3
    s_cmp_lg_u32 s7, 0
    s_cbranch_scc1 L_ra_99
    s_mov_b64 s[98:99], 0
    v_mov_b32 v110, 0xffbfffbf
    v_cmp_eq_u32 vcc, v110, v48
    s_nop 0
    s_or_b64 s[98:99], s[98:99], vcc
    v_cmp_eq_u32 vcc, v110, v49
    s_nop 0
    s_or_b64 s[98:99], s[98:99], vcc
    v_cmp_eq_u32 vcc, v110, v50
    s_nop 0
    s_or_b64 s[98:99], s[98:99], vcc
    v_cmp_eq_u32 vcc, v110, v51
    s_nop 0
    s_or_b64 s[98:99], s[98:99], vcc
    v_cmp_eq_u32 vcc, v110, v52
    s_nop 0
    s_or_b64 s[98:99], s[98:99], vcc
    v_cmp_eq_u32 vcc, v110, v53
    s_nop 0
    s_or_b64 s[98:99], s[98:99], vcc
    v_cmp_eq_u32 vcc, v110, v54
    s_nop 0
    s_or_b64 s[98:99], s[98:99], vcc
    v_cmp_eq_u32 vcc, v110, v55
    s_nop 0
    s_or_b64 s[98:99], s[98:99], vcc
    s_cmp_eq_u64 s[98:99], 0
    s_cbranch_scc1 L_rdone_101
    s_branch L_ra_99
L_slowsm_97:
    s_waitcnt lgkmcnt(0)
    ds_read_b128 v[72:75], v15 offset:0
    ds_read_b128 v[88:91], v15 offset:4096
    ds_read_b128 v[76:79], v15 offset:1024
    ds_read_b128 v[92:95], v15 offset:5120
    ds_read_b128 v[80:83], v15 offset:2048
    ds_read_b128 v[96:99], v15 offset:6144
    ds_read_b128 v[84:87], v15 offset:3072
    ds_read_b128 v[100:103], v15 offset:7168
    s_waitcnt lgkmcnt(0)
    v_mfma_f32_16x16x32_bf16 v[16:19], v[72:75], v[56:59], 0
    v_mfma_f32_16x16x32_bf16 v[16:19], v[76:79], v[60:63], v[16:19]
    v_mfma_f32_16x16x32_bf16 v[16:19], v[80:83], v[64:67], v[16:19]
    v_mfma_f32_16x16x32_bf16 v[16:19], v[84:87], v[68:71], v[16:19]
    v_mfma_f32_16x16x32_bf16 v[20:23], v[88:91], v[56:59], 0
    v_mfma_f32_16x16x32_bf16 v[20:23], v[92:95], v[60:63], v[20:23]
    v_mfma_f32_16x16x32_bf16 v[20:23], v[96:99], v[64:67], v[20:23]
    v_mfma_f32_16x16x32_bf16 v[20:23], v[100:103], v[68:71], v[20:23]
    ds_read_b128 v[72:75], v5 offset:0
    ds_read_b128 v[76:79], v5 offset:64
    ds_read_b128 v[80:83], v5 offset:128
    ds_read_b128 v[84:87], v5 offset:192
    ds_read_b128 v[88:91], v15 offset:12288
    ds_read_b128 v[92:95], v15 offset:13312
    ds_read_b128 v[100:103], v12 offset:0
    s_waitcnt lgkmcnt(0)
    v_mfma_f32_16x16x32_bf16 v[96:99], v[72:75], v[56:59], 0
    v_mfma_f32_16x16x32_bf16 v[96:99], v[76:79], v[60:63], v[96:99]
    v_mfma_f32_16x16x32_bf16 v[96:99], v[80:83], v[64:67], v[96:99]
    v_mfma_f32_16x16x32_bf16 v[96:99], v[84:87], v[68:71], v[96:99]
    v_max3_f32 v110, v16, v17, v18
    v_max3_f32 v110, v110, v19, v20
    v_max3_f32 v110, v110, v21, v22
    v_max_f32 v110, v110, v23
    s_nop 2
    v_max3_f32 v110, v110, v96, v97
    v_mov_b32 v98, v110
    s_nop 1
    v_permlane16_swap_b32 v110, v98
    v_max_f32 v110, v110, v98
    v_mov_b32 v98, v110
    s_nop 1
    v_permlane32_swap_b32 v110, v98
    v_max_f32 v110, v110, v98
    v_sub_f32 v16, v16, v110
    v_exp_f32 v16, v16
    v_sub_f32 v17, v17, v110
    v_exp_f32 v17, v17
    v_sub_f32 v18, v18, v110
    v_exp_f32 v18, v18
    v_sub_f32 v19, v19, v110
    v_exp_f32 v19, v19
    v_sub_f32 v20, v20, v110
    v_exp_f32 v20, v20
    v_sub_f32 v21, v21, v110
    v_exp_f32 v21, v21
    v_sub_f32 v22, v22, v110
    v_exp_f32 v22, v22
    v_sub_f32 v23, v23, v110
    v_exp_f32 v23, v23
    v_sub_f32 v96, v96, v110
    v_exp_f32 v96, v96
    v_sub_f32 v97, v97, v110
    v_exp_f32 v97, v97
    v_cvt_pk_bf16_f32 v16, v16, v17
    v_cvt_pk_bf16_f32 v17, v18, v19
    v_cvt_pk_bf16_f32 v18, v20, v21
    v_cvt_pk_bf16_f32 v19, v22, v23
    v_cvt_pk_bf16_f32 v104, v96, v97
    v_cvt_pk_bf16_f32 v109, v96, v97
    v_mfma_f32_16x16x32_bf16 v[20:23], v[100:103], v[16:19], 0
    v_mfma_f32_16x16x32_bf16 v[24:27], v[88:91], v[16:19], 0
    v_mfma_f32_16x16x32_bf16 v[28:31], v[92:95], v[16:19], 0
    v_mfma_f32_16x16x16_bf16 v[20:23], v[100:101], v[104:105], v[20:23]
    v_mfma_f32_16x16x16_bf16 v[24:27], v[106:107], v[104:105], v[24:27]
    v_mfma_f32_16x16x16_bf16 v[28:31], v[106:107], v[108:109], v[28:31]
    ds_read_b128 v[72:75], v8 offset:0
    ds_read_b128 v[76:79], v8 offset:1024
    ds_read_b128 v[80:83], v8 offset:4096
    ds_read_b128 v[84:87], v8 offset:5120
    ds_read_b128 v[88:91], v8 offset:2048
    ds_read_b128 v[92:95], v8 offset:3072
    ds_read_b128 v[96:99], v8 offset:6144
    ds_read_b128 v[100:103], v8 offset:7168
    v_rcp_f32 v110, v20
    s_waitcnt lgkmcnt(0)
    s_mov_b64 vcc, 0
    s_nop 7
    s_branch L_smback_98
L_last_f2:
    buffer_store_dwordx2 v[106:107], v0, s[68:71], s29 offen sc1
    ds_read_b128 v[16:19], v5 offset:128
    s_waitcnt vmcnt(1)
    ds_read_b128 v[88:91], v7 offset:32768
    ds_read_b128 v[92:95], v7 offset:33792
    ds_read_b128 v[96:99], v7 offset:34816
    ds_read_b128 v[100:103], v7 offset:35840
    ds_read_b128 v[24:27], v12 offset:256
    ds_read_b128 v[28:31], v12 offset:256
    s_waitcnt lgkmcnt(0)
    buffer_store_dwordx4 v[16:19], v1, s[68:71], s28 offen sc1
    s_barrier
    v_smfmac_f32_16x16x64_bf16 v[24:27], v[40:43], a[128:135], v2
    v_smfmac_f32_16x16x64_bf16 v[28:31], v[40:43], a[192:199], v2
    v_smfmac_f32_16x16x64_bf16 v[32:35], v[40:43], v[128:135], v2
    v_smfmac_f32_16x16x64_bf16 v[36:39], v[40:43], v[136:143], v2
    ds_read_b128 v[40:43], v13 offset:8192
    v_smfmac_f32_16x16x64_bf16 v[24:27], v[44:47], a[136:143], v2
    v_smfmac_f32_16x16x64_bf16 v[28:31], v[44:47], a[200:207], v2
    v_smfmac_f32_16x16x64_bf16 v[32:35], v[44:47], v[144:151], v2
    v_smfmac_f32_16x16x64_bf16 v[36:39], v[44:47], v[152:159], v2
    ds_read_b128 v[44:47], v13 offset:9216
    v_smfmac_f32_16x16x64_bf16 v[24:27], v[48:51], a[144:151], v2
    v_smfmac_f32_16x16x64_bf16 v[28:31], v[48:51], a[208:215], v2
    v_smfmac_f32_16x16x64_bf16 v[32:35], v[48:51], v[160:167], v2
    v_smfmac_f32_16x16x64_bf16 v[36:39], v[48:51], v[168:175], v2
    ds_read_b128 v[48:51], v13 offset:10240
    v_smfmac_f32_16x16x64_bf16 v[24:27], v[52:55], a[152:159], v2
    v_smfmac_f32_16x16x64_bf16 v[28:31], v[52:55], a[216:223], v2
    v_smfmac_f32_16x16x64_bf16 v[32:35], v[52:55], v[176:183], v2
    v_smfmac_f32_16x16x64_bf16 v[36:39], v[52:55], v[184:191], v2
    ds_read_b128 v[52:55], v13 offset:11264
    s_waitcnt lgkmcnt(3)
    v_smfmac_f32_16x16x64_bf16 v[24:27], v[40:43], a[160:167], v2
    v_smfmac_f32_16x16x64_bf16 v[28:31], v[40:43], a[224:231], v2
    v_smfmac_f32_16x16x64_bf16 v[32:35], v[40:43], v[56:63], v2
    v_smfmac_f32_16x16x64_bf16 v[36:39], v[40:43], v[64:71], v2
    ds_read_b128 v[56:59], v7 offset:36864
    ds_read_b128 v[60:63], v7 offset:37888
    ds_read_b128 v[64:67], v7 offset:38912
    ds_read_b128 v[68:71], v7 offset:39936
    s_waitcnt lgkmcnt(6)
    v_smfmac_f32_16x16x64_bf16 v[24:27], v[44:47], a[168:175], v2
    v_smfmac_f32_16x16x64_bf16 v[28:31], v[44:47], a[232:239], v2
    v_smfmac_f32_16x16x64_bf16 v[32:35], v[44:47], v[72:79], v2
    v_smfmac_f32_16x16x64_bf16 v[36:39], v[44:47], v[80:87], v2
    s_waitcnt lgkmcnt(5)
    v_smfmac_f32_16x16x64_bf16 v[24:27], v[48:51], a[176:183], v2
    v_smfmac_f32_16x16x64_bf16 v[28:31], v[48:51], a[240:247], v2
    v_smfmac_f32_16x16x64_bf16 v[32:35], v[48:51], v[88:95], v2
    v_smfmac_f32_16x16x64_bf16 v[36:39], v[48:51], v[96:103], v2
    s_waitcnt lgkmcnt(4)
    v_smfmac_f32_16x16x64_bf16 v[24:27], v[52:55], a[184:191], v2
    v_smfmac_f32_16x16x64_bf16 v[28:31], v[52:55], a[248:255], v2
    s_waitcnt lgkmcnt(2)
    v_smfmac_f32_16x16x64_bf16 v[32:35], v[52:55], v[56:63], v2
    s_waitcnt lgkmcnt(0)
    v_smfmac_f32_16x16x64_bf16 v[36:39], v[52:55], v[64:71], v2
    v_add_f32 v24, v24, v26
    v_add_f32 v28, v28, v30
    v_add_f32 v25, v25, v27
    v_add_f32 v29, v29, v31
    v_cvt_pk_bf16_f32 v24, v24, v28
    v_cvt_pk_bf16_f32 v25, v25, v29
    ds_write2_b32 v14, v24, v25 offset0:0 offset1:72
    v_add_f32 v32, v32, v34
    v_add_f32 v33, v33, v35
    v_cvt_pk_bf16_f32 v106, v32, v33
    v_add_f32 v36, v36, v38
    v_add_f32 v37, v37, v39
    v_cvt_pk_bf16_f32 v107, v36, v37
    buffer_store_dwordx2 v[106:107], v0, s[68:71], s19 offen sc1
    s_waitcnt lgkmcnt(0)
    s_barrier
    ds_read_b128 v[72:75], v5 offset:128
    s_waitcnt lgkmcnt(0)
    buffer_store_dwordx4 v[72:75], v1, s[68:71], s18 offen sc1
    s_waitcnt vmcnt(0)
    s_barrier
    s_endpgm
L_cl_3:
    ds_read_b128 v[56:59], v7 offset:0
    ds_read_b128 v[60:63], v7 offset:1024
    ds_read_b128 v[64:67], v7 offset:2048
    ds_read_b128 v[68:71], v7 offset:3072
    ds_read_b128 v[72:75], v7 offset:4096
    ds_read_b128 v[76:79], v7 offset:5120
    ds_read_b128 v[80:83], v7 offset:6144
    ds_read_b128 v[84:87], v7 offset:7168
    ds_read_b128 v[16:19], v12 offset:256
    ds_read_b128 v[20:23], v12 offset:256
    ds_read_b128 v[32:35], v12 offset:256
    ds_read_b128 v[36:39], v12 offset:256
    v_mov_b32 v104, 1
    s_mov_b32 m0, s91
    s_mov_b32 s15, 1048576
    buffer_load_dwordx4 v[24:27], v1, s[68:71], s17 offen offset:0 sc1
    buffer_load_dwordx4 v[28:31], v1, s[68:71], s17 offen offset:1024 sc1
L_chk_f3:
    buffer_load_dwordx4 v[88:91], v1, s[68:71], s17 offen offset:0 sc1
    buffer_load_dwordx4 v[92:95], v1, s[68:71], s17 offen offset:1024 sc1
    s_waitcnt vmcnt(2)
    ds_write_b128 v13, v[24:27] offset:10240
    ds_write_b128 v13, v[28:31] offset:11264
    v_max3_u32 v111, v24, v25, v26
    v_max3_u32 v110, v27, v28, v29
    v_max3_u32 v111, v111, v30, v31
    v_max_u32 v111, v111, v110
    v_cmp_eq_u32 vcc, -1, v111
    s_cbranch_vccz L_bar1_f3
    buffer_load_dwordx4 v[24:27], v1, s[68:71], s17 offen offset:0 sc1
    buffer_load_dwordx4 v[28:31], v1, s[68:71], s17 offen offset:1024 sc1
    s_waitcnt vmcnt(2)
    ds_write_b128 v13, v[88:91] offset:10240
    ds_write_b128 v13, v[92:95] offset:11264
    v_max3_u32 v111, v88, v89, v90
    v_max3_u32 v110, v91, v92, v93
    v_max3_u32 v111, v111, v94, v95
    v_max_u32 v111, v111, v110
    v_cmp_eq_u32 vcc, -1, v111
    s_cbranch_vccnz L_mre_104
L_bar1_f3:
    s_cmp_eq_u32 s14, 63
    s_waitcnt lgkmcnt(0)
    s_barrier
    ds_read_b128 v[40:43], v13 offset:0
    ds_read_b128 v[44:47], v13 offset:1024
    ds_read_b128 v[48:51], v13 offset:2048
    ds_read_b128 v[52:55], v13 offset:3072
    s_cbranch_scc1 L_last_f3
    buffer_store_dwordx2 v[106:107], v0, s[68:71], s29 offen sc1
    s_waitcnt lgkmcnt(3)
    v_smfmac_f32_16x16x64_bf16 v[16:19], v[40:43], a[0:7], v2
    v_smfmac_f32_16x16x64_bf16 v[20:23], v[40:43], a[64:71], v2
    s_mov_b64 exec, 1
    buffer_store_dword v104, off, s[68:71], s30 sc1
    s_mov_b64 exec, -1
    s_waitcnt lgkmcnt(2)
    v_smfmac_f32_16x16x64_bf16 v[16:19], v[44:47], a[8:15], v2
    ds_read_b128 v[40:43], v13 offset:8192
    v_smfmac_f32_16x16x64_bf16 v[20:23], v[44:47], a[72:79], v2
    buffer_load_dwordx4 v1, s[68:71], s26 offen offset:0 sc1 lds
    s_waitcnt lgkmcnt(2)
    v_smfmac_f32_16x16x64_bf16 v[16:19], v[48:51], a[16:23], v2
    ds_read_b128 v[44:47], v13 offset:9216
    v_smfmac_f32_16x16x64_bf16 v[20:23], v[48:51], a[80:87], v2
    ds_read_b128 v[48:51], v13 offset:10240
    s_waitcnt lgkmcnt(3)
    v_smfmac_f32_16x16x64_bf16 v[16:19], v[52:55], a[24:31], v2
    s_waitcnt vmcnt(3)
    s_nop 0
    ds_read_b128 v[24:27], v5 offset:192
    v_smfmac_f32_16x16x64_bf16 v[20:23], v[52:55], a[88:95], v2
    buffer_load_dwordx4 v1, s[68:71], s26 offen offset:1024 sc1 lds
    s_waitcnt lgkmcnt(3)
    v_smfmac_f32_16x16x64_bf16 v[16:19], v[40:43], a[32:39], v2
    ds_read_b128 v[28:31], v12 offset:512
    v_smfmac_f32_16x16x64_bf16 v[20:23], v[40:43], a[96:103], v2
    ds_read_b128 v[88:91], v7 offset:32768
    v_smfmac_f32_16x16x64_bf16 v[32:35], v[40:43], v[56:63], v2
    ds_read_b128 v[92:95], v7 offset:33792
    v_smfmac_f32_16x16x64_bf16 v[36:39], v[40:43], v[64:71], v2
    buffer_load_dwordx4 v1, s[68:71], s26 offen offset:2048 sc1 lds
    s_waitcnt lgkmcnt(2)
    buffer_store_dwordx4 v[28:31], v1, s[68:71], s84 offen
    v_smfmac_f32_16x16x64_bf16 v[16:19], v[44:47], a[40:47], v2
    ds_read_b128 v[52:55], v13 offset:11264
    v_smfmac_f32_16x16x64_bf16 v[20:23], v[44:47], a[104:111], v2
    ds_read_b128 v[96:99], v7 offset:34816
    v_smfmac_f32_16x16x64_bf16 v[32:35], v[44:47], v[72:79], v2
    ds_read_b128 v[56:59], v7 offset:36864
    buffer_store_dwordx4 v[24:27], v1, s[68:71], s28 offen sc1
    v_smfmac_f32_16x16x64_bf16 v[36:39], v[44:47], v[80:87], v2
    buffer_load_dwordx4 v1, s[68:71], s26 offen offset:3072 sc1 lds
    ds_read_b128 v[100:103], v7 offset:35840
    ds_read_b128 v[24:27], v12 offset:256
    v_smfmac_f32_16x16x64_bf16 v[16:19], v[48:51], a[48:55], v2
    ds_read_b128 v[60:63], v7 offset:37888
    buffer_store_dwordx4 v[28:31], v1, s[68:71], s84 offen offset:1024
    s_nop 1
    ds_read_b128 v[28:31], v12 offset:256
    v_smfmac_f32_16x16x64_bf16 v[20:23], v[48:51], a[112:119], v2
    ds_read_b128 v[64:67], v7 offset:38912
    s_waitcnt lgkmcnt(7)
    v_smfmac_f32_16x16x64_bf16 v[16:19], v[52:55], a[56:63], v2
    ds_read_b128 v[68:71], v7 offset:39936
    v_smfmac_f32_16x16x64_bf16 v[20:23], v[52:55], a[120:127], v2
    ds_read_b128 v[72:75], v15 offset:0
    s_waitcnt lgkmcnt(3)
    v_smfmac_f32_16x16x64_bf16 v[24:27], v[40:43], a[160:167], v2
    ds_read_b128 v[76:79], v15 offset:1024
    v_smfmac_f32_16x16x64_bf16 v[28:31], v[40:43], a[224:231], v2
    ds_read_b128 v[40:43], v13 offset:0
    v_add_f32 v16, v16, v18
    v_smfmac_f32_16x16x64_bf16 v[24:27], v[44:47], a[168:175], v2
    ds_read_b128 v[80:83], v15 offset:2048
    v_add_f32 v20, v20, v22
    v_smfmac_f32_16x16x64_bf16 v[28:31], v[44:47], a[232:239], v2
    ds_read_b128 v[44:47], v13 offset:1024
    v_add_f32 v17, v17, v19
    v_smfmac_f32_16x16x64_bf16 v[24:27], v[48:51], a[176:183], v2
    ds_read_b128 v[84:87], v15 offset:3072
    v_add_f32 v21, v21, v23
    v_smfmac_f32_16x16x64_bf16 v[28:31], v[48:51], a[240:247], v2
    v_mul_f32 v16, s31, v16
    v_smfmac_f32_16x16x64_bf16 v[32:35], v[48:51], v[88:95], v2
    v_mul_f32 v20, s31, v20
    v_smfmac_f32_16x16x64_bf16 v[36:39], v[48:51], v[96:103], v2
    ds_read_b128 v[88:91], v15 offset:4096
    v_cvt_pk_bf16_f32 v16, v16, v20
    v_smfmac_f32_16x16x64_bf16 v[24:27], v[52:55], a[184:191], v2
    ds_read_b128 v[48:51], v13 offset:2048
    v_mul_f32 v17, s31, v17
    v_smfmac_f32_16x16x64_bf16 v[28:31], v[52:55], a[248:255], v2
    ds_read_b128 v[92:95], v15 offset:5120
    v_mul_f32 v21, s31, v21
    v_smfmac_f32_16x16x64_bf16 v[32:35], v[52:55], v[56:63], v2
    ds_read_b128 v[96:99], v15 offset:6144
    s_waitcnt lgkmcnt(4)
    v_cvt_pk_bf16_f32 v17, v17, v21
    v_smfmac_f32_16x16x64_bf16 v[36:39], v[52:55], v[64:71], v2
    ds_write2_b32 v3, v16, v17 offset0:0 offset1:72
    ds_read_b128 v[52:55], v13 offset:3072
    v_smfmac_f32_16x16x64_bf16 v[24:27], v[40:43], a[128:135], v2
    ds_read_b128 v[100:103], v15 offset:7168
    v_smfmac_f32_16x16x64_bf16 v[28:31], v[40:43], a[192:199], v2
    v_smfmac_f32_16x16x64_bf16 v[24:27], v[44:47], a[136:143], v2
    s_waitcnt lgkmcnt(2)
    s_barrier
    ds_read_b128 v[56:59], v4 offset:0
    v_smfmac_f32_16x16x64_bf16 v[28:31], v[44:47], a[200:207], v2
    ds_read_b128 v[60:63], v4 offset:64
    v_smfmac_f32_16x16x64_bf16 v[24:27], v[48:51], a[144:151], v2
    ds_read_b128 v[64:67], v4 offset:128
    v_smfmac_f32_16x16x64_bf16 v[28:31], v[48:51], a[208:215], v2
    ds_read_b128 v[68:71], v4 offset:192
    s_waitcnt lgkmcnt(5)
    v_smfmac_f32_16x16x64_bf16 v[24:27], v[52:55], a[152:159], v2
    v_smfmac_f32_16x16x64_bf16 v[28:31], v[52:55], a[216:223], v2
    v_smfmac_f32_16x16x64_bf16 v[32:35], v[40:43], v[128:135], v2
    s_waitcnt lgkmcnt(3)
    v_mfma_f32_16x16x32_bf16 v[16:19], v[72:75], v[56:59], 0
    s_waitcnt lgkmcnt(2)
    v_add_f32 v24, v24, v26
    v_add_f32 v28, v28, v30
    v_mfma_f32_16x16x32_bf16 v[16:19], v[76:79], v[60:63], v[16:19]
    s_waitcnt lgkmcnt(1)
    v_add_f32 v25, v25, v27
    v_add_f32 v29, v29, v31
    v_mfma_f32_16x16x32_bf16 v[16:19], v[80:83], v[64:67], v[16:19]
    s_waitcnt lgkmcnt(0)
    v_cvt_pk_bf16_f32 v24, v24, v28
    v_cvt_pk_bf16_f32 v25, v25, v29
    v_mfma_f32_16x16x32_bf16 v[16:19], v[84:87], v[68:71], v[16:19]
    ds_write2_b32 v14, v24, v25 offset0:0 offset1:72
    v_mfma_f32_16x16x32_bf16 v[20:23], v[88:91], v[56:59], 0
    v_mfma_f32_16x16x32_bf16 v[20:23], v[92:95], v[60:63], v[20:23]
    v_exp_f32 v16, v16
    v_mfma_f32_16x16x32_bf16 v[20:23], v[96:99], v[64:67], v[20:23]
    s_waitcnt lgkmcnt(0)
    s_barrier
    ds_read_b128 v[72:75], v5 offset:0
    ds_read_b128 v[76:79], v5 offset:64
    ds_read_b128 v[80:83], v5 offset:128
    ds_read_b128 v[84:87], v5 offset:192
    v_exp_f32 v17, v17
    v_mfma_f32_16x16x32_bf16 v[20:23], v[100:103], v[68:71], v[20:23]
    ds_read_b128 v[88:91], v15 offset:14336
    v_exp_f32 v18, v18
    v_smfmac_f32_16x16x64_bf16 v[36:39], v[40:43], v[136:143], v2
    ds_read_b128 v[92:95], v15 offset:15360
    v_exp_f32 v19, v19
    v_smfmac_f32_16x16x64_bf16 v[32:35], v[44:47], v[144:151], v2
    ds_read_b128 v[100:103], v12 offset:0
    v_exp_f32 v20, v20
    v_smfmac_f32_16x16x64_bf16 v[36:39], v[44:47], v[152:159], v2
    v_exp_f32 v21, v21
    v_smfmac_f32_16x16x64_bf16 v[32:35], v[48:51], v[160:167], v2
    v_exp_f32 v22, v22
    v_smfmac_f32_16x16x64_bf16 v[36:39], v[48:51], v[168:175], v2
    v_exp_f32 v23, v23
    v_smfmac_f32_16x16x64_bf16 v[32:35], v[52:55], v[176:183], v2
    v_cvt_pk_bf16_f32 v16, v16, v17
    v_smfmac_f32_16x16x64_bf16 v[36:39], v[52:55], v[184:191], v2
    ds_read_b128 v[40:43], v12 offset:256
    s_waitcnt lgkmcnt(1)
    v_cvt_pk_bf16_f32 v17, v18, v19
    v_mfma_f32_16x16x32_bf16 v[96:99], v[72:75], v[56:59], 0
    v_cvt_pk_bf16_f32 v18, v20, v21
    v_cvt_pk_bf16_f32 v19, v22, v23
    v_mfma_f32_16x16x32_bf16 v[96:99], v[76:79], v[60:63], v[96:99]
    v_add_f32 v32, v32, v34
    v_add_f32 v33, v33, v35
    v_mfma_f32_16x16x32_bf16 v[96:99], v[80:83], v[64:67], v[96:99]
    v_cvt_pk_bf16_f32 v106, v32, v33
    v_add_f32 v36, v36, v38
    v_mfma_f32_16x16x32_bf16 v[96:99], v[84:87], v[68:71], v[96:99]
    v_add_f32 v37, v37, v39
    v_cvt_pk_bf16_f32 v107, v36, v37
    v_mfma_f32_16x16x32_bf16 v[20:23], v[100:103], v[16:19], 0
    ds_read_b128 v[44:47], v12 offset:256
    v_mfma_f32_16x16x32_bf16 v[24:27], v[88:91], v[16:19], 0
    v_exp_f32 v96, v96
    v_exp_f32 v97, v97
    v_mfma_f32_16x16x32_bf16 v[28:31], v[92:95], v[16:19], 0
    ds_read_b128 v[48:51], v12 offset:256
    v_cvt_pk_bf16_f32 v104, v96, v97
    v_cvt_pk_bf16_f32 v109, v96, v97
    s_nop 0
    v_mfma_f32_16x16x16_bf16 v[20:23], v[100:101], v[104:105], v[20:23]
    ds_read_b128 v[52:55], v12 offset:256
    v_mfma_f32_16x16x16_bf16 v[24:27], v[106:107], v[104:105], v[24:27]
    ds_read_b128 v[72:75], v8 offset:0
    v_mfma_f32_16x16x16_bf16 v[28:31], v[106:107], v[108:109], v[28:31]
    ds_read_b128 v[76:79], v8 offset:1024
    v_rcp_f32 v110, v20
    s_nop 0
    v_max_f32 v21, v20, v110
    v_cmp_ngt_f32 vcc, s32, v21
L_smback_106:
    v_pk_mul_f32 v[24:25], v[24:25], v[110:111] op_sel_hi:[1,0]
    v_pk_mul_f32 v[26:27], v[26:27], v[110:111] op_sel_hi:[1,0]
    v_pk_mul_f32 v[28:29], v[28:29], v[110:111] op_sel_hi:[1,0]
    v_pk_mul_f32 v[30:31], v[30:31], v[110:111] op_sel_hi:[1,0]
    s_mov_b64 exec, s[88:89]
    v_cvt_pk_bf16_f32 v24, v24, v25
    v_cvt_pk_bf16_f32 v25, v26, v27
    v_cvt_pk_bf16_f32 v26, v28, v29
    v_cvt_pk_bf16_f32 v27, v30, v31
    ds_write_b128 v6, v[24:27]
    s_mov_b64 exec, -1
    s_cbranch_vccnz L_slowsm_105
    ds_read_b128 v[80:83], v8 offset:4096
    ds_read_b128 v[84:87], v8 offset:5120
    s_waitcnt lgkmcnt(2)
    s_barrier
    ds_read_b128 v[24:27], v13 offset:16384
    ds_read_b128 v[28:31], v13 offset:17408
    ds_read_b128 v[56:59], v12 offset:256
    ds_read_b128 v[60:63], v12 offset:256
    ds_read_b128 v[88:91], v8 offset:2048
    s_waitcnt lgkmcnt(4)
    v_smfmac_f32_16x16x64_bf16 v[40:43], v[24:27], v[192:199], v2
    ds_read_b128 v[92:95], v8 offset:3072
    v_smfmac_f32_16x16x64_bf16 v[44:47], v[24:27], v[208:215], v2
    ds_read_b128 v[96:99], v8 offset:6144
    s_waitcnt lgkmcnt(5)
    v_smfmac_f32_16x16x64_bf16 v[40:43], v[28:31], v[200:207], v2
    ds_read_b128 v[100:103], v8 offset:7168
    s_mov_b32 s11, s24
    v_smfmac_f32_16x16x64_bf16 v[44:47], v[28:31], v[216:223], v2
    ds_read_b128 v[64:67], v12 offset:256
    s_mov_b32 s12, s23
    v_smfmac_f32_16x16x64_bf16 v[48:51], v[24:27], v[224:231], v2
    ds_read_b128 v[68:71], v12 offset:256
    v_add_f32 v40, v40, v42
    v_add_f32 v41, v41, v43
    v_smfmac_f32_16x16x64_bf16 v[52:55], v[24:27], v[240:247], v2
    ds_read_b128 v[32:35], v8 offset:32768
    v_add_f32 v44, v44, v46
    v_smfmac_f32_16x16x64_bf16 v[48:51], v[28:31], v[232:239], v2
    ds_read_b128 v[36:39], v8 offset:33792
    v_add_f32 v45, v45, v47
    v_smfmac_f32_16x16x64_bf16 v[52:55], v[28:31], v[248:255], v2
    ds_read_b128 v[16:19], v8 offset:34816
    s_waitcnt lgkmcnt(9)
    v_cvt_pk_bf16_f32 v40, v40, v44
    v_smfmac_f32_16x16x64_bf16 v[56:59], v[24:27], v[72:79], v2
    ds_read_b128 v[20:23], v8 offset:35840
    v_cvt_pk_bf16_f32 v41, v41, v45
    v_add_f32 v48, v48, v50
    v_add_f32 v49, v49, v51
    v_smfmac_f32_16x16x64_bf16 v[60:63], v[24:27], v[80:87], v2
    s_waitcnt lgkmcnt(8)
    v_add_f32 v52, v52, v54
    v_add_f32 v53, v53, v55
    v_smfmac_f32_16x16x64_bf16 v[56:59], v[28:31], v[88:95], v2
    v_cvt_pk_bf16_f32 v42, v48, v52
    v_cvt_pk_bf16_f32 v43, v49, v53
    buffer_store_dwordx4 v[40:43], v9, s[68:71], s85 offen
    s_waitcnt lgkmcnt(6)
    v_smfmac_f32_16x16x64_bf16 v[60:63], v[28:31], v[96:103], v2
    s_mov_b32 s13, s22
    s_mov_b32 s15, 1048576
    s_waitcnt lgkmcnt(4)
    v_smfmac_f32_16x16x64_bf16 v[64:67], v[24:27], v[112:119], v2
    s_waitcnt lgkmcnt(2)
    v_add_f32 v56, v56, v58
    v_add_f32 v57, v57, v59
    v_smfmac_f32_16x16x64_bf16 v[64:67], v[28:31], v[32:39], v2
    ds_read_b128 v[88:91], v13 offset:26880
    v_add_f32 v60, v60, v62
    v_smfmac_f32_16x16x64_bf16 v[68:71], v[24:27], v[120:127], v2
    s_mov_b32 s10, s27
    s_waitcnt lgkmcnt(1)
    v_add_f32 v61, v61, v63
    v_smfmac_f32_16x16x64_bf16 v[68:71], v[28:31], v[16:23], v2
    v_cvt_pk_bf16_f32 v56, v56, v60
    v_cvt_pk_bf16_f32 v57, v57, v61
    v_pk_add_f32 v[64:65], v[64:65], v[66:67]
    s_nop 2
    v_pk_add_f32 v[68:69], v[68:69], v[70:71]
    v_cvt_pk_bf16_f32 v58, v64, v68
    v_cvt_pk_bf16_f32 v59, v65, v69
    buffer_store_dwordx4 v[56:59], v9, s[68:71], s86 offen
    s_nop 1
    ds_read_b128 v[56:59], v7 offset:0
    ds_read_b128 v[60:63], v7 offset:1024
    ds_read_b128 v[64:67], v7 offset:2048
    ds_read_b128 v[68:71], v7 offset:3072
    ds_read_b128 v[72:75], v7 offset:4096
    ds_read_b128 v[76:79], v7 offset:5120
    ds_read_b128 v[80:83], v7 offset:6144
    ds_read_b128 v[84:87], v7 offset:7168
    ds_read_b128 v[16:19], v12 offset:256
    ds_read_b128 v[20:23], v12 offset:256
    ds_read_b128 v[32:35], v12 offset:256
    ds_read_b128 v[36:39], v12 offset:256
    s_mov_b32 s7, s23
    s_mov_b32 s23, s24
    s_mov_b32 s24, s25
    s_mov_b32 s25, s7
    s_add_u32 s17, s23, s16
    s_add_u32 s21, s21, 1
    s_mov_b32 s87, 262144
    s_cmp_eq_u32 s21, 3
    s_cselect_b32 s87, 0xfff80000, s87
    s_cselect_b32 s21, 0, s21
    s_add_u32 s85, s85, s87
    s_add_u32 s86, s86, s87
    s_add_u32 s22, s22, s87
    s_add_u32 s84, s84, s90
    s_mov_b32 s90, s87
    s_add_u32 s14, s14, 1
    s_mov_b32 s28, s18
    s_mov_b32 s29, s19
    s_add_u32 s18, s18, 131072
    s_add_u32 s19, s19, 65536
    s_mov_b32 s30, s20
    s_mov_b32 s20, s33
    s_add_u32 s33, s33, 128
    v_mov_b32 v104, 1
    s_add_u32 s27, s27, 128
    s_xor_b32 s91, s91, 16384
    s_add_u32 s26, s26, 262144
    s_mov_b32 m0, s91
    buffer_load_dwordx4 v[40:43], v1, s[68:71], s13 offen sc1
    buffer_load_dwordx4 v[44:47], v1, s[68:71], s13 offen offset:1024 sc1
    s_nop 7
    s_nop 7
    v_xor_b32 v15, 0x4000, v15
    s_nop 7
    s_nop 7
    v_mov_b32 v111, -1
    s_waitcnt lgkmcnt(12)
L_ra_107:
    buffer_load_dwordx4 v[48:51], v1, s[68:71], s13 offen sc1
    buffer_load_dwordx4 v[52:55], v1, s[68:71], s13 offen offset:1024 sc1
    s_waitcnt vmcnt(3)
    v_mfma_f32_16x16x32_bf16 v[92:95], v[88:91], v[40:43], 0
    s_waitcnt vmcnt(2)
    v_mfma_f32_16x16x32_bf16 v[92:95], v[88:91], v[44:47], v[92:95]
    s_nop 7
    v_cmp_u_f32 vcc, v92, v93
    v_add_f32_dpp v92, v92, v92 row_ror:4 row_mask:0xf bank_mask:0xf
    v_add_f32_dpp v93, v93, v93 row_ror:4 row_mask:0xf bank_mask:0xf
    s_cbranch_vccz L_rdone_109
    buffer_load_dwordx4 v[40:43], v1, s[68:71], s13 offen sc1
    buffer_load_dwordx4 v[44:47], v1, s[68:71], s13 offen offset:1024 sc1
    s_waitcnt vmcnt(3)
    v_mfma_f32_16x16x32_bf16 v[92:95], v[88:91], v[48:51], 0
    s_waitcnt vmcnt(2)
    v_mfma_f32_16x16x32_bf16 v[92:95], v[88:91], v[52:55], v[92:95]
    s_nop 7
    v_cmp_u_f32 vcc, v92, v93
    v_add_f32_dpp v92, v92, v92 row_ror:4 row_mask:0xf bank_mask:0xf
    v_add_f32_dpp v93, v93, v93 row_ror:4 row_mask:0xf bank_mask:0xf
    s_cbranch_vccnz L_rslow_108
L_rdone_109:
    v_add_f32_dpp v92, v92, v92 row_ror:8 row_mask:0xf bank_mask:0xf
    v_add_f32_dpp v93, v93, v93 row_ror:8 row_mask:0xf bank_mask:0xf
    v_cvt_pk_bf16_f32 v110, v92, v93
    v_min_u32 v110, 0xfffffffe, v110
    buffer_store_dword v110, v10, s[68:71], s11 offen
    buffer_store_dword v111, v10, s[68:71], s12 offen
L_kvok_110:
    s_mov_b32 s15, 1048576
    s_nop 7
    s_nop 7
    s_nop 7
    s_nop 7
    s_nop 7
    s_nop 7
    buffer_load_dwordx4 v[24:27], v1, s[68:71], s17 offen offset:0 sc1
    buffer_load_dwordx4 v[28:31], v1, s[68:71], s17 offen offset:1024 sc1
    s_nop 7
    s_nop 7
    s_nop 7
    s_nop 7
    s_branch L_chk_f3
L_mre_104:
    s_sub_u32 s15, s15, 1
    s_cmp_lg_u32 s15, 0
    s_cbranch_scc1 L_chk_f3
    s_branch L_err_8
L_rslow_108:
    s_sub_u32 s15, s15, 1
    s_cmp_eq_u32 s15, 0
    s_cbranch_scc1 L_err_10
    s_and_b32 s7, s15, 3
    s_cmp_lg_u32 s7, 0
    s_cbranch_scc1 L_ra_107
    s_mov_b64 s[98:99], 0
    v_mov_b32 v110, 0xffbfffbf
    v_cmp_eq_u32 vcc, v110, v48
    s_nop 0
    s_or_b64 s[98:99], s[98:99], vcc
    v_cmp_eq_u32 vcc, v110, v49
    s_nop 0
    s_or_b64 s[98:99], s[98:99], vcc
    v_cmp_eq_u32 vcc, v110, v50
    s_nop 0
    s_or_b64 s[98:99], s[98:99], vcc
    v_cmp_eq_u32 vcc, v110, v51
    s_nop 0
    s_or_b64 s[98:99], s[98:99], vcc
    v_cmp_eq_u32 vcc, v110, v52
    s_nop 0
    s_or_b64 s[98:99], s[98:99], vcc
    v_cmp_eq_u32 vcc, v110, v53
    s_nop 0
    s_or_b64 s[98:99], s[98:99], vcc
    v_cmp_eq_u32 vcc, v110, v54
    s_nop 0
    s_or_b64 s[98:99], s[98:99], vcc
    v_cmp_eq_u32 vcc, v110, v55
    s_nop 0
    s_or_b64 s[98:99], s[98:99], vcc
    s_cmp_eq_u64 s[98:99], 0
    s_cbranch_scc1 L_rdone_109
    s_branch L_ra_107
L_slowsm_105:
    s_waitcnt lgkmcnt(0)
    ds_read_b128 v[72:75], v15 offset:0
    ds_read_b128 v[88:91], v15 offset:4096
    ds_read_b128 v[76:79], v15 offset:1024
    ds_read_b128 v[92:95], v15 offset:5120
    ds_read_b128 v[80:83], v15 offset:2048
    ds_read_b128 v[96:99], v15 offset:6144
    ds_read_b128 v[84:87], v15 offset:3072
    ds_read_b128 v[100:103], v15 offset:7168
    s_waitcnt lgkmcnt(0)
    v_mfma_f32_16x16x32_bf16 v[16:19], v[72:75], v[56:59], 0
    v_mfma_f32_16x16x32_bf16 v[16:19], v[76:79], v[60:63], v[16:19]
    v_mfma_f32_16x16x32_bf16 v[16:19], v[80:83], v[64:67], v[16:19]
    v_mfma_f32_16x16x32_bf16 v[16:19], v[84:87], v[68:71], v[16:19]
    v_mfma_f32_16x16x32_bf16 v[20:23], v[88:91], v[56:59], 0
    v_mfma_f32_16x16x32_bf16 v[20:23], v[92:95], v[60:63], v[20:23]
    v_mfma_f32_16x16x32_bf16 v[20:23], v[96:99], v[64:67], v[20:23]
    v_mfma_f32_16x16x32_bf16 v[20:23], v[100:103], v[68:71], v[20:23]
    ds_read_b128 v[72:75], v5 offset:0
    ds_read_b128 v[76:79], v5 offset:64
    ds_read_b128 v[80:83], v5 offset:128
    ds_read_b128 v[84:87], v5 offset:192
    ds_read_b128 v[88:91], v15 offset:14336
    ds_read_b128 v[92:95], v15 offset:15360
    ds_read_b128 v[100:103], v12 offset:0
    s_waitcnt lgkmcnt(0)
    v_mfma_f32_16x16x32_bf16 v[96:99], v[72:75], v[56:59], 0
    v_mfma_f32_16x16x32_bf16 v[96:99], v[76:79], v[60:63], v[96:99]
    v_mfma_f32_16x16x32_bf16 v[96:99], v[80:83], v[64:67], v[96:99]
    v_mfma_f32_16x16x32_bf16 v[96:99], v[84:87], v[68:71], v[96:99]
    v_max3_f32 v110, v16, v17, v18
    v_max3_f32 v110, v110, v19, v20
    v_max3_f32 v110, v110, v21, v22
    v_max_f32 v110, v110, v23
    s_nop 2
    v_max3_f32 v110, v110, v96, v97
    v_mov_b32 v98, v110
    s_nop 1
    v_permlane16_swap_b32 v110, v98
    v_max_f32 v110, v110, v98
    v_mov_b32 v98, v110
    s_nop 1
    v_permlane32_swap_b32 v110, v98
    v_max_f32 v110, v110, v98
    v_sub_f32 v16, v16, v110
    v_exp_f32 v16, v16
    v_sub_f32 v17, v17, v110
    v_exp_f32 v17, v17
    v_sub_f32 v18, v18, v110
    v_exp_f32 v18, v18
    v_sub_f32 v19, v19, v110
    v_exp_f32 v19, v19
    v_sub_f32 v20, v20, v110
    v_exp_f32 v20, v20
    v_sub_f32 v21, v21, v110
    v_exp_f32 v21, v21
    v_sub_f32 v22, v22, v110
    v_exp_f32 v22, v22
    v_sub_f32 v23, v23, v110
    v_exp_f32 v23, v23
    v_sub_f32 v96, v96, v110
    v_exp_f32 v96, v96
    v_sub_f32 v97, v97, v110
    v_exp_f32 v97, v97
    v_cvt_pk_bf16_f32 v16, v16, v17
    v_cvt_pk_bf16_f32 v17, v18, v19
    v_cvt_pk_bf16_f32 v18, v20, v21
    v_cvt_pk_bf16_f32 v19, v22, v23
    v_cvt_pk_bf16_f32 v104, v96, v97
    v_cvt_pk_bf16_f32 v109, v96, v97
    v_mfma_f32_16x16x32_bf16 v[20:23], v[100:103], v[16:19], 0
    v_mfma_f32_16x16x32_bf16 v[24:27], v[88:91], v[16:19], 0
    v_mfma_f32_16x16x32_bf16 v[28:31], v[92:95], v[16:19], 0
    v_mfma_f32_16x16x16_bf16 v[20:23], v[100:101], v[104:105], v[20:23]
    v_mfma_f32_16x16x16_bf16 v[24:27], v[106:107], v[104:105], v[24:27]
    v_mfma_f32_16x16x16_bf16 v[28:31], v[106:107], v[108:109], v[28:31]
    ds_read_b128 v[72:75], v8 offset:0
    ds_read_b128 v[76:79], v8 offset:1024
    ds_read_b128 v[80:83], v8 offset:4096
    ds_read_b128 v[84:87], v8 offset:5120
    ds_read_b128 v[88:91], v8 offset:2048
    ds_read_b128 v[92:95], v8 offset:3072
    ds_read_b128 v[96:99], v8 offset:6144
    ds_read_b128 v[100:103], v8 offset:7168
    v_rcp_f32 v110, v20
    s_waitcnt lgkmcnt(0)
    s_mov_b64 vcc, 0
    s_nop 7
    s_branch L_smback_106
L_last_f3:
    buffer_store_dwordx2 v[106:107], v0, s[68:71], s29 offen sc1
    s_mov_b64 exec, 1
    buffer_store_dword v104, off, s[68:71], s30 sc1
    s_mov_b64 exec, -1
    ds_read_b128 v[16:19], v5 offset:192
    s_waitcnt vmcnt(2)
    ds_read_b128 v[88:91], v7 offset:32768
    ds_read_b128 v[92:95], v7 offset:33792
    ds_read_b128 v[96:99], v7 offset:34816
    ds_read_b128 v[100:103], v7 offset:35840
    ds_read_b128 v[24:27], v12 offset:256
    ds_read_b128 v[28:31], v12 offset:256
    s_waitcnt lgkmcnt(0)
    buffer_store_dwordx4 v[16:19], v1, s[68:71], s28 offen sc1
    s_barrier
    v_smfmac_f32_16x16x64_bf16 v[24:27], v[40:43], a[128:135], v2
    v_smfmac_f32_16x16x64_bf16 v[28:31], v[40:43], a[192:199], v2
    v_smfmac_f32_16x16x64_bf16 v[32:35], v[40:43], v[128:135], v2
    v_smfmac_f32_16x16x64_bf16 v[36:39], v[40:43], v[136:143], v2
    ds_read_b128 v[40:43], v13 offset:8192
    v_smfmac_f32_16x16x64_bf16 v[24:27], v[44:47], a[136:143], v2
    v_smfmac_f32_16x16x64_bf16 v[28:31], v[44:47], a[200:207], v2
    v_smfmac_f32_16x16x64_bf16 v[32:35], v[44:47], v[144:151], v2
    v_smfmac_f32_16x16x64_bf16 v[36:39], v[44:47], v[152:159], v2
    ds_read_b128 v[44:47], v13 offset:9216
    v_smfmac_f32_16x16x64_bf16 v[24:27], v[48:51], a[144:151], v2
    v_smfmac_f32_16x16x64_bf16 v[28:31], v[48:51], a[208:215], v2
    v_smfmac_f32_16x16x64_bf16 v[32:35], v[48:51], v[160:167], v2
    v_smfmac_f32_16x16x64_bf16 v[36:39], v[48:51], v[168:175], v2
    ds_read_b128 v[48:51], v13 offset:10240
    v_smfmac_f32_16x16x64_bf16 v[24:27], v[52:55], a[152:159], v2
    v_smfmac_f32_16x16x64_bf16 v[28:31], v[52:55], a[216:223], v2
    v_smfmac_f32_16x16x64_bf16 v[32:35], v[52:55], v[176:183], v2
    v_smfmac_f32_16x16x64_bf16 v[36:39], v[52:55], v[184:191], v2
    ds_read_b128 v[52:55], v13 offset:11264
    s_waitcnt lgkmcnt(3)
    v_smfmac_f32_16x16x64_bf16 v[24:27], v[40:43], a[160:167], v2
    v_smfmac_f32_16x16x64_bf16 v[28:31], v[40:43], a[224:231], v2
    v_smfmac_f32_16x16x64_bf16 v[32:35], v[40:43], v[56:63], v2
    v_smfmac_f32_16x16x64_bf16 v[36:39], v[40:43], v[64:71], v2
    ds_read_b128 v[56:59], v7 offset:36864
    ds_read_b128 v[60:63], v7 offset:37888
    ds_read_b128 v[64:67], v7 offset:38912
    ds_read_b128 v[68:71], v7 offset:39936
    s_waitcnt lgkmcnt(6)
    v_smfmac_f32_16x16x64_bf16 v[24:27], v[44:47], a[168:175], v2
    v_smfmac_f32_16x16x64_bf16 v[28:31], v[44:47], a[232:239], v2
    v_smfmac_f32_16x16x64_bf16 v[32:35], v[44:47], v[72:79], v2
    v_smfmac_f32_16x16x64_bf16 v[36:39], v[44:47], v[80:87], v2
    s_waitcnt lgkmcnt(5)
    v_smfmac_f32_16x16x64_bf16 v[24:27], v[48:51], a[176:183], v2
    v_smfmac_f32_16x16x64_bf16 v[28:31], v[48:51], a[240:247], v2
    v_smfmac_f32_16x16x64_bf16 v[32:35], v[48:51], v[88:95], v2
    v_smfmac_f32_16x16x64_bf16 v[36:39], v[48:51], v[96:103], v2
    s_waitcnt lgkmcnt(4)
    v_smfmac_f32_16x16x64_bf16 v[24:27], v[52:55], a[184:191], v2
    v_smfmac_f32_16x16x64_bf16 v[28:31], v[52:55], a[248:255], v2
    s_waitcnt lgkmcnt(2)
    v_smfmac_f32_16x16x64_bf16 v[32:35], v[52:55], v[56:63], v2
    s_waitcnt lgkmcnt(0)
    v_smfmac_f32_16x16x64_bf16 v[36:39], v[52:55], v[64:71], v2
    v_add_f32 v24, v24, v26
    v_add_f32 v28, v28, v30
    v_add_f32 v25, v25, v27
    v_add_f32 v29, v29, v31
    v_cvt_pk_bf16_f32 v24, v24, v28
    v_cvt_pk_bf16_f32 v25, v25, v29
    ds_write2_b32 v14, v24, v25 offset0:0 offset1:72
    v_add_f32 v32, v32, v34
    v_add_f32 v33, v33, v35
    v_cvt_pk_bf16_f32 v106, v32, v33
    v_add_f32 v36, v36, v38
    v_add_f32 v37, v37, v39
    v_cvt_pk_bf16_f32 v107, v36, v37
    buffer_store_dwordx2 v[106:107], v0, s[68:71], s19 offen sc1
    s_waitcnt lgkmcnt(0)
    s_barrier
    ds_read_b128 v[72:75], v5 offset:192
    s_waitcnt lgkmcnt(0)
    buffer_store_dwordx4 v[72:75], v1, s[68:71], s18 offen sc1
    s_waitcnt vmcnt(0)
    s_barrier
    s_mov_b64 exec, 1
    v_mov_b32 v110, 1
    buffer_store_dword v110, off, s[68:71], s20 sc1
    buffer_store_dword v110, off, s[68:71], s33 sc1
    s_endpgm
L_cl_4:
    ds_read_b128 v[56:59], v7 offset:0
    ds_read_b128 v[60:63], v7 offset:1024
    ds_read_b128 v[64:67], v7 offset:2048
    ds_read_b128 v[68:71], v7 offset:3072
    ds_read_b128 v[72:75], v7 offset:4096
    ds_read_b128 v[76:79], v7 offset:5120
    ds_read_b128 v[80:83], v7 offset:6144
    ds_read_b128 v[84:87], v7 offset:7168
    ds_read_b128 v[16:19], v12 offset:256
    ds_read_b128 v[20:23], v12 offset:256
    ds_read_b128 v[32:35], v12 offset:256
    ds_read_b128 v[36:39], v12 offset:256
    v_mov_b32 v104, 1
    s_mov_b32 m0, s91
    s_mov_b32 s15, 1048576
    buffer_load_dwordx4 v[24:27], v1, s[68:71], s17 offen offset:0 sc1
    buffer_load_dwordx4 v[28:31], v1, s[68:71], s17 offen offset:1024 sc1
L_chk_s0:
    buffer_load_dwordx4 v[88:91], v1, s[68:71], s17 offen offset:0 sc1
    buffer_load_dwordx4 v[92:95], v1, s[68:71], s17 offen offset:1024 sc1
    s_waitcnt vmcnt(2)
    ds_write_b128 v13, v[24:27] offset:0
    ds_write_b128 v13, v[28:31] offset:1024
    v_max3_u32 v111, v24, v25, v26
    v_max3_u32 v110, v27, v28, v29
    v_max3_u32 v111, v111, v30, v31
    v_max_u32 v111, v111, v110
    v_cmp_eq_u32 vcc, -1, v111
    s_cbranch_vccz L_bar1_s0
    buffer_load_dwordx4 v[24:27], v1, s[68:71], s17 offen offset:0 sc1
    buffer_load_dwordx4 v[28:31], v1, s[68:71], s17 offen offset:1024 sc1
    s_waitcnt vmcnt(2)
    ds_write_b128 v13, v[88:91] offset:0
    ds_write_b128 v13, v[92:95] offset:1024
    v_max3_u32 v111, v88, v89, v90
    v_max3_u32 v110, v91, v92, v93
    v_max3_u32 v111, v111, v94, v95
    v_max_u32 v111, v111, v110
    v_cmp_eq_u32 vcc, -1, v111
    s_cbranch_vccnz L_mre_112
L_bar1_s0:
    s_cmp_eq_u32 s14, 63
    s_waitcnt lgkmcnt(0)
    s_barrier
    ds_read_b128 v[40:43], v13 offset:0
    ds_read_b128 v[44:47], v13 offset:1024
    ds_read_b128 v[48:51], v13 offset:2048
    ds_read_b128 v[52:55], v13 offset:3072
    s_cbranch_scc1 L_last_s0
    buffer_store_dwordx2 v[106:107], v0, s[68:71], s29 offen sc1
    s_waitcnt lgkmcnt(3)
    v_smfmac_f32_16x16x64_bf16 v[16:19], v[40:43], a[0:7], v2
    buffer_load_dwordx4 v1, s[68:71], s26 offen offset:0 sc1 lds
    v_smfmac_f32_16x16x64_bf16 v[20:23], v[40:43], a[64:71], v2
    ds_read_b128 v[40:43], v13 offset:8192
    s_waitcnt lgkmcnt(3)
    v_smfmac_f32_16x16x64_bf16 v[16:19], v[44:47], a[8:15], v2
    v_smfmac_f32_16x16x64_bf16 v[20:23], v[44:47], a[72:79], v2
    ds_read_b128 v[44:47], v13 offset:9216
    s_waitcnt lgkmcnt(3)
    v_smfmac_f32_16x16x64_bf16 v[16:19], v[48:51], a[16:23], v2
    buffer_load_dwordx4 v1, s[68:71], s26 offen offset:1024 sc1 lds
    v_smfmac_f32_16x16x64_bf16 v[20:23], v[48:51], a[80:87], v2
    ds_read_b128 v[48:51], v13 offset:10240
    s_waitcnt lgkmcnt(3)
    v_smfmac_f32_16x16x64_bf16 v[16:19], v[52:55], a[24:31], v2
    s_waitcnt vmcnt(3)
    s_nop 0
    ds_read_b128 v[24:27], v5 offset:0
    v_smfmac_f32_16x16x64_bf16 v[20:23], v[52:55], a[88:95], v2
    ds_read_b128 v[28:31], v12 offset:512
    s_waitcnt lgkmcnt(4)
    v_smfmac_f32_16x16x64_bf16 v[16:19], v[40:43], a[32:39], v2
    buffer_load_dwordx4 v1, s[68:71], s26 offen offset:2048 sc1 lds
    ds_read_b128 v[88:91], v7 offset:32768
    v_smfmac_f32_16x16x64_bf16 v[20:23], v[40:43], a[96:103], v2
    ds_read_b128 v[92:95], v7 offset:33792
    v_smfmac_f32_16x16x64_bf16 v[32:35], v[40:43], v[56:63], v2
    ds_read_b128 v[52:55], v13 offset:11264
    v_smfmac_f32_16x16x64_bf16 v[36:39], v[40:43], v[64:71], v2
    s_waitcnt lgkmcnt(3)
    buffer_store_dwordx4 v[28:31], v1, s[68:71], s84 offen sc1
    v_smfmac_f32_16x16x64_bf16 v[16:19], v[44:47], a[40:47], v2
    buffer_load_dwordx4 v1, s[68:71], s26 offen offset:3072 sc1 lds
    ds_read_b128 v[96:99], v7 offset:34816
    v_smfmac_f32_16x16x64_bf16 v[20:23], v[44:47], a[104:111], v2
    ds_read_b128 v[56:59], v7 offset:36864
    v_smfmac_f32_16x16x64_bf16 v[32:35], v[44:47], v[72:79], v2
    ds_read_b128 v[100:103], v7 offset:35840
    v_smfmac_f32_16x16x64_bf16 v[36:39], v[44:47], v[80:87], v2
    buffer_store_dwordx4 v[24:27], v1, s[68:71], s28 offen sc1
    s_nop 1
    ds_read_b128 v[24:27], v12 offset:256
    v_smfmac_f32_16x16x64_bf16 v[16:19], v[48:51], a[48:55], v2
    ds_read_b128 v[60:63], v7 offset:37888
    buffer_store_dwordx4 v[28:31], v1, s[68:71], s84 offen offset:1024 sc1
    s_nop 1
    ds_read_b128 v[28:31], v12 offset:256
    v_smfmac_f32_16x16x64_bf16 v[20:23], v[48:51], a[112:119], v2
    ds_read_b128 v[64:67], v7 offset:38912
    s_waitcnt lgkmcnt(7)
    v_smfmac_f32_16x16x64_bf16 v[16:19], v[52:55], a[56:63], v2
    ds_read_b128 v[68:71], v7 offset:39936
    v_smfmac_f32_16x16x64_bf16 v[20:23], v[52:55], a[120:127], v2
    ds_read_b128 v[72:75], v15 offset:0
    s_waitcnt lgkmcnt(3)
    v_smfmac_f32_16x16x64_bf16 v[24:27], v[40:43], a[160:167], v2
    ds_read_b128 v[76:79], v15 offset:1024
    v_smfmac_f32_16x16x64_bf16 v[28:31], v[40:43], a[224:231], v2
    ds_read_b128 v[40:43], v13 offset:0
    v_add_f32 v16, v16, v18
    v_smfmac_f32_16x16x64_bf16 v[24:27], v[44:47], a[168:175], v2
    ds_read_b128 v[80:83], v15 offset:2048
    v_add_f32 v20, v20, v22
    v_smfmac_f32_16x16x64_bf16 v[28:31], v[44:47], a[232:239], v2
    ds_read_b128 v[44:47], v13 offset:1024
    v_add_f32 v17, v17, v19
    v_smfmac_f32_16x16x64_bf16 v[24:27], v[48:51], a[176:183], v2
    ds_read_b128 v[84:87], v15 offset:3072
    v_add_f32 v21, v21, v23
    v_smfmac_f32_16x16x64_bf16 v[28:31], v[48:51], a[240:247], v2
    v_mul_f32 v16, s31, v16
    v_smfmac_f32_16x16x64_bf16 v[32:35], v[48:51], v[88:95], v2
    v_mul_f32 v20, s31, v20
    v_smfmac_f32_16x16x64_bf16 v[36:39], v[48:51], v[96:103], v2
    ds_read_b128 v[88:91], v15 offset:4096
    v_cvt_pk_bf16_f32 v16, v16, v20
    v_smfmac_f32_16x16x64_bf16 v[24:27], v[52:55], a[184:191], v2
    ds_read_b128 v[48:51], v13 offset:2048
    v_mul_f32 v17, s31, v17
    v_smfmac_f32_16x16x64_bf16 v[28:31], v[52:55], a[248:255], v2
    ds_read_b128 v[92:95], v15 offset:5120
    v_mul_f32 v21, s31, v21
    v_smfmac_f32_16x16x64_bf16 v[32:35], v[52:55], v[56:63], v2
    ds_read_b128 v[96:99], v15 offset:6144
    s_waitcnt lgkmcnt(4)
    v_cvt_pk_bf16_f32 v17, v17, v21
    v_smfmac_f32_16x16x64_bf16 v[36:39], v[52:55], v[64:71], v2
    ds_write2_b32 v3, v16, v17 offset0:0 offset1:72
    ds_read_b128 v[52:55], v13 offset:3072
    v_smfmac_f32_16x16x64_bf16 v[24:27], v[40:43], a[128:135], v2
    ds_read_b128 v[100:103], v15 offset:7168
    v_smfmac_f32_16x16x64_bf16 v[28:31], v[40:43], a[192:199], v2
    v_smfmac_f32_16x16x64_bf16 v[24:27], v[44:47], a[136:143], v2
    s_waitcnt lgkmcnt(2)
    s_barrier
    ds_read_b128 v[56:59], v4 offset:0
    v_smfmac_f32_16x16x64_bf16 v[28:31], v[44:47], a[200:207], v2
    ds_read_b128 v[60:63], v4 offset:64
    v_smfmac_f32_16x16x64_bf16 v[24:27], v[48:51], a[144:151], v2
    ds_read_b128 v[64:67], v4 offset:128
    v_smfmac_f32_16x16x64_bf16 v[28:31], v[48:51], a[208:215], v2
    ds_read_b128 v[68:71], v4 offset:192
    s_waitcnt lgkmcnt(5)
    v_smfmac_f32_16x16x64_bf16 v[24:27], v[52:55], a[152:159], v2
    v_smfmac_f32_16x16x64_bf16 v[28:31], v[52:55], a[216:223], v2
    v_smfmac_f32_16x16x64_bf16 v[32:35], v[40:43], v[128:135], v2
    s_waitcnt lgkmcnt(3)
    v_mfma_f32_16x16x32_bf16 v[16:19], v[72:75], v[56:59], 0
    s_waitcnt lgkmcnt(2)
    v_add_f32 v24, v24, v26
    v_add_f32 v28, v28, v30
    v_mfma_f32_16x16x32_bf16 v[16:19], v[76:79], v[60:63], v[16:19]
    s_waitcnt lgkmcnt(1)
    v_add_f32 v25, v25, v27
    v_add_f32 v29, v29, v31
    v_mfma_f32_16x16x32_bf16 v[16:19], v[80:83], v[64:67], v[16:19]
    s_waitcnt lgkmcnt(0)
    v_cvt_pk_bf16_f32 v24, v24, v28
    v_cvt_pk_bf16_f32 v25, v25, v29
    v_mfma_f32_16x16x32_bf16 v[16:19], v[84:87], v[68:71], v[16:19]
    ds_write2_b32 v14, v24, v25 offset0:0 offset1:72
    v_mfma_f32_16x16x32_bf16 v[20:23], v[88:91], v[56:59], 0
    v_mfma_f32_16x16x32_bf16 v[20:23], v[92:95], v[60:63], v[20:23]
    v_exp_f32 v16, v16
    v_mfma_f32_16x16x32_bf16 v[20:23], v[96:99], v[64:67], v[20:23]
    s_waitcnt lgkmcnt(0)
    s_barrier
    ds_read_b128 v[72:75], v5 offset:0
    ds_read_b128 v[76:79], v5 offset:64
    ds_read_b128 v[80:83], v5 offset:128
    ds_read_b128 v[84:87], v5 offset:192
    v_exp_f32 v17, v17
    v_mfma_f32_16x16x32_bf16 v[20:23], v[100:103], v[68:71], v[20:23]
    ds_read_b128 v[88:91], v15 offset:8192
    v_exp_f32 v18, v18
    v_smfmac_f32_16x16x64_bf16 v[36:39], v[40:43], v[136:143], v2
    ds_read_b128 v[92:95], v15 offset:9216
    v_exp_f32 v19, v19
    v_smfmac_f32_16x16x64_bf16 v[32:35], v[44:47], v[144:151], v2
    ds_read_b128 v[100:103], v12 offset:0
    v_exp_f32 v20, v20
    v_smfmac_f32_16x16x64_bf16 v[36:39], v[44:47], v[152:159], v2
    v_exp_f32 v21, v21
    v_smfmac_f32_16x16x64_bf16 v[32:35], v[48:51], v[160:167], v2
    v_exp_f32 v22, v22
    v_smfmac_f32_16x16x64_bf16 v[36:39], v[48:51], v[168:175], v2
    v_exp_f32 v23, v23
    v_smfmac_f32_16x16x64_bf16 v[32:35], v[52:55], v[176:183], v2
    v_cvt_pk_bf16_f32 v16, v16, v17
    v_smfmac_f32_16x16x64_bf16 v[36:39], v[52:55], v[184:191], v2
    ds_read_b128 v[40:43], v12 offset:256
    s_waitcnt lgkmcnt(1)
    v_cvt_pk_bf16_f32 v17, v18, v19
    v_mfma_f32_16x16x32_bf16 v[96:99], v[72:75], v[56:59], 0
    v_cvt_pk_bf16_f32 v18, v20, v21
    v_cvt_pk_bf16_f32 v19, v22, v23
    v_mfma_f32_16x16x32_bf16 v[96:99], v[76:79], v[60:63], v[96:99]
    v_add_f32 v32, v32, v34
    v_add_f32 v33, v33, v35
    v_mfma_f32_16x16x32_bf16 v[96:99], v[80:83], v[64:67], v[96:99]
    v_cvt_pk_bf16_f32 v106, v32, v33
    v_add_f32 v36, v36, v38
    v_mfma_f32_16x16x32_bf16 v[96:99], v[84:87], v[68:71], v[96:99]
    v_add_f32 v37, v37, v39
    v_cvt_pk_bf16_f32 v107, v36, v37
    v_mfma_f32_16x16x32_bf16 v[20:23], v[100:103], v[16:19], 0
    ds_read_b128 v[44:47], v12 offset:256
    v_mfma_f32_16x16x32_bf16 v[24:27], v[88:91], v[16:19], 0
    v_exp_f32 v96, v96
    v_exp_f32 v97, v97
    v_mfma_f32_16x16x32_bf16 v[28:31], v[92:95], v[16:19], 0
    ds_read_b128 v[48:51], v12 offset:256
    v_cvt_pk_bf16_f32 v104, v96, v97
    v_cvt_pk_bf16_f32 v109, v96, v97
    s_nop 0
    v_mfma_f32_16x16x16_bf16 v[20:23], v[100:101], v[104:105], v[20:23]
    ds_read_b128 v[52:55], v12 offset:256
    v_mfma_f32_16x16x16_bf16 v[24:27], v[106:107], v[104:105], v[24:27]
    ds_read_b128 v[72:75], v8 offset:0
    v_mfma_f32_16x16x16_bf16 v[28:31], v[106:107], v[108:109], v[28:31]
    ds_read_b128 v[76:79], v8 offset:1024
    v_rcp_f32 v110, v20
    s_nop 0
    v_max_f32 v21, v20, v110
    v_cmp_ngt_f32 vcc, s32, v21
L_smback_114:
    v_pk_mul_f32 v[24:25], v[24:25], v[110:111] op_sel_hi:[1,0]
    v_pk_mul_f32 v[26:27], v[26:27], v[110:111] op_sel_hi:[1,0]
    v_pk_mul_f32 v[28:29], v[28:29], v[110:111] op_sel_hi:[1,0]
    v_pk_mul_f32 v[30:31], v[30:31], v[110:111] op_sel_hi:[1,0]
    s_mov_b64 exec, s[88:89]
    v_cvt_pk_bf16_f32 v24, v24, v25
    v_cvt_pk_bf16_f32 v25, v26, v27
    v_cvt_pk_bf16_f32 v26, v28, v29
    v_cvt_pk_bf16_f32 v27, v30, v31
    ds_write_b128 v6, v[24:27]
    s_mov_b64 exec, -1
    s_cbranch_vccnz L_slowsm_113
    ds_read_b128 v[80:83], v8 offset:4096
    ds_read_b128 v[84:87], v8 offset:5120
    s_waitcnt lgkmcnt(2)
    s_barrier
    ds_read_b128 v[24:27], v13 offset:16384
    ds_read_b128 v[28:31], v13 offset:17408
    ds_read_b128 v[56:59], v12 offset:256
    ds_read_b128 v[60:63], v12 offset:256
    ds_read_b128 v[88:91], v8 offset:2048
    s_waitcnt lgkmcnt(4)
    v_smfmac_f32_16x16x64_bf16 v[40:43], v[24:27], v[192:199], v2
    ds_read_b128 v[92:95], v8 offset:3072
    v_smfmac_f32_16x16x64_bf16 v[44:47], v[24:27], v[208:215], v2
    ds_read_b128 v[96:99], v8 offset:6144
    s_waitcnt lgkmcnt(5)
    v_smfmac_f32_16x16x64_bf16 v[40:43], v[28:31], v[200:207], v2
    ds_read_b128 v[100:103], v8 offset:7168
    s_mov_b32 s11, s24
    v_smfmac_f32_16x16x64_bf16 v[44:47], v[28:31], v[216:223], v2
    ds_read_b128 v[64:67], v12 offset:256
    s_mov_b32 s12, s23
    v_smfmac_f32_16x16x64_bf16 v[48:51], v[24:27], v[224:231], v2
    ds_read_b128 v[68:71], v12 offset:256
    v_add_f32 v40, v40, v42
    v_add_f32 v41, v41, v43
    v_smfmac_f32_16x16x64_bf16 v[52:55], v[24:27], v[240:247], v2
    ds_read_b128 v[32:35], v8 offset:32768
    v_add_f32 v44, v44, v46
    v_smfmac_f32_16x16x64_bf16 v[48:51], v[28:31], v[232:239], v2
    ds_read_b128 v[36:39], v8 offset:33792
    v_add_f32 v45, v45, v47
    v_smfmac_f32_16x16x64_bf16 v[52:55], v[28:31], v[248:255], v2
    ds_read_b128 v[16:19], v8 offset:34816
    s_waitcnt lgkmcnt(9)
    v_cvt_pk_bf16_f32 v40, v40, v44
    v_smfmac_f32_16x16x64_bf16 v[56:59], v[24:27], v[72:79], v2
    ds_read_b128 v[20:23], v8 offset:35840
    v_cvt_pk_bf16_f32 v41, v41, v45
    v_add_f32 v48, v48, v50
    v_add_f32 v49, v49, v51
    v_smfmac_f32_16x16x64_bf16 v[60:63], v[24:27], v[80:87], v2
    s_waitcnt lgkmcnt(8)
    v_add_f32 v52, v52, v54
    v_add_f32 v53, v53, v55
    v_smfmac_f32_16x16x64_bf16 v[56:59], v[28:31], v[88:95], v2
    v_cvt_pk_bf16_f32 v42, v48, v52
    v_cvt_pk_bf16_f32 v43, v49, v53
    buffer_store_dwordx4 v[40:43], v9, s[68:71], s85 offen sc1
    s_waitcnt lgkmcnt(6)
    v_smfmac_f32_16x16x64_bf16 v[60:63], v[28:31], v[96:103], v2
    s_mov_b32 s13, s22
    s_mov_b32 s15, 1048576
    s_waitcnt lgkmcnt(4)
    v_smfmac_f32_16x16x64_bf16 v[64:67], v[24:27], v[112:119], v2
    s_waitcnt lgkmcnt(2)
    v_add_f32 v56, v56, v58
    v_add_f32 v57, v57, v59
    v_smfmac_f32_16x16x64_bf16 v[64:67], v[28:31], v[32:39], v2
    ds_read_b128 v[88:91], v13 offset:26880
    v_add_f32 v60, v60, v62
    v_smfmac_f32_16x16x64_bf16 v[68:71], v[24:27], v[120:127], v2
    s_mov_b32 s10, s27
    s_waitcnt lgkmcnt(1)
    v_add_f32 v61, v61, v63
    v_smfmac_f32_16x16x64_bf16 v[68:71], v[28:31], v[16:23], v2
    v_cvt_pk_bf16_f32 v56, v56, v60
    v_cvt_pk_bf16_f32 v57, v57, v61
    v_pk_add_f32 v[64:65], v[64:65], v[66:67]
    s_nop 2
    v_pk_add_f32 v[68:69], v[68:69], v[70:71]
    v_cvt_pk_bf16_f32 v58, v64, v68
    v_cvt_pk_bf16_f32 v59, v65, v69
    buffer_store_dwordx4 v[56:59], v9, s[68:71], s86 offen sc1
    s_nop 1
    ds_read_b128 v[56:59], v7 offset:0
    ds_read_b128 v[60:63], v7 offset:1024
    ds_read_b128 v[64:67], v7 offset:2048
    ds_read_b128 v[68:71], v7 offset:3072
    ds_read_b128 v[72:75], v7 offset:4096
    ds_read_b128 v[76:79], v7 offset:5120
    ds_read_b128 v[80:83], v7 offset:6144
    ds_read_b128 v[84:87], v7 offset:7168
    ds_read_b128 v[16:19], v12 offset:256
    ds_read_b128 v[20:23], v12 offset:256
    ds_read_b128 v[32:35], v12 offset:256
    ds_read_b128 v[36:39], v12 offset:256
    s_mov_b32 s7, s23
    s_mov_b32 s23, s24
    s_mov_b32 s24, s25
    s_mov_b32 s25, s7
    s_add_u32 s17, s23, s16
    s_add_u32 s21, s21, 1
    s_mov_b32 s87, 262144
    s_cmp_eq_u32 s21, 3
    s_cselect_b32 s87, 0xfff80000, s87
    s_cselect_b32 s21, 0, s21
    s_add_u32 s85, s85, s87
    s_add_u32 s86, s86, s87
    s_add_u32 s22, s22, s87
    s_add_u32 s84, s84, s90
    s_mov_b32 s90, s87
    s_add_u32 s14, s14, 1
    s_mov_b32 s28, s18
    s_mov_b32 s29, s19
    s_add_u32 s18, s18, 131072
    s_add_u32 s19, s19, 65536
    s_mov_b32 s30, s20
    s_mov_b32 s20, s33
    s_add_u32 s33, s33, 128
    v_mov_b32 v104, 1
    s_add_u32 s27, s27, 128
    s_xor_b32 s91, s91, 16384
    s_add_u32 s26, s26, 262144
    s_mov_b32 m0, s91
    buffer_load_dwordx4 v[40:43], v1, s[68:71], s13 offen sc1
    buffer_load_dwordx4 v[44:47], v1, s[68:71], s13 offen offset:1024 sc1
    s_nop 7
    s_nop 7
    v_xor_b32 v15, 0x4000, v15
    s_nop 7
    s_nop 7
    v_mov_b32 v111, -1
    s_waitcnt lgkmcnt(12)
L_ra_115:
    buffer_load_dwordx4 v[48:51], v1, s[68:71], s13 offen sc1
    buffer_load_dwordx4 v[52:55], v1, s[68:71], s13 offen offset:1024 sc1
    s_waitcnt vmcnt(3)
    v_mfma_f32_16x16x32_bf16 v[92:95], v[88:91], v[40:43], 0
    s_waitcnt vmcnt(2)
    v_mfma_f32_16x16x32_bf16 v[92:95], v[88:91], v[44:47], v[92:95]
    s_nop 7
    v_cmp_u_f32 vcc, v92, v93
    v_add_f32_dpp v92, v92, v92 row_ror:4 row_mask:0xf bank_mask:0xf
    v_add_f32_dpp v93, v93, v93 row_ror:4 row_mask:0xf bank_mask:0xf
    s_cbranch_vccz L_rdone_117
    buffer_load_dwordx4 v[40:43], v1, s[68:71], s13 offen sc1
    buffer_load_dwordx4 v[44:47], v1, s[68:71], s13 offen offset:1024 sc1
    s_waitcnt vmcnt(3)
    v_mfma_f32_16x16x32_bf16 v[92:95], v[88:91], v[48:51], 0
    s_waitcnt vmcnt(2)
    v_mfma_f32_16x16x32_bf16 v[92:95], v[88:91], v[52:55], v[92:95]
    s_nop 7
    v_cmp_u_f32 vcc, v92, v93
    v_add_f32_dpp v92, v92, v92 row_ror:4 row_mask:0xf bank_mask:0xf
    v_add_f32_dpp v93, v93, v93 row_ror:4 row_mask:0xf bank_mask:0xf
    s_cbranch_vccnz L_rslow_116
L_rdone_117:
    v_add_f32_dpp v92, v92, v92 row_ror:8 row_mask:0xf bank_mask:0xf
    v_add_f32_dpp v93, v93, v93 row_ror:8 row_mask:0xf bank_mask:0xf
    v_cvt_pk_bf16_f32 v110, v92, v93
    v_min_u32 v110, 0xfffffffe, v110
    buffer_store_dword v110, v10, s[68:71], s11 offen sc1
    buffer_store_dword v111, v10, s[68:71], s12 offen sc1
L_kvok_118:
    s_mov_b32 s15, 1048576
    s_nop 7
    s_nop 7
    s_nop 7
    s_nop 7
    s_nop 7
    s_nop 7
    buffer_load_dwordx4 v[24:27], v1, s[68:71], s17 offen offset:0 sc1
    buffer_load_dwordx4 v[28:31], v1, s[68:71], s17 offen offset:1024 sc1
    s_nop 7
    s_nop 7
    s_nop 7
    s_nop 7
    s_branch L_chk_s0
L_mre_112:
    s_sub_u32 s15, s15, 1
    s_cmp_lg_u32 s15, 0
    s_cbranch_scc1 L_chk_s0
    s_branch L_err_8
L_rslow_116:
    s_sub_u32 s15, s15, 1
    s_cmp_eq_u32 s15, 0
    s_cbranch_scc1 L_err_10
    s_and_b32 s7, s15, 3
    s_cmp_lg_u32 s7, 0
    s_cbranch_scc1 L_ra_115
    s_mov_b64 s[98:99], 0
    v_mov_b32 v110, 0xffbfffbf
    v_cmp_eq_u32 vcc, v110, v48
    s_nop 0
    s_or_b64 s[98:99], s[98:99], vcc
    v_cmp_eq_u32 vcc, v110, v49
    s_nop 0
    s_or_b64 s[98:99], s[98:99], vcc
    v_cmp_eq_u32 vcc, v110, v50
    s_nop 0
    s_or_b64 s[98:99], s[98:99], vcc
    v_cmp_eq_u32 vcc, v110, v51
    s_nop 0
    s_or_b64 s[98:99], s[98:99], vcc
    v_cmp_eq_u32 vcc, v110, v52
    s_nop 0
    s_or_b64 s[98:99], s[98:99], vcc
    v_cmp_eq_u32 vcc, v110, v53
    s_nop 0
    s_or_b64 s[98:99], s[98:99], vcc
    v_cmp_eq_u32 vcc, v110, v54
    s_nop 0
    s_or_b64 s[98:99], s[98:99], vcc
    v_cmp_eq_u32 vcc, v110, v55
    s_nop 0
    s_or_b64 s[98:99], s[98:99], vcc
    s_cmp_eq_u64 s[98:99], 0
    s_cbranch_scc1 L_rdone_117
    s_branch L_ra_115
L_slowsm_113:
    s_waitcnt lgkmcnt(0)
    ds_read_b128 v[72:75], v15 offset:0
    ds_read_b128 v[88:91], v15 offset:4096
    ds_read_b128 v[76:79], v15 offset:1024
    ds_read_b128 v[92:95], v15 offset:5120
    ds_read_b128 v[80:83], v15 offset:2048
    ds_read_b128 v[96:99], v15 offset:6144
    ds_read_b128 v[84:87], v15 offset:3072
    ds_read_b128 v[100:103], v15 offset:7168
    s_waitcnt lgkmcnt(0)
    v_mfma_f32_16x16x32_bf16 v[16:19], v[72:75], v[56:59], 0
    v_mfma_f32_16x16x32_bf16 v[16:19], v[76:79], v[60:63], v[16:19]
    v_mfma_f32_16x16x32_bf16 v[16:19], v[80:83], v[64:67], v[16:19]
    v_mfma_f32_16x16x32_bf16 v[16:19], v[84:87], v[68:71], v[16:19]
    v_mfma_f32_16x16x32_bf16 v[20:23], v[88:91], v[56:59], 0
    v_mfma_f32_16x16x32_bf16 v[20:23], v[92:95], v[60:63], v[20:23]
    v_mfma_f32_16x16x32_bf16 v[20:23], v[96:99], v[64:67], v[20:23]
    v_mfma_f32_16x16x32_bf16 v[20:23], v[100:103], v[68:71], v[20:23]
    ds_read_b128 v[72:75], v5 offset:0
    ds_read_b128 v[76:79], v5 offset:64
    ds_read_b128 v[80:83], v5 offset:128
    ds_read_b128 v[84:87], v5 offset:192
    ds_read_b128 v[88:91], v15 offset:8192
    ds_read_b128 v[92:95], v15 offset:9216
    ds_read_b128 v[100:103], v12 offset:0
    s_waitcnt lgkmcnt(0)
    v_mfma_f32_16x16x32_bf16 v[96:99], v[72:75], v[56:59], 0
    v_mfma_f32_16x16x32_bf16 v[96:99], v[76:79], v[60:63], v[96:99]
    v_mfma_f32_16x16x32_bf16 v[96:99], v[80:83], v[64:67], v[96:99]
    v_mfma_f32_16x16x32_bf16 v[96:99], v[84:87], v[68:71], v[96:99]
    v_max3_f32 v110, v16, v17, v18
    v_max3_f32 v110, v110, v19, v20
    v_max3_f32 v110, v110, v21, v22
    v_max_f32 v110, v110, v23
    s_nop 2
    v_max3_f32 v110, v110, v96, v97
    v_mov_b32 v98, v110
    s_nop 1
    v_permlane16_swap_b32 v110, v98
    v_max_f32 v110, v110, v98
    v_mov_b32 v98, v110
    s_nop 1
    v_permlane32_swap_b32 v110, v98
    v_max_f32 v110, v110, v98
    v_sub_f32 v16, v16, v110
    v_exp_f32 v16, v16
    v_sub_f32 v17, v17, v110
    v_exp_f32 v17, v17
    v_sub_f32 v18, v18, v110
    v_exp_f32 v18, v18
    v_sub_f32 v19, v19, v110
    v_exp_f32 v19, v19
    v_sub_f32 v20, v20, v110
    v_exp_f32 v20, v20
    v_sub_f32 v21, v21, v110
    v_exp_f32 v21, v21
    v_sub_f32 v22, v22, v110
    v_exp_f32 v22, v22
    v_sub_f32 v23, v23, v110
    v_exp_f32 v23, v23
    v_sub_f32 v96, v96, v110
    v_exp_f32 v96, v96
    v_sub_f32 v97, v97, v110
    v_exp_f32 v97, v97
    v_cvt_pk_bf16_f32 v16, v16, v17
    v_cvt_pk_bf16_f32 v17, v18, v19
    v_cvt_pk_bf16_f32 v18, v20, v21
    v_cvt_pk_bf16_f32 v19, v22, v23
    v_cvt_pk_bf16_f32 v104, v96, v97
    v_cvt_pk_bf16_f32 v109, v96, v97
    v_mfma_f32_16x16x32_bf16 v[20:23], v[100:103], v[16:19], 0
    v_mfma_f32_16x16x32_bf16 v[24:27], v[88:91], v[16:19], 0
    v_mfma_f32_16x16x32_bf16 v[28:31], v[92:95], v[16:19], 0
    v_mfma_f32_16x16x16_bf16 v[20:23], v[100:101], v[104:105], v[20:23]
    v_mfma_f32_16x16x16_bf16 v[24:27], v[106:107], v[104:105], v[24:27]
    v_mfma_f32_16x16x16_bf16 v[28:31], v[106:107], v[108:109], v[28:31]
    ds_read_b128 v[72:75], v8 offset:0
    ds_read_b128 v[76:79], v8 offset:1024
    ds_read_b128 v[80:83], v8 offset:4096
    ds_read_b128 v[84:87], v8 offset:5120
    ds_read_b128 v[88:91], v8 offset:2048
    ds_read_b128 v[92:95], v8 offset:3072
    ds_read_b128 v[96:99], v8 offset:6144
    ds_read_b128 v[100:103], v8 offset:7168
    v_rcp_f32 v110, v20
    s_waitcnt lgkmcnt(0)
    s_mov_b64 vcc, 0
    s_nop 7
    s_branch L_smback_114
L_last_s0:
    buffer_store_dwordx2 v[106:107], v0, s[68:71], s29 offen sc1
    ds_read_b128 v[16:19], v5 offset:0
    s_waitcnt vmcnt(1)
    ds_read_b128 v[88:91], v7 offset:32768
    ds_read_b128 v[92:95], v7 offset:33792
    ds_read_b128 v[96:99], v7 offset:34816
    ds_read_b128 v[100:103], v7 offset:35840
    ds_read_b128 v[24:27], v12 offset:256
    ds_read_b128 v[28:31], v12 offset:256
    s_waitcnt lgkmcnt(0)
    buffer_store_dwordx4 v[16:19], v1, s[68:71], s28 offen sc1
    s_barrier
    v_smfmac_f32_16x16x64_bf16 v[24:27], v[40:43], a[128:135], v2
    v_smfmac_f32_16x16x64_bf16 v[28:31], v[40:43], a[192:199], v2
    v_smfmac_f32_16x16x64_bf16 v[32:35], v[40:43], v[128:135], v2
    v_smfmac_f32_16x16x64_bf16 v[36:39], v[40:43], v[136:143], v2
    ds_read_b128 v[40:43], v13 offset:8192
    v_smfmac_f32_16x16x64_bf16 v[24:27], v[44:47], a[136:143], v2
    v_smfmac_f32_16x16x64_bf16 v[28:31], v[44:47], a[200:207], v2
    v_smfmac_f32_16x16x64_bf16 v[32:35], v[44:47], v[144:151], v2
    v_smfmac_f32_16x16x64_bf16 v[36:39], v[44:47], v[152:159], v2
    ds_read_b128 v[44:47], v13 offset:9216
    v_smfmac_f32_16x16x64_bf16 v[24:27], v[48:51], a[144:151], v2
    v_smfmac_f32_16x16x64_bf16 v[28:31], v[48:51], a[208:215], v2
    v_smfmac_f32_16x16x64_bf16 v[32:35], v[48:51], v[160:167], v2
    v_smfmac_f32_16x16x64_bf16 v[36:39], v[48:51], v[168:175], v2
    ds_read_b128 v[48:51], v13 offset:10240
    v_smfmac_f32_16x16x64_bf16 v[24:27], v[52:55], a[152:159], v2
    v_smfmac_f32_16x16x64_bf16 v[28:31], v[52:55], a[216:223], v2
    v_smfmac_f32_16x16x64_bf16 v[32:35], v[52:55], v[176:183], v2
    v_smfmac_f32_16x16x64_bf16 v[36:39], v[52:55], v[184:191], v2
    ds_read_b128 v[52:55], v13 offset:11264
    s_waitcnt lgkmcnt(3)
    v_smfmac_f32_16x16x64_bf16 v[24:27], v[40:43], a[160:167], v2
    v_smfmac_f32_16x16x64_bf16 v[28:31], v[40:43], a[224:231], v2
    v_smfmac_f32_16x16x64_bf16 v[32:35], v[40:43], v[56:63], v2
    v_smfmac_f32_16x16x64_bf16 v[36:39], v[40:43], v[64:71], v2
    ds_read_b128 v[56:59], v7 offset:36864
    ds_read_b128 v[60:63], v7 offset:37888
    ds_read_b128 v[64:67], v7 offset:38912
    ds_read_b128 v[68:71], v7 offset:39936
    s_waitcnt lgkmcnt(6)
    v_smfmac_f32_16x16x64_bf16 v[24:27], v[44:47], a[168:175], v2
    v_smfmac_f32_16x16x64_bf16 v[28:31], v[44:47], a[232:239], v2
    v_smfmac_f32_16x16x64_bf16 v[32:35], v[44:47], v[72:79], v2
    v_smfmac_f32_16x16x64_bf16 v[36:39], v[44:47], v[80:87], v2
    s_waitcnt lgkmcnt(5)
    v_smfmac_f32_16x16x64_bf16 v[24:27], v[48:51], a[176:183], v2
    v_smfmac_f32_16x16x64_bf16 v[28:31], v[48:51], a[240:247], v2
    v_smfmac_f32_16x16x64_bf16 v[32:35], v[48:51], v[88:95], v2
    v_smfmac_f32_16x16x64_bf16 v[36:39], v[48:51], v[96:103], v2
    s_waitcnt lgkmcnt(4)
    v_smfmac_f32_16x16x64_bf16 v[24:27], v[52:55], a[184:191], v2
    v_smfmac_f32_16x16x64_bf16 v[28:31], v[52:55], a[248:255], v2
    s_waitcnt lgkmcnt(2)
    v_smfmac_f32_16x16x64_bf16 v[32:35], v[52:55], v[56:63], v2
    s_waitcnt lgkmcnt(0)
    v_smfmac_f32_16x16x64_bf16 v[36:39], v[52:55], v[64:71], v2
    v_add_f32 v24, v24, v26
    v_add_f32 v28, v28, v30
    v_add_f32 v25, v25, v27
    v_add_f32 v29, v29, v31
    v_cvt_pk_bf16_f32 v24, v24, v28
    v_cvt_pk_bf16_f32 v25, v25, v29
    ds_write2_b32 v14, v24, v25 offset0:0 offset1:72
    v_add_f32 v32, v32, v34
    v_add_f32 v33, v33, v35
    v_cvt_pk_bf16_f32 v106, v32, v33
    v_add_f32 v36, v36, v38
    v_add_f32 v37, v37, v39
    v_cvt_pk_bf16_f32 v107, v36, v37
    buffer_store_dwordx2 v[106:107], v0, s[68:71], s19 offen sc1
    s_waitcnt lgkmcnt(0)
    s_barrier
    ds_read_b128 v[72:75], v5 offset:0
    s_waitcnt lgkmcnt(0)
    buffer_store_dwordx4 v[72:75], v1, s[68:71], s18 offen sc1
    s_waitcnt vmcnt(0)
    s_barrier
    s_endpgm
L_cl_5:
    ds_read_b128 v[56:59], v7 offset:0
    ds_read_b128 v[60:63], v7 offset:1024
    ds_read_b128 v[64:67], v7 offset:2048
    ds_read_b128 v[68:71], v7 offset:3072
    ds_read_b128 v[72:75], v7 offset:4096
    ds_read_b128 v[76:79], v7 offset:5120
    ds_read_b128 v[80:83], v7 offset:6144
    ds_read_b128 v[84:87], v7 offset:7168
    ds_read_b128 v[16:19], v12 offset:256
    ds_read_b128 v[20:23], v12 offset:256
    ds_read_b128 v[32:35], v12 offset:256
    ds_read_b128 v[36:39], v12 offset:256
    v_mov_b32 v104, 1
    s_mov_b32 m0, s91
    s_mov_b32 s15, 1048576
    buffer_load_dwordx4 v[24:27], v1, s[68:71], s17 offen offset:0 sc1
    buffer_load_dwordx4 v[28:31], v1, s[68:71], s17 offen offset:1024 sc1
L_chk_s1:
    buffer_load_dwordx4 v[88:91], v1, s[68:71], s17 offen offset:0 sc1
    buffer_load_dwordx4 v[92:95], v1, s[68:71], s17 offen offset:1024 sc1
    s_waitcnt vmcnt(2)
    ds_write_b128 v13, v[24:27] offset:2048
    ds_write_b128 v13, v[28:31] offset:3072
    v_max3_u32 v111, v24, v25, v26
    v_max3_u32 v110, v27, v28, v29
    v_max3_u32 v111, v111, v30, v31
    v_max_u32 v111, v111, v110
    v_cmp_eq_u32 vcc, -1, v111
    s_cbranch_vccz L_bar1_s1
    buffer_load_dwordx4 v[24:27], v1, s[68:71], s17 offen offset:0 sc1
    buffer_load_dwordx4 v[28:31], v1, s[68:71], s17 offen offset:1024 sc1
    s_waitcnt vmcnt(2)
    ds_write_b128 v13, v[88:91] offset:2048
    ds_write_b128 v13, v[92:95] offset:3072
    v_max3_u32 v111, v88, v89, v90
    v_max3_u32 v110, v91, v92, v93
    v_max3_u32 v111, v111, v94, v95
    v_max_u32 v111, v111, v110
    v_cmp_eq_u32 vcc, -1, v111
    s_cbranch_vccnz L_mre_120
L_bar1_s1:
    s_cmp_eq_u32 s14, 63
    s_waitcnt lgkmcnt(0)
    s_barrier
    ds_read_b128 v[40:43], v13 offset:0
    ds_read_b128 v[44:47], v13 offset:1024
    ds_read_b128 v[48:51], v13 offset:2048
    ds_read_b128 v[52:55], v13 offset:3072
    s_cbranch_scc1 L_last_s1
    buffer_store_dwordx2 v[106:107], v0, s[68:71], s29 offen sc1
    s_waitcnt lgkmcnt(3)
    v_smfmac_f32_16x16x64_bf16 v[16:19], v[40:43], a[0:7], v2
    v_smfmac_f32_16x16x64_bf16 v[20:23], v[40:43], a[64:71], v2
    buffer_load_dwordx4 v1, s[68:71], s26 offen offset:0 sc1 lds
    s_waitcnt lgkmcnt(2)
    v_smfmac_f32_16x16x64_bf16 v[16:19], v[44:47], a[8:15], v2
    ds_read_b128 v[40:43], v13 offset:8192
    v_smfmac_f32_16x16x64_bf16 v[20:23], v[44:47], a[72:79], v2
    buffer_load_dword v111, off, s[68:71], s27 sc1
    s_waitcnt lgkmcnt(2)
    v_smfmac_f32_16x16x64_bf16 v[16:19], v[48:51], a[16:23], v2
    ds_read_b128 v[44:47], v13 offset:9216
    v_smfmac_f32_16x16x64_bf16 v[20:23], v[48:51], a[80:87], v2
    buffer_load_dwordx4 v1, s[68:71], s26 offen offset:1024 sc1 lds
    s_waitcnt lgkmcnt(2)
    v_smfmac_f32_16x16x64_bf16 v[16:19], v[52:55], a[24:31], v2
    s_waitcnt vmcnt(4)
    s_nop 0
    ds_read_b128 v[24:27], v5 offset:64
    v_smfmac_f32_16x16x64_bf16 v[20:23], v[52:55], a[88:95], v2
    ds_read_b128 v[28:31], v12 offset:512
    s_waitcnt lgkmcnt(3)
    v_smfmac_f32_16x16x64_bf16 v[16:19], v[40:43], a[32:39], v2
    ds_read_b128 v[88:91], v7 offset:32768
    v_smfmac_f32_16x16x64_bf16 v[20:23], v[40:43], a[96:103], v2
    buffer_load_dwordx4 v1, s[68:71], s26 offen offset:2048 sc1 lds
    v_smfmac_f32_16x16x64_bf16 v[32:35], v[40:43], v[56:63], v2
    ds_read_b128 v[48:51], v13 offset:10240
    v_smfmac_f32_16x16x64_bf16 v[36:39], v[40:43], v[64:71], v2
    ds_read_b128 v[92:95], v7 offset:33792
    s_waitcnt lgkmcnt(5)
    v_smfmac_f32_16x16x64_bf16 v[16:19], v[44:47], a[40:47], v2
    ds_read_b128 v[52:55], v13 offset:11264
    s_waitcnt lgkmcnt(4)
    buffer_store_dwordx4 v[28:31], v1, s[68:71], s84 offen sc1
    v_smfmac_f32_16x16x64_bf16 v[20:23], v[44:47], a[104:111], v2
    buffer_load_dwordx4 v1, s[68:71], s26 offen offset:3072 sc1 lds
    ds_read_b128 v[96:99], v7 offset:34816
    v_smfmac_f32_16x16x64_bf16 v[32:35], v[44:47], v[72:79], v2
    ds_read_b128 v[56:59], v7 offset:36864
    v_smfmac_f32_16x16x64_bf16 v[36:39], v[44:47], v[80:87], v2
    ds_read_b128 v[100:103], v7 offset:35840
    s_waitcnt lgkmcnt(5)
    v_smfmac_f32_16x16x64_bf16 v[16:19], v[48:51], a[48:55], v2
    ds_read_b128 v[60:63], v7 offset:37888
    buffer_store_dwordx4 v[24:27], v1, s[68:71], s28 offen sc1
    s_nop 1
    ds_read_b128 v[24:27], v12 offset:256
    v_smfmac_f32_16x16x64_bf16 v[20:23], v[48:51], a[112:119], v2
    ds_read_b128 v[64:67], v7 offset:38912
    s_waitcnt lgkmcnt(6)
    v_smfmac_f32_16x16x64_bf16 v[16:19], v[52:55], a[56:63], v2
    buffer_store_dwordx4 v[28:31], v1, s[68:71], s84 offen offset:1024 sc1
    s_nop 1
    ds_read_b128 v[28:31], v12 offset:256
    v_smfmac_f32_16x16x64_bf16 v[20:23], v[52:55], a[120:127], v2
    ds_read_b128 v[68:71], v7 offset:39936
    s_waitcnt lgkmcnt(1)
    v_smfmac_f32_16x16x64_bf16 v[24:27], v[40:43], a[160:167], v2
    ds_read_b128 v[72:75], v15 offset:0
    v_smfmac_f32_16x16x64_bf16 v[28:31], v[40:43], a[224:231], v2
    ds_read_b128 v[76:79], v15 offset:1024
    v_add_f32 v16, v16, v18
    v_smfmac_f32_16x16x64_bf16 v[24:27], v[44:47], a[168:175], v2
    ds_read_b128 v[40:43], v13 offset:0
    v_add_f32 v20, v20, v22
    v_smfmac_f32_16x16x64_bf16 v[28:31], v[44:47], a[232:239], v2
    ds_read_b128 v[80:83], v15 offset:2048
    v_add_f32 v17, v17, v19
    v_smfmac_f32_16x16x64_bf16 v[24:27], v[48:51], a[176:183], v2
    ds_read_b128 v[44:47], v13 offset:1024
    v_add_f32 v21, v21, v23
    v_smfmac_f32_16x16x64_bf16 v[28:31], v[48:51], a[240:247], v2
    ds_read_b128 v[84:87], v15 offset:3072
    v_mul_f32 v16, s31, v16
    v_smfmac_f32_16x16x64_bf16 v[32:35], v[48:51], v[88:95], v2
    v_mul_f32 v20, s31, v20
    v_smfmac_f32_16x16x64_bf16 v[36:39], v[48:51], v[96:103], v2
    ds_read_b128 v[88:91], v15 offset:4096
    v_cvt_pk_bf16_f32 v16, v16, v20
    v_smfmac_f32_16x16x64_bf16 v[24:27], v[52:55], a[184:191], v2
    ds_read_b128 v[48:51], v13 offset:2048
    v_mul_f32 v17, s31, v17
    v_smfmac_f32_16x16x64_bf16 v[28:31], v[52:55], a[248:255], v2
    ds_read_b128 v[92:95], v15 offset:5120
    v_mul_f32 v21, s31, v21
    v_smfmac_f32_16x16x64_bf16 v[32:35], v[52:55], v[56:63], v2
    ds_read_b128 v[96:99], v15 offset:6144
    s_waitcnt lgkmcnt(5)
    v_cvt_pk_bf16_f32 v17, v17, v21
    v_smfmac_f32_16x16x64_bf16 v[36:39], v[52:55], v[64:71], v2
    ds_write2_b32 v3, v16, v17 offset0:0 offset1:72
    ds_read_b128 v[52:55], v13 offset:3072
    v_smfmac_f32_16x16x64_bf16 v[24:27], v[40:43], a[128:135], v2
    ds_read_b128 v[100:103], v15 offset:7168
    v_smfmac_f32_16x16x64_bf16 v[28:31], v[40:43], a[192:199], v2
    v_smfmac_f32_16x16x64_bf16 v[24:27], v[44:47], a[136:143], v2
    s_waitcnt lgkmcnt(2)
    s_barrier
    ds_read_b128 v[56:59], v4 offset:0
    v_smfmac_f32_16x16x64_bf16 v[28:31], v[44:47], a[200:207], v2
    ds_read_b128 v[60:63], v4 offset:64
    v_smfmac_f32_16x16x64_bf16 v[24:27], v[48:51], a[144:151], v2
    ds_read_b128 v[64:67], v4 offset:128
    v_smfmac_f32_16x16x64_bf16 v[28:31], v[48:51], a[208:215], v2
    ds_read_b128 v[68:71], v4 offset:192
    s_waitcnt lgkmcnt(5)
    v_smfmac_f32_16x16x64_bf16 v[24:27], v[52:55], a[152:159], v2
    v_smfmac_f32_16x16x64_bf16 v[28:31], v[52:55], a[216:223], v2
    v_smfmac_f32_16x16x64_bf16 v[32:35], v[40:43], v[128:135], v2
    s_waitcnt lgkmcnt(3)
    v_mfma_f32_16x16x32_bf16 v[16:19], v[72:75], v[56:59], 0
    s_waitcnt lgkmcnt(2)
    v_add_f32 v24, v24, v26
    v_add_f32 v28, v28, v30
    v_mfma_f32_16x16x32_bf16 v[16:19], v[76:79], v[60:63], v[16:19]
    s_waitcnt lgkmcnt(1)
    v_add_f32 v25, v25, v27
    v_add_f32 v29, v29, v31
    v_mfma_f32_16x16x32_bf16 v[16:19], v[80:83], v[64:67], v[16:19]
    s_waitcnt lgkmcnt(0)
    v_cvt_pk_bf16_f32 v24, v24, v28
    v_cvt_pk_bf16_f32 v25, v25, v29
    v_mfma_f32_16x16x32_bf16 v[16:19], v[84:87], v[68:71], v[16:19]
    ds_write2_b32 v14, v24, v25 offset0:0 offset1:72
    v_mfma_f32_16x16x32_bf16 v[20:23], v[88:91], v[56:59], 0
    v_mfma_f32_16x16x32_bf16 v[20:23], v[92:95], v[60:63], v[20:23]
    v_exp_f32 v16, v16
    v_mfma_f32_16x16x32_bf16 v[20:23], v[96:99], v[64:67], v[20:23]
    s_waitcnt lgkmcnt(0)
    s_barrier
    ds_read_b128 v[72:75], v5 offset:0
    ds_read_b128 v[76:79], v5 offset:64
    ds_read_b128 v[80:83], v5 offset:128
    ds_read_b128 v[84:87], v5 offset:192
    v_exp_f32 v17, v17
    v_mfma_f32_16x16x32_bf16 v[20:23], v[100:103], v[68:71], v[20:23]
    ds_read_b128 v[88:91], v15 offset:10240
    v_exp_f32 v18, v18
    v_smfmac_f32_16x16x64_bf16 v[36:39], v[40:43], v[136:143], v2
    ds_read_b128 v[92:95], v15 offset:11264
    v_exp_f32 v19, v19
    v_smfmac_f32_16x16x64_bf16 v[32:35], v[44:47], v[144:151], v2
    ds_read_b128 v[100:103], v12 offset:0
    v_exp_f32 v20, v20
    v_smfmac_f32_16x16x64_bf16 v[36:39], v[44:47], v[152:159], v2
    v_exp_f32 v21, v21
    v_smfmac_f32_16x16x64_bf16 v[32:35], v[48:51], v[160:167], v2
    v_exp_f32 v22, v22
    v_smfmac_f32_16x16x64_bf16 v[36:39], v[48:51], v[168:175], v2
    v_exp_f32 v23, v23
    v_smfmac_f32_16x16x64_bf16 v[32:35], v[52:55], v[176:183], v2
    v_cvt_pk_bf16_f32 v16, v16, v17
    v_smfmac_f32_16x16x64_bf16 v[36:39], v[52:55], v[184:191], v2
    ds_read_b128 v[40:43], v12 offset:256
    s_waitcnt lgkmcnt(1)
    v_cvt_pk_bf16_f32 v17, v18, v19
    v_mfma_f32_16x16x32_bf16 v[96:99], v[72:75], v[56:59], 0
    v_cvt_pk_bf16_f32 v18, v20, v21
    v_cvt_pk_bf16_f32 v19, v22, v23
    v_mfma_f32_16x16x32_bf16 v[96:99], v[76:79], v[60:63], v[96:99]
    v_add_f32 v32, v32, v34
    v_add_f32 v33, v33, v35
    v_mfma_f32_16x16x32_bf16 v[96:99], v[80:83], v[64:67], v[96:99]
    v_cvt_pk_bf16_f32 v106, v32, v33
    v_add_f32 v36, v36, v38
    v_mfma_f32_16x16x32_bf16 v[96:99], v[84:87], v[68:71], v[96:99]
    v_add_f32 v37, v37, v39
    v_cvt_pk_bf16_f32 v107, v36, v37
    v_mfma_f32_16x16x32_bf16 v[20:23], v[100:103], v[16:19], 0
    ds_read_b128 v[44:47], v12 offset:256
    v_mfma_f32_16x16x32_bf16 v[24:27], v[88:91], v[16:19], 0
    v_exp_f32 v96, v96
    v_exp_f32 v97, v97
    v_mfma_f32_16x16x32_bf16 v[28:31], v[92:95], v[16:19], 0
    ds_read_b128 v[48:51], v12 offset:256
    v_cvt_pk_bf16_f32 v104, v96, v97
    v_cvt_pk_bf16_f32 v109, v96, v97
    s_nop 0
    v_mfma_f32_16x16x16_bf16 v[20:23], v[100:101], v[104:105], v[20:23]
    ds_read_b128 v[52:55], v12 offset:256
    v_mfma_f32_16x16x16_bf16 v[24:27], v[106:107], v[104:105], v[24:27]
    ds_read_b128 v[72:75], v8 offset:0
    v_mfma_f32_16x16x16_bf16 v[28:31], v[106:107], v[108:109], v[28:31]
    ds_read_b128 v[76:79], v8 offset:1024
    v_rcp_f32 v110, v20
    s_nop 0
    v_max_f32 v21, v20, v110
    v_cmp_ngt_f32 vcc, s32, v21
L_smback_122:
    v_pk_mul_f32 v[24:25], v[24:25], v[110:111] op_sel_hi:[1,0]
    v_pk_mul_f32 v[26:27], v[26:27], v[110:111] op_sel_hi:[1,0]
    v_pk_mul_f32 v[28:29], v[28:29], v[110:111] op_sel_hi:[1,0]
    v_pk_mul_f32 v[30:31], v[30:31], v[110:111] op_sel_hi:[1,0]
    s_mov_b64 exec, s[88:89]
    v_cvt_pk_bf16_f32 v24, v24, v25
    v_cvt_pk_bf16_f32 v25, v26, v27
    v_cvt_pk_bf16_f32 v26, v28, v29
    v_cvt_pk_bf16_f32 v27, v30, v31
    ds_write_b128 v6, v[24:27]
    s_mov_b64 exec, -1
    s_cbranch_vccnz L_slowsm_121
    ds_read_b128 v[80:83], v8 offset:4096
    ds_read_b128 v[84:87], v8 offset:5120
    s_waitcnt lgkmcnt(2)
    s_barrier
    ds_read_b128 v[24:27], v13 offset:16384
    ds_read_b128 v[28:31], v13 offset:17408
    ds_read_b128 v[56:59], v12 offset:256
    ds_read_b128 v[60:63], v12 offset:256
    ds_read_b128 v[88:91], v8 offset:2048
    s_waitcnt lgkmcnt(4)
    v_smfmac_f32_16x16x64_bf16 v[40:43], v[24:27], v[192:199], v2
    ds_read_b128 v[92:95], v8 offset:3072
    v_smfmac_f32_16x16x64_bf16 v[44:47], v[24:27], v[208:215], v2
    ds_read_b128 v[96:99], v8 offset:6144
    s_waitcnt lgkmcnt(5)
    v_smfmac_f32_16x16x64_bf16 v[40:43], v[28:31], v[200:207], v2
    ds_read_b128 v[100:103], v8 offset:7168
    s_mov_b32 s11, s24
    v_smfmac_f32_16x16x64_bf16 v[44:47], v[28:31], v[216:223], v2
    ds_read_b128 v[64:67], v12 offset:256
    s_mov_b32 s12, s23
    v_smfmac_f32_16x16x64_bf16 v[48:51], v[24:27], v[224:231], v2
    ds_read_b128 v[68:71], v12 offset:256
    v_add_f32 v40, v40, v42
    v_add_f32 v41, v41, v43
    v_smfmac_f32_16x16x64_bf16 v[52:55], v[24:27], v[240:247], v2
    ds_read_b128 v[32:35], v8 offset:32768
    v_add_f32 v44, v44, v46
    v_smfmac_f32_16x16x64_bf16 v[48:51], v[28:31], v[232:239], v2
    ds_read_b128 v[36:39], v8 offset:33792
    v_add_f32 v45, v45, v47
    v_smfmac_f32_16x16x64_bf16 v[52:55], v[28:31], v[248:255], v2
    ds_read_b128 v[16:19], v8 offset:34816
    s_waitcnt lgkmcnt(9)
    v_cvt_pk_bf16_f32 v40, v40, v44
    v_smfmac_f32_16x16x64_bf16 v[56:59], v[24:27], v[72:79], v2
    ds_read_b128 v[20:23], v8 offset:35840
    v_cvt_pk_bf16_f32 v41, v41, v45
    v_add_f32 v48, v48, v50
    v_add_f32 v49, v49, v51
    v_smfmac_f32_16x16x64_bf16 v[60:63], v[24:27], v[80:87], v2
    s_waitcnt lgkmcnt(8)
    v_add_f32 v52, v52, v54
    v_add_f32 v53, v53, v55
    v_smfmac_f32_16x16x64_bf16 v[56:59], v[28:31], v[88:95], v2
    v_cvt_pk_bf16_f32 v42, v48, v52
    v_cvt_pk_bf16_f32 v43, v49, v53
    buffer_store_dwordx4 v[40:43], v9, s[68:71], s85 offen sc1
    s_waitcnt lgkmcnt(6)
    v_smfmac_f32_16x16x64_bf16 v[60:63], v[28:31], v[96:103], v2
    s_mov_b32 s13, s22
    s_mov_b32 s15, 1048576
    s_waitcnt lgkmcnt(4)
    v_smfmac_f32_16x16x64_bf16 v[64:67], v[24:27], v[112:119], v2
    s_waitcnt lgkmcnt(2)
    v_add_f32 v56, v56, v58
    v_add_f32 v57, v57, v59
    v_smfmac_f32_16x16x64_bf16 v[64:67], v[28:31], v[32:39], v2
    ds_read_b128 v[88:91], v13 offset:26880
    v_add_f32 v60, v60, v62
    v_smfmac_f32_16x16x64_bf16 v[68:71], v[24:27], v[120:127], v2
    s_mov_b32 s10, s27
    s_waitcnt lgkmcnt(1)
    v_add_f32 v61, v61, v63
    v_smfmac_f32_16x16x64_bf16 v[68:71], v[28:31], v[16:23], v2
    v_cvt_pk_bf16_f32 v56, v56, v60
    v_cvt_pk_bf16_f32 v57, v57, v61
    v_pk_add_f32 v[64:65], v[64:65], v[66:67]
    s_nop 2
    v_pk_add_f32 v[68:69], v[68:69], v[70:71]
    v_cvt_pk_bf16_f32 v58, v64, v68
    v_cvt_pk_bf16_f32 v59, v65, v69
    buffer_store_dwordx4 v[56:59], v9, s[68:71], s86 offen sc1
    s_waitcnt vmcnt(8)
    v_readfirstlane_b32 s9, v111
    ds_read_b128 v[56:59], v7 offset:0
    ds_read_b128 v[60:63], v7 offset:1024
    ds_read_b128 v[64:67], v7 offset:2048
    ds_read_b128 v[68:71], v7 offset:3072
    ds_read_b128 v[72:75], v7 offset:4096
    ds_read_b128 v[76:79], v7 offset:5120
    ds_read_b128 v[80:83], v7 offset:6144
    ds_read_b128 v[84:87], v7 offset:7168
    ds_read_b128 v[16:19], v12 offset:256
    ds_read_b128 v[20:23], v12 offset:256
    ds_read_b128 v[32:35], v12 offset:256
    ds_read_b128 v[36:39], v12 offset:256
    s_mov_b32 s7, s23
    s_mov_b32 s23, s24
    s_mov_b32 s24, s25
    s_mov_b32 s25, s7
    s_add_u32 s17, s23, s16
    s_add_u32 s21, s21, 1
    s_mov_b32 s87, 262144
    s_cmp_eq_u32 s21, 3
    s_cselect_b32 s87, 0xfff80000, s87
    s_cselect_b32 s21, 0, s21
    s_add_u32 s85, s85, s87
    s_add_u32 s86, s86, s87
    s_add_u32 s22, s22, s87
    s_add_u32 s84, s84, s90
    s_mov_b32 s90, s87
    s_add_u32 s14, s14, 1
    s_mov_b32 s28, s18
    s_mov_b32 s29, s19
    s_add_u32 s18, s18, 131072
    s_add_u32 s19, s19, 65536
    s_mov_b32 s30, s20
    s_mov_b32 s20, s33
    s_add_u32 s33, s33, 128
    v_mov_b32 v104, 1
    s_add_u32 s27, s27, 128
    s_xor_b32 s91, s91, 16384
    s_add_u32 s26, s26, 262144
    s_mov_b32 m0, s91
    buffer_load_dwordx4 v[40:43], v1, s[68:71], s13 offen sc1
    buffer_load_dwordx4 v[44:47], v1, s[68:71], s13 offen offset:1024 sc1
    s_nop 7
    s_nop 7
    v_xor_b32 v15, 0x4000, v15
    s_nop 7
    s_nop 7
    v_mov_b32 v111, -1
    s_waitcnt lgkmcnt(12)
L_ra_123:
    buffer_load_dwordx4 v[48:51], v1, s[68:71], s13 offen sc1
    buffer_load_dwordx4 v[52:55], v1, s[68:71], s13 offen offset:1024 sc1
    s_waitcnt vmcnt(3)
    v_mfma_f32_16x16x32_bf16 v[92:95], v[88:91], v[40:43], 0
    s_waitcnt vmcnt(2)
    v_mfma_f32_16x16x32_bf16 v[92:95], v[88:91], v[44:47], v[92:95]
    s_nop 7
    v_cmp_u_f32 vcc, v92, v93
    v_add_f32_dpp v92, v92, v92 row_ror:4 row_mask:0xf bank_mask:0xf
    v_add_f32_dpp v93, v93, v93 row_ror:4 row_mask:0xf bank_mask:0xf
    s_cbranch_vccz L_rdone_125
    buffer_load_dwordx4 v[40:43], v1, s[68:71], s13 offen sc1
    buffer_load_dwordx4 v[44:47], v1, s[68:71], s13 offen offset:1024 sc1
    s_waitcnt vmcnt(3)
    v_mfma_f32_16x16x32_bf16 v[92:95], v[88:91], v[48:51], 0
    s_waitcnt vmcnt(2)
    v_mfma_f32_16x16x32_bf16 v[92:95], v[88:91], v[52:55], v[92:95]
    s_nop 7
    v_cmp_u_f32 vcc, v92, v93
    v_add_f32_dpp v92, v92, v92 row_ror:4 row_mask:0xf bank_mask:0xf
    v_add_f32_dpp v93, v93, v93 row_ror:4 row_mask:0xf bank_mask:0xf
    s_cbranch_vccnz L_rslow_124
L_rdone_125:
    v_add_f32_dpp v92, v92, v92 row_ror:8 row_mask:0xf bank_mask:0xf
    v_add_f32_dpp v93, v93, v93 row_ror:8 row_mask:0xf bank_mask:0xf
    v_cvt_pk_bf16_f32 v110, v92, v93
    v_min_u32 v110, 0xfffffffe, v110
    buffer_store_dword v110, v10, s[68:71], s11 offen sc1
    buffer_store_dword v111, v10, s[68:71], s12 offen sc1
    s_cmp_lg_u32 s9, 1
    s_cbranch_scc1 L_kvpoll_127
L_kvok_126:
    s_mov_b32 s15, 1048576
    s_nop 7
    s_nop 7
    s_nop 7
    s_nop 7
    s_nop 7
    s_nop 7
    buffer_load_dwordx4 v[24:27], v1, s[68:71], s17 offen offset:0 sc1
    buffer_load_dwordx4 v[28:31], v1, s[68:71], s17 offen offset:1024 sc1
    s_nop 7
    s_nop 7
    s_nop 7
    s_nop 7
    s_branch L_chk_s1
L_kvpoll_127:
    s_cmp_ge_u32 s14, 63
    s_cbranch_scc1 L_kvok_126
    s_mov_b32 s15, 1048576
L_poll_128:
    buffer_load_dword v111, off, s[68:71], s10 offset:0 sc1
    s_waitcnt vmcnt(0)
    v_readfirstlane_b32 s7, v111
    s_nop 0
    s_cmp_eq_u32 s7, 1
    s_cbranch_scc1 L_polld_129
    s_sub_u32 s15, s15, 1
    s_cmp_eq_u32 s15, 0
    s_cbranch_scc1 L_err_9
    s_branch L_poll_128
L_polld_129:
    s_branch L_kvok_126
L_mre_120:
    s_sub_u32 s15, s15, 1
    s_cmp_lg_u32 s15, 0
    s_cbranch_scc1 L_chk_s1
    s_branch L_err_8
L_rslow_124:
    s_sub_u32 s15, s15, 1
    s_cmp_eq_u32 s15, 0
    s_cbranch_scc1 L_err_10
    s_and_b32 s7, s15, 3
    s_cmp_lg_u32 s7, 0
    s_cbranch_scc1 L_ra_123
    s_mov_b64 s[98:99], 0
    v_mov_b32 v110, 0xffbfffbf
    v_cmp_eq_u32 vcc, v110, v48
    s_nop 0
    s_or_b64 s[98:99], s[98:99], vcc
    v_cmp_eq_u32 vcc, v110, v49
    s_nop 0
    s_or_b64 s[98:99], s[98:99], vcc
    v_cmp_eq_u32 vcc, v110, v50
    s_nop 0
    s_or_b64 s[98:99], s[98:99], vcc
    v_cmp_eq_u32 vcc, v110, v51
    s_nop 0
    s_or_b64 s[98:99], s[98:99], vcc
    v_cmp_eq_u32 vcc, v110, v52
    s_nop 0
    s_or_b64 s[98:99], s[98:99], vcc
    v_cmp_eq_u32 vcc, v110, v53
    s_nop 0
    s_or_b64 s[98:99], s[98:99], vcc
    v_cmp_eq_u32 vcc, v110, v54
    s_nop 0
    s_or_b64 s[98:99], s[98:99], vcc
    v_cmp_eq_u32 vcc, v110, v55
    s_nop 0
    s_or_b64 s[98:99], s[98:99], vcc
    s_cmp_eq_u64 s[98:99], 0
    s_cbranch_scc1 L_rdone_125
    s_branch L_ra_123
L_slowsm_121:
    s_waitcnt lgkmcnt(0)
    ds_read_b128 v[72:75], v15 offset:0
    ds_read_b128 v[88:91], v15 offset:4096
    ds_read_b128 v[76:79], v15 offset:1024
    ds_read_b128 v[92:95], v15 offset:5120
    ds_read_b128 v[80:83], v15 offset:2048
    ds_read_b128 v[96:99], v15 offset:6144
    ds_read_b128 v[84:87], v15 offset:3072
    ds_read_b128 v[100:103], v15 offset:7168
    s_waitcnt lgkmcnt(0)
    v_mfma_f32_16x16x32_bf16 v[16:19], v[72:75], v[56:59], 0
    v_mfma_f32_16x16x32_bf16 v[16:19], v[76:79], v[60:63], v[16:19]
    v_mfma_f32_16x16x32_bf16 v[16:19], v[80:83], v[64:67], v[16:19]
    v_mfma_f32_16x16x32_bf16 v[16:19], v[84:87], v[68:71], v[16:19]
    v_mfma_f32_16x16x32_bf16 v[20:23], v[88:91], v[56:59], 0
    v_mfma_f32_16x16x32_bf16 v[20:23], v[92:95], v[60:63], v[20:23]
    v_mfma_f32_16x16x32_bf16 v[20:23], v[96:99], v[64:67], v[20:23]
    v_mfma_f32_16x16x32_bf16 v[20:23], v[100:103], v[68:71], v[20:23]
    ds_read_b128 v[72:75], v5 offset:0
    ds_read_b128 v[76:79], v5 offset:64
    ds_read_b128 v[80:83], v5 offset:128
    ds_read_b128 v[84:87], v5 offset:192
    ds_read_b128 v[88:91], v15 offset:10240
    ds_read_b128 v[92:95], v15 offset:11264
    ds_read_b128 v[100:103], v12 offset:0
    s_waitcnt lgkmcnt(0)
    v_mfma_f32_16x16x32_bf16 v[96:99], v[72:75], v[56:59], 0
    v_mfma_f32_16x16x32_bf16 v[96:99], v[76:79], v[60:63], v[96:99]
    v_mfma_f32_16x16x32_bf16 v[96:99], v[80:83], v[64:67], v[96:99]
    v_mfma_f32_16x16x32_bf16 v[96:99], v[84:87], v[68:71], v[96:99]
    v_max3_f32 v110, v16, v17, v18
    v_max3_f32 v110, v110, v19, v20
    v_max3_f32 v110, v110, v21, v22
    v_max_f32 v110, v110, v23
    s_nop 2
    v_max3_f32 v110, v110, v96, v97
    v_mov_b32 v98, v110
    s_nop 1
    v_permlane16_swap_b32 v110, v98
    v_max_f32 v110, v110, v98
    v_mov_b32 v98, v110
    s_nop 1
    v_permlane32_swap_b32 v110, v98
    v_max_f32 v110, v110, v98
    v_sub_f32 v16, v16, v110
    v_exp_f32 v16, v16
    v_sub_f32 v17, v17, v110
    v_exp_f32 v17, v17
    v_sub_f32 v18, v18, v110
    v_exp_f32 v18, v18
    v_sub_f32 v19, v19, v110
    v_exp_f32 v19, v19
    v_sub_f32 v20, v20, v110
    v_exp_f32 v20, v20
    v_sub_f32 v21, v21, v110
    v_exp_f32 v21, v21
    v_sub_f32 v22, v22, v110
    v_exp_f32 v22, v22
    v_sub_f32 v23, v23, v110
    v_exp_f32 v23, v23
    v_sub_f32 v96, v96, v110
    v_exp_f32 v96, v96
    v_sub_f32 v97, v97, v110
    v_exp_f32 v97, v97
    v_cvt_pk_bf16_f32 v16, v16, v17
    v_cvt_pk_bf16_f32 v17, v18, v19
    v_cvt_pk_bf16_f32 v18, v20, v21
    v_cvt_pk_bf16_f32 v19, v22, v23
    v_cvt_pk_bf16_f32 v104, v96, v97
    v_cvt_pk_bf16_f32 v109, v96, v97
    v_mfma_f32_16x16x32_bf16 v[20:23], v[100:103], v[16:19], 0
    v_mfma_f32_16x16x32_bf16 v[24:27], v[88:91], v[16:19], 0
    v_mfma_f32_16x16x32_bf16 v[28:31], v[92:95], v[16:19], 0
    v_mfma_f32_16x16x16_bf16 v[20:23], v[100:101], v[104:105], v[20:23]
    v_mfma_f32_16x16x16_bf16 v[24:27], v[106:107], v[104:105], v[24:27]
    v_mfma_f32_16x16x16_bf16 v[28:31], v[106:107], v[108:109], v[28:31]
    ds_read_b128 v[72:75], v8 offset:0
    ds_read_b128 v[76:79], v8 offset:1024
    ds_read_b128 v[80:83], v8 offset:4096
    ds_read_b128 v[84:87], v8 offset:5120
    ds_read_b128 v[88:91], v8 offset:2048
    ds_read_b128 v[92:95], v8 offset:3072
    ds_read_b128 v[96:99], v8 offset:6144
    ds_read_b128 v[100:103], v8 offset:7168
    v_rcp_f32 v110, v20
    s_waitcnt lgkmcnt(0)
    s_mov_b64 vcc, 0
    s_nop 7
    s_branch L_smback_122
L_last_s1:
    buffer_store_dwordx2 v[106:107], v0, s[68:71], s29 offen sc1
    ds_read_b128 v[16:19], v5 offset:64
    s_waitcnt vmcnt(1)
    ds_read_b128 v[88:91], v7 offset:32768
    ds_read_b128 v[92:95], v7 offset:33792
    ds_read_b128 v[96:99], v7 offset:34816
    ds_read_b128 v[100:103], v7 offset:35840
    ds_read_b128 v[24:27], v12 offset:256
    ds_read_b128 v[28:31], v12 offset:256
    s_waitcnt lgkmcnt(0)
    buffer_store_dwordx4 v[16:19], v1, s[68:71], s28 offen sc1
    s_barrier
    v_smfmac_f32_16x16x64_bf16 v[24:27], v[40:43], a[128:135], v2
    v_smfmac_f32_16x16x64_bf16 v[28:31], v[40:43], a[192:199], v2
    v_smfmac_f32_16x16x64_bf16 v[32:35], v[40:43], v[128:135], v2
    v_smfmac_f32_16x16x64_bf16 v[36:39], v[40:43], v[136:143], v2
    ds_read_b128 v[40:43], v13 offset:8192
    v_smfmac_f32_16x16x64_bf16 v[24:27], v[44:47], a[136:143], v2
    v_smfmac_f32_16x16x64_bf16 v[28:31], v[44:47], a[200:207], v2
    v_smfmac_f32_16x16x64_bf16 v[32:35], v[44:47], v[144:151], v2
    v_smfmac_f32_16x16x64_bf16 v[36:39], v[44:47], v[152:159], v2
    ds_read_b128 v[44:47], v13 offset:9216
    v_smfmac_f32_16x16x64_bf16 v[24:27], v[48:51], a[144:151], v2
    v_smfmac_f32_16x16x64_bf16 v[28:31], v[48:51], a[208:215], v2
    v_smfmac_f32_16x16x64_bf16 v[32:35], v[48:51], v[160:167], v2
    v_smfmac_f32_16x16x64_bf16 v[36:39], v[48:51], v[168:175], v2
    ds_read_b128 v[48:51], v13 offset:10240
    v_smfmac_f32_16x16x64_bf16 v[24:27], v[52:55], a[152:159], v2
    v_smfmac_f32_16x16x64_bf16 v[28:31], v[52:55], a[216:223], v2
    v_smfmac_f32_16x16x64_bf16 v[32:35], v[52:55], v[176:183], v2
    v_smfmac_f32_16x16x64_bf16 v[36:39], v[52:55], v[184:191], v2
    ds_read_b128 v[52:55], v13 offset:11264
    s_waitcnt lgkmcnt(3)
    v_smfmac_f32_16x16x64_bf16 v[24:27], v[40:43], a[160:167], v2
    v_smfmac_f32_16x16x64_bf16 v[28:31], v[40:43], a[224:231], v2
    v_smfmac_f32_16x16x64_bf16 v[32:35], v[40:43], v[56:63], v2
    v_smfmac_f32_16x16x64_bf16 v[36:39], v[40:43], v[64:71], v2
    ds_read_b128 v[56:59], v7 offset:36864
    ds_read_b128 v[60:63], v7 offset:37888
    ds_read_b128 v[64:67], v7 offset:38912
    ds_read_b128 v[68:71], v7 offset:39936
    s_waitcnt lgkmcnt(6)
    v_smfmac_f32_16x16x64_bf16 v[24:27], v[44:47], a[168:175], v2
    v_smfmac_f32_16x16x64_bf16 v[28:31], v[44:47], a[232:239], v2
    v_smfmac_f32_16x16x64_bf16 v[32:35], v[44:47], v[72:79], v2
    v_smfmac_f32_16x16x64_bf16 v[36:39], v[44:47], v[80:87], v2
    s_waitcnt lgkmcnt(5)
    v_smfmac_f32_16x16x64_bf16 v[24:27], v[48:51], a[176:183], v2
    v_smfmac_f32_16x16x64_bf16 v[28:31], v[48:51], a[240:247], v2
    v_smfmac_f32_16x16x64_bf16 v[32:35], v[48:51], v[88:95], v2
    v_smfmac_f32_16x16x64_bf16 v[36:39], v[48:51], v[96:103], v2
    s_waitcnt lgkmcnt(4)
    v_smfmac_f32_16x16x64_bf16 v[24:27], v[52:55], a[184:191], v2
    v_smfmac_f32_16x16x64_bf16 v[28:31], v[52:55], a[248:255], v2
    s_waitcnt lgkmcnt(2)
    v_smfmac_f32_16x16x64_bf16 v[32:35], v[52:55], v[56:63], v2
    s_waitcnt lgkmcnt(0)
    v_smfmac_f32_16x16x64_bf16 v[36:39], v[52:55], v[64:71], v2
    v_add_f32 v24, v24, v26
    v_add_f32 v28, v28, v30
    v_add_f32 v25, v25, v27
    v_add_f32 v29, v29, v31
    v_cvt_pk_bf16_f32 v24, v24, v28
    v_cvt_pk_bf16_f32 v25, v25, v29
    ds_write2_b32 v14, v24, v25 offset0:0 offset1:72
    v_add_f32 v32, v32, v34
    v_add_f32 v33, v33, v35
    v_cvt_pk_bf16_f32 v106, v32, v33
    v_add_f32 v36, v36, v38
    v_add_f32 v37, v37, v39
    v_cvt_pk_bf16_f32 v107, v36, v37
    buffer_store_dwordx2 v[106:107], v0, s[68:71], s19 offen sc1
    s_waitcnt lgkmcnt(0)
    s_barrier
    ds_read_b128 v[72:75], v5 offset:64
    s_waitcnt lgkmcnt(0)
    buffer_store_dwordx4 v[72:75], v1, s[68:71], s18 offen sc1
    s_waitcnt vmcnt(0)
    s_barrier
    s_endpgm
L_cl_6:
    ds_read_b128 v[56:59], v7 offset:0
    ds_read_b128 v[60:63], v7 offset:1024
    ds_read_b128 v[64:67], v7 offset:2048
    ds_read_b128 v[68:71], v7 offset:3072
    ds_read_b128 v[72:75], v7 offset:4096
    ds_read_b128 v[76:79], v7 offset:5120
    ds_read_b128 v[80:83], v7 offset:6144
    ds_read_b128 v[84:87], v7 offset:7168
    ds_read_b128 v[16:19], v12 offset:256
    ds_read_b128 v[20:23], v12 offset:256
    ds_read_b128 v[32:35], v12 offset:256
    ds_read_b128 v[36:39], v12 offset:256
    v_mov_b32 v104, 1
    s_mov_b32 m0, s91
    s_mov_b32 s15, 1048576
    buffer_load_dwordx4 v[24:27], v1, s[68:71], s17 offen offset:0 sc1
    buffer_load_dwordx4 v[28:31], v1, s[68:71], s17 offen offset:1024 sc1
L_chk_s2:
    buffer_load_dwordx4 v[88:91], v1, s[68:71], s17 offen offset:0 sc1
    buffer_load_dwordx4 v[92:95], v1, s[68:71], s17 offen offset:1024 sc1
    s_waitcnt vmcnt(2)
    ds_write_b128 v13, v[24:27] offset:8192
    ds_write_b128 v13, v[28:31] offset:9216
    v_max3_u32 v111, v24, v25, v26
    v_max3_u32 v110, v27, v28, v29
    v_max3_u32 v111, v111, v30, v31
    v_max_u32 v111, v111, v110
    v_cmp_eq_u32 vcc, -1, v111
    s_cbranch_vccz L_bar1_s2
    buffer_load_dwordx4 v[24:27], v1, s[68:71], s17 offen offset:0 sc1
    buffer_load_dwordx4 v[28:31], v1, s[68:71], s17 offen offset:1024 sc1
    s_waitcnt vmcnt(2)
    ds_write_b128 v13, v[88:91] offset:8192
    ds_write_b128 v13, v[92:95] offset:9216
    v_max3_u32 v111, v88, v89, v90
    v_max3_u32 v110, v91, v92, v93
    v_max3_u32 v111, v111, v94, v95
    v_max_u32 v111, v111, v110
    v_cmp_eq_u32 vcc, -1, v111
    s_cbranch_vccnz L_mre_130
L_bar1_s2:
    s_cmp_eq_u32 s14, 63
    s_waitcnt lgkmcnt(0)
    s_barrier
    ds_read_b128 v[40:43], v13 offset:0
    ds_read_b128 v[44:47], v13 offset:1024
    ds_read_b128 v[48:51], v13 offset:2048
    ds_read_b128 v[52:55], v13 offset:3072
    s_cbranch_scc1 L_last_s2
    buffer_store_dwordx2 v[106:107], v0, s[68:71], s29 offen sc1
    s_waitcnt lgkmcnt(3)
    v_smfmac_f32_16x16x64_bf16 v[16:19], v[40:43], a[0:7], v2
    v_smfmac_f32_16x16x64_bf16 v[20:23], v[40:43], a[64:71], v2
    ds_read_b128 v[40:43], v13 offset:8192
    s_waitcnt lgkmcnt(3)
    v_smfmac_f32_16x16x64_bf16 v[16:19], v[44:47], a[8:15], v2
    buffer_load_dwordx4 v1, s[68:71], s26 offen offset:0 sc1 lds
    v_smfmac_f32_16x16x64_bf16 v[20:23], v[44:47], a[72:79], v2
    ds_read_b128 v[44:47], v13 offset:9216
    s_waitcnt lgkmcnt(3)
    v_smfmac_f32_16x16x64_bf16 v[16:19], v[48:51], a[16:23], v2
    v_smfmac_f32_16x16x64_bf16 v[20:23], v[48:51], a[80:87], v2
    ds_read_b128 v[48:51], v13 offset:10240
    s_waitcnt lgkmcnt(3)
    v_smfmac_f32_16x16x64_bf16 v[16:19], v[52:55], a[24:31], v2
    buffer_load_dwordx4 v1, s[68:71], s26 offen offset:1024 sc1 lds
    s_waitcnt vmcnt(3)
    s_nop 0
    v_smfmac_f32_16x16x64_bf16 v[20:23], v[52:55], a[88:95], v2
    ds_read_b128 v[24:27], v5 offset:128
    s_waitcnt lgkmcnt(3)
    v_smfmac_f32_16x16x64_bf16 v[16:19], v[40:43], a[32:39], v2
    ds_read_b128 v[28:31], v12 offset:512
    v_smfmac_f32_16x16x64_bf16 v[20:23], v[40:43], a[96:103], v2
    ds_read_b128 v[88:91], v7 offset:32768
    v_smfmac_f32_16x16x64_bf16 v[32:35], v[40:43], v[56:63], v2
    buffer_load_dwordx4 v1, s[68:71], s26 offen offset:2048 sc1 lds
    s_waitcnt lgkmcnt(1)
    buffer_store_dwordx4 v[28:31], v1, s[68:71], s84 offen sc1
    v_smfmac_f32_16x16x64_bf16 v[36:39], v[40:43], v[64:71], v2
    ds_read_b128 v[92:95], v7 offset:33792
    v_smfmac_f32_16x16x64_bf16 v[16:19], v[44:47], a[40:47], v2
    ds_read_b128 v[52:55], v13 offset:11264
    buffer_store_dwordx4 v[24:27], v1, s[68:71], s28 offen sc1
    v_smfmac_f32_16x16x64_bf16 v[20:23], v[44:47], a[104:111], v2
    ds_read_b128 v[96:99], v7 offset:34816
    v_smfmac_f32_16x16x64_bf16 v[32:35], v[44:47], v[72:79], v2
    buffer_load_dwordx4 v1, s[68:71], s26 offen offset:3072 sc1 lds
    ds_read_b128 v[56:59], v7 offset:36864
    v_smfmac_f32_16x16x64_bf16 v[36:39], v[44:47], v[80:87], v2
    ds_read_b128 v[100:103], v7 offset:35840
    buffer_store_dwordx4 v[28:31], v1, s[68:71], s84 offen offset:1024 sc1
    ds_read_b128 v[24:27], v12 offset:256
    v_smfmac_f32_16x16x64_bf16 v[16:19], v[48:51], a[48:55], v2
    ds_read_b128 v[60:63], v7 offset:37888
    ds_read_b128 v[28:31], v12 offset:256
    v_smfmac_f32_16x16x64_bf16 v[20:23], v[48:51], a[112:119], v2
    ds_read_b128 v[64:67], v7 offset:38912
    s_waitcnt lgkmcnt(7)
    v_smfmac_f32_16x16x64_bf16 v[16:19], v[52:55], a[56:63], v2
    ds_read_b128 v[68:71], v7 offset:39936
    v_smfmac_f32_16x16x64_bf16 v[20:23], v[52:55], a[120:127], v2
    ds_read_b128 v[72:75], v15 offset:0
    s_waitcnt lgkmcnt(3)
    v_smfmac_f32_16x16x64_bf16 v[24:27], v[40:43], a[160:167], v2
    ds_read_b128 v[76:79], v15 offset:1024
    v_smfmac_f32_16x16x64_bf16 v[28:31], v[40:43], a[224:231], v2
    ds_read_b128 v[40:43], v13 offset:0
    v_add_f32 v16, v16, v18
    v_smfmac_f32_16x16x64_bf16 v[24:27], v[44:47], a[168:175], v2
    ds_read_b128 v[80:83], v15 offset:2048
    v_add_f32 v20, v20, v22
    v_smfmac_f32_16x16x64_bf16 v[28:31], v[44:47], a[232:239], v2
    ds_read_b128 v[44:47], v13 offset:1024
    v_add_f32 v17, v17, v19
    v_smfmac_f32_16x16x64_bf16 v[24:27], v[48:51], a[176:183], v2
    ds_read_b128 v[84:87], v15 offset:3072
    v_add_f32 v21, v21, v23
    v_smfmac_f32_16x16x64_bf16 v[28:31], v[48:51], a[240:247], v2
    v_mul_f32 v16, s31, v16
    v_smfmac_f32_16x16x64_bf16 v[32:35], v[48:51], v[88:95], v2
    v_mul_f32 v20, s31, v20
    v_smfmac_f32_16x16x64_bf16 v[36:39], v[48:51], v[96:103], v2
    ds_read_b128 v[88:91], v15 offset:4096
    v_cvt_pk_bf16_f32 v16, v16, v20
    v_smfmac_f32_16x16x64_bf16 v[24:27], v[52:55], a[184:191], v2
    ds_read_b128 v[48:51], v13 offset:2048
    v_mul_f32 v17, s31, v17
    v_smfmac_f32_16x16x64_bf16 v[28:31], v[52:55], a[248:255], v2
    ds_read_b128 v[92:95], v15 offset:5120
    v_mul_f32 v21, s31, v21
    v_smfmac_f32_16x16x64_bf16 v[32:35], v[52:55], v[56:63], v2
    ds_read_b128 v[96:99], v15 offset:6144
    s_waitcnt lgkmcnt(4)
    v_cvt_pk_bf16_f32 v17, v17, v21
    v_smfmac_f32_16x16x64_bf16 v[36:39], v[52:55], v[64:71], v2
    ds_write2_b32 v3, v16, v17 offset0:0 offset1:72
    ds_read_b128 v[52:55], v13 offset:3072
    v_smfmac_f32_16x16x64_bf16 v[24:27], v[40:43], a[128:135], v2
    ds_read_b128 v[100:103], v15 offset:7168
    v_smfmac_f32_16x16x64_bf16 v[28:31], v[40:43], a[192:199], v2
    v_smfmac_f32_16x16x64_bf16 v[24:27], v[44:47], a[136:143], v2
    s_waitcnt lgkmcnt(2)
    s_barrier
    ds_read_b128 v[56:59], v4 offset:0
    v_smfmac_f32_16x16x64_bf16 v[28:31], v[44:47], a[200:207], v2
    ds_read_b128 v[60:63], v4 offset:64
    v_smfmac_f32_16x16x64_bf16 v[24:27], v[48:51], a[144:151], v2
    ds_read_b128 v[64:67], v4 offset:128
    v_smfmac_f32_16x16x64_bf16 v[28:31], v[48:51], a[208:215], v2
    ds_read_b128 v[68:71], v4 offset:192
    s_waitcnt lgkmcnt(5)
    v_smfmac_f32_16x16x64_bf16 v[24:27], v[52:55], a[152:159], v2
    v_smfmac_f32_16x16x64_bf16 v[28:31], v[52:55], a[216:223], v2
    v_smfmac_f32_16x16x64_bf16 v[32:35], v[40:43], v[128:135], v2
    s_waitcnt lgkmcnt(3)
    v_mfma_f32_16x16x32_bf16 v[16:19], v[72:75], v[56:59], 0
    s_waitcnt lgkmcnt(2)
    v_add_f32 v24, v24, v26
    v_add_f32 v28, v28, v30
    v_mfma_f32_16x16x32_bf16 v[16:19], v[76:79], v[60:63], v[16:19]
    s_waitcnt lgkmcnt(1)
    v_add_f32 v25, v25, v27
    v_add_f32 v29, v29, v31
    v_mfma_f32_16x16x32_bf16 v[16:19], v[80:83], v[64:67], v[16:19]
    s_waitcnt lgkmcnt(0)
    v_cvt_pk_bf16_f32 v24, v24, v28
    v_cvt_pk_bf16_f32 v25, v25, v29
    v_mfma_f32_16x16x32_bf16 v[16:19], v[84:87], v[68:71], v[16:19]
    ds_write2_b32 v14, v24, v25 offset0:0 offset1:72
    v_mfma_f32_16x16x32_bf16 v[20:23], v[88:91], v[56:59], 0
    v_mfma_f32_16x16x32_bf16 v[20:23], v[92:95], v[60:63], v[20:23]
    v_exp_f32 v16, v16
    v_mfma_f32_16x16x32_bf16 v[20:23], v[96:99], v[64:67], v[20:23]
    s_waitcnt lgkmcnt(0)
    s_barrier
    ds_read_b128 v[72:75], v5 offset:0
    ds_read_b128 v[76:79], v5 offset:64
    ds_read_b128 v[80:83], v5 offset:128
    ds_read_b128 v[84:87], v5 offset:192
    v_exp_f32 v17, v17
    v_mfma_f32_16x16x32_bf16 v[20:23], v[100:103], v[68:71], v[20:23]
    ds_read_b128 v[88:91], v15 offset:12288
    v_exp_f32 v18, v18
    v_smfmac_f32_16x16x64_bf16 v[36:39], v[40:43], v[136:143], v2
    ds_read_b128 v[92:95], v15 offset:13312
    v_exp_f32 v19, v19
    v_smfmac_f32_16x16x64_bf16 v[32:35], v[44:47], v[144:151], v2
    ds_read_b128 v[100:103], v12 offset:0
    v_exp_f32 v20, v20
    v_smfmac_f32_16x16x64_bf16 v[36:39], v[44:47], v[152:159], v2
    v_exp_f32 v21, v21
    v_smfmac_f32_16x16x64_bf16 v[32:35], v[48:51], v[160:167], v2
    v_exp_f32 v22, v22
    v_smfmac_f32_16x16x64_bf16 v[36:39], v[48:51], v[168:175], v2
    v_exp_f32 v23, v23
    v_smfmac_f32_16x16x64_bf16 v[32:35], v[52:55], v[176:183], v2
    v_cvt_pk_bf16_f32 v16, v16, v17
    v_smfmac_f32_16x16x64_bf16 v[36:39], v[52:55], v[184:191], v2
    ds_read_b128 v[40:43], v12 offset:256
    s_waitcnt lgkmcnt(1)
    v_cvt_pk_bf16_f32 v17, v18, v19
    v_mfma_f32_16x16x32_bf16 v[96:99], v[72:75], v[56:59], 0
    v_cvt_pk_bf16_f32 v18, v20, v21
    v_cvt_pk_bf16_f32 v19, v22, v23
    v_mfma_f32_16x16x32_bf16 v[96:99], v[76:79], v[60:63], v[96:99]
    v_add_f32 v32, v32, v34
    v_add_f32 v33, v33, v35
    v_mfma_f32_16x16x32_bf16 v[96:99], v[80:83], v[64:67], v[96:99]
    v_cvt_pk_bf16_f32 v106, v32, v33
    v_add_f32 v36, v36, v38
    v_mfma_f32_16x16x32_bf16 v[96:99], v[84:87], v[68:71], v[96:99]
    v_add_f32 v37, v37, v39
    v_cvt_pk_bf16_f32 v107, v36, v37
    v_mfma_f32_16x16x32_bf16 v[20:23], v[100:103], v[16:19], 0
    ds_read_b128 v[44:47], v12 offset:256
    v_mfma_f32_16x16x32_bf16 v[24:27], v[88:91], v[16:19], 0
    v_exp_f32 v96, v96
    v_exp_f32 v97, v97
    v_mfma_f32_16x16x32_bf16 v[28:31], v[92:95], v[16:19], 0
    ds_read_b128 v[48:51], v12 offset:256
    v_cvt_pk_bf16_f32 v104, v96, v97
    v_cvt_pk_bf16_f32 v109, v96, v97
    s_nop 0
    v_mfma_f32_16x16x16_bf16 v[20:23], v[100:101], v[104:105], v[20:23]
    ds_read_b128 v[52:55], v12 offset:256
    v_mfma_f32_16x16x16_bf16 v[24:27], v[106:107], v[104:105], v[24:27]
    ds_read_b128 v[72:75], v8 offset:0
    v_mfma_f32_16x16x16_bf16 v[28:31], v[106:107], v[108:109], v[28:31]
    ds_read_b128 v[76:79], v8 offset:1024
    v_rcp_f32 v110, v20
    s_nop 0
    v_max_f32 v21, v20, v110
    v_cmp_ngt_f32 vcc, s32, v21
L_smback_132:
    v_pk_mul_f32 v[24:25], v[24:25], v[110:111] op_sel_hi:[1,0]
    v_pk_mul_f32 v[26:27], v[26:27], v[110:111] op_sel_hi:[1,0]
    v_pk_mul_f32 v[28:29], v[28:29], v[110:111] op_sel_hi:[1,0]
    v_pk_mul_f32 v[30:31], v[30:31], v[110:111] op_sel_hi:[1,0]
    s_mov_b64 exec, s[88:89]
    v_cvt_pk_bf16_f32 v24, v24, v25
    v_cvt_pk_bf16_f32 v25, v26, v27
    v_cvt_pk_bf16_f32 v26, v28, v29
    v_cvt_pk_bf16_f32 v27, v30, v31
    ds_write_b128 v6, v[24:27]
    s_mov_b64 exec, -1
    s_cbranch_vccnz L_slowsm_131
    ds_read_b128 v[80:83], v8 offset:4096
    ds_read_b128 v[84:87], v8 offset:5120
    s_waitcnt lgkmcnt(2)
    s_barrier
    ds_read_b128 v[24:27], v13 offset:16384
    ds_read_b128 v[28:31], v13 offset:17408
    ds_read_b128 v[56:59], v12 offset:256
    ds_read_b128 v[60:63], v12 offset:256
    ds_read_b128 v[88:91], v8 offset:2048
    s_waitcnt lgkmcnt(4)
    v_smfmac_f32_16x16x64_bf16 v[40:43], v[24:27], v[192:199], v2
    ds_read_b128 v[92:95], v8 offset:3072
    v_smfmac_f32_16x16x64_bf16 v[44:47], v[24:27], v[208:215], v2
    ds_read_b128 v[96:99], v8 offset:6144
    s_waitcnt lgkmcnt(5)
    v_smfmac_f32_16x16x64_bf16 v[40:43], v[28:31], v[200:207], v2
    ds_read_b128 v[100:103], v8 offset:7168
    s_mov_b32 s11, s24
    v_smfmac_f32_16x16x64_bf16 v[44:47], v[28:31], v[216:223], v2
    ds_read_b128 v[64:67], v12 offset:256
    s_mov_b32 s12, s23
    v_smfmac_f32_16x16x64_bf16 v[48:51], v[24:27], v[224:231], v2
    ds_read_b128 v[68:71], v12 offset:256
    v_add_f32 v40, v40, v42
    v_add_f32 v41, v41, v43
    v_smfmac_f32_16x16x64_bf16 v[52:55], v[24:27], v[240:247], v2
    ds_read_b128 v[32:35], v8 offset:32768
    v_add_f32 v44, v44, v46
    v_smfmac_f32_16x16x64_bf16 v[48:51], v[28:31], v[232:239], v2
    ds_read_b128 v[36:39], v8 offset:33792
    v_add_f32 v45, v45, v47
    v_smfmac_f32_16x16x64_bf16 v[52:55], v[28:31], v[248:255], v2
    ds_read_b128 v[16:19], v8 offset:34816
    s_waitcnt lgkmcnt(9)
    v_cvt_pk_bf16_f32 v40, v40, v44
    v_smfmac_f32_16x16x64_bf16 v[56:59], v[24:27], v[72:79], v2
    ds_read_b128 v[20:23], v8 offset:35840
    v_cvt_pk_bf16_f32 v41, v41, v45
    v_add_f32 v48, v48, v50
    v_add_f32 v49, v49, v51
    v_smfmac_f32_16x16x64_bf16 v[60:63], v[24:27], v[80:87], v2
    s_waitcnt lgkmcnt(8)
    v_add_f32 v52, v52, v54
    v_add_f32 v53, v53, v55
    v_smfmac_f32_16x16x64_bf16 v[56:59], v[28:31], v[88:95], v2
    v_cvt_pk_bf16_f32 v42, v48, v52
    v_cvt_pk_bf16_f32 v43, v49, v53
    buffer_store_dwordx4 v[40:43], v9, s[68:71], s85 offen sc1
    s_waitcnt lgkmcnt(6)
    v_smfmac_f32_16x16x64_bf16 v[60:63], v[28:31], v[96:103], v2
    s_mov_b32 s13, s22
    s_mov_b32 s15, 1048576
    s_waitcnt lgkmcnt(4)
    v_smfmac_f32_16x16x64_bf16 v[64:67], v[24:27], v[112:119], v2
    s_waitcnt lgkmcnt(2)
    v_add_f32 v56, v56, v58
    v_add_f32 v57, v57, v59
    v_smfmac_f32_16x16x64_bf16 v[64:67], v[28:31], v[32:39], v2
    ds_read_b128 v[88:91], v13 offset:26880
    v_add_f32 v60, v60, v62
    v_smfmac_f32_16x16x64_bf16 v[68:71], v[24:27], v[120:127], v2
    s_mov_b32 s10, s27
    s_waitcnt lgkmcnt(1)
    v_add_f32 v61, v61, v63
    v_smfmac_f32_16x16x64_bf16 v[68:71], v[28:31], v[16:23], v2
    v_cvt_pk_bf16_f32 v56, v56, v60
    v_cvt_pk_bf16_f32 v57, v57, v61
    v_pk_add_f32 v[64:65], v[64:65], v[66:67]
    s_nop 2
    v_pk_add_f32 v[68:69], v[68:69], v[70:71]
    v_cvt_pk_bf16_f32 v58, v64, v68
    v_cvt_pk_bf16_f32 v59, v65, v69
    buffer_store_dwordx4 v[56:59], v9, s[68:71], s86 offen sc1
    s_nop 1
    ds_read_b128 v[56:59], v7 offset:0
    ds_read_b128 v[60:63], v7 offset:1024
    ds_read_b128 v[64:67], v7 offset:2048
    ds_read_b128 v[68:71], v7 offset:3072
    ds_read_b128 v[72:75], v7 offset:4096
    ds_read_b128 v[76:79], v7 offset:5120
    ds_read_b128 v[80:83], v7 offset:6144
    ds_read_b128 v[84:87], v7 offset:7168
    ds_read_b128 v[16:19], v12 offset:256
    ds_read_b128 v[20:23], v12 offset:256
    ds_read_b128 v[32:35], v12 offset:256
    ds_read_b128 v[36:39], v12 offset:256
    s_mov_b32 s7, s23
    s_mov_b32 s23, s24
    s_mov_b32 s24, s25
    s_mov_b32 s25, s7
    s_add_u32 s17, s23, s16
    s_add_u32 s21, s21, 1
    s_mov_b32 s87, 262144
    s_cmp_eq_u32 s21, 3
    s_cselect_b32 s87, 0xfff80000, s87
    s_cselect_b32 s21, 0, s21
    s_add_u32 s85, s85, s87
    s_add_u32 s86, s86, s87
    s_add_u32 s22, s22, s87
    s_add_u32 s84, s84, s90
    s_mov_b32 s90, s87
    s_add_u32 s14, s14, 1
    s_mov_b32 s28, s18
    s_mov_b32 s29, s19
    s_add_u32 s18, s18, 131072
    s_add_u32 s19, s19, 65536
    s_mov_b32 s30, s20
    s_mov_b32 s20, s33
    s_add_u32 s33, s33, 128
    v_mov_b32 v104, 1
    s_add_u32 s27, s27, 128
    s_xor_b32 s91, s91, 16384
    s_add_u32 s26, s26, 262144
    s_mov_b32 m0, s91
    buffer_load_dwordx4 v[40:43], v1, s[68:71], s13 offen sc1
    buffer_load_dwordx4 v[44:47], v1, s[68:71], s13 offen offset:1024 sc1
    s_nop 7
    s_nop 7
    v_xor_b32 v15, 0x4000, v15
    s_nop 7
    s_nop 7
    v_mov_b32 v111, -1
    s_waitcnt lgkmcnt(12)
L_ra_133:
    buffer_load_dwordx4 v[48:51], v1, s[68:71], s13 offen sc1
    buffer_load_dwordx4 v[52:55], v1, s[68:71], s13 offen offset:1024 sc1
    s_waitcnt vmcnt(3)
    v_mfma_f32_16x16x32_bf16 v[92:95], v[88:91], v[40:43], 0
    s_waitcnt vmcnt(2)
    v_mfma_f32_16x16x32_bf16 v[92:95], v[88:91], v[44:47], v[92:95]
    s_nop 7
    v_cmp_u_f32 vcc, v92, v93
    v_add_f32_dpp v92, v92, v92 row_ror:4 row_mask:0xf bank_mask:0xf
    v_add_f32_dpp v93, v93, v93 row_ror:4 row_mask:0xf bank_mask:0xf
    s_cbranch_vccz L_rdone_135
    buffer_load_dwordx4 v[40:43], v1, s[68:71], s13 offen sc1
    buffer_load_dwordx4 v[44:47], v1, s[68:71], s13 offen offset:1024 sc1
    s_waitcnt vmcnt(3)
    v_mfma_f32_16x16x32_bf16 v[92:95], v[88:91], v[48:51], 0
    s_waitcnt vmcnt(2)
    v_mfma_f32_16x16x32_bf16 v[92:95], v[88:91], v[52:55], v[92:95]
    s_nop 7
    v_cmp_u_f32 vcc, v92, v93
    v_add_f32_dpp v92, v92, v92 row_ror:4 row_mask:0xf bank_mask:0xf
    v_add_f32_dpp v93, v93, v93 row_ror:4 row_mask:0xf bank_mask:0xf
    s_cbranch_vccnz L_rslow_134
L_rdone_135:
    v_add_f32_dpp v92, v92, v92 row_ror:8 row_mask:0xf bank_mask:0xf
    v_add_f32_dpp v93, v93, v93 row_ror:8 row_mask:0xf bank_mask:0xf
    v_cvt_pk_bf16_f32 v110, v92, v93
    v_min_u32 v110, 0xfffffffe, v110
    buffer_store_dword v110, v10, s[68:71], s11 offen sc1
    buffer_store_dword v111, v10, s[68:71], s12 offen sc1
L_kvok_136:
    s_mov_b32 s15, 1048576
    s_nop 7
    s_nop 7
    s_nop 7
    s_nop 7
    s_nop 7
    s_nop 7
    buffer_load_dwordx4 v[24:27], v1, s[68:71], s17 offen offset:0 sc1
    buffer_load_dwordx4 v[28:31], v1, s[68:71], s17 offen offset:1024 sc1
    s_nop 7
    s_nop 7
    s_nop 7
    s_nop 7
    s_branch L_chk_s2
L_mre_130:
    s_sub_u32 s15, s15, 1
    s_cmp_lg_u32 s15, 0
    s_cbranch_scc1 L_chk_s2
    s_branch L_err_8
L_rslow_134:
    s_sub_u32 s15, s15, 1
    s_cmp_eq_u32 s15, 0
    s_cbranch_scc1 L_err_10
    s_and_b32 s7, s15, 3
    s_cmp_lg_u32 s7, 0
    s_cbranch_scc1 L_ra_133
    s_mov_b64 s[98:99], 0
    v_mov_b32 v110, 0xffbfffbf
    v_cmp_eq_u32 vcc, v110, v48
    s_nop 0
    s_or_b64 s[98:99], s[98:99], vcc
    v_cmp_eq_u32 vcc, v110, v49
    s_nop 0
    s_or_b64 s[98:99], s[98:99], vcc
    v_cmp_eq_u32 vcc, v110, v50
    s_nop 0
    s_or_b64 s[98:99], s[98:99], vcc
    v_cmp_eq_u32 vcc, v110, v51
    s_nop 0
    s_or_b64 s[98:99], s[98:99], vcc
    v_cmp_eq_u32 vcc, v110, v52
    s_nop 0
    s_or_b64 s[98:99], s[98:99], vcc
    v_cmp_eq_u32 vcc, v110, v53
    s_nop 0
    s_or_b64 s[98:99], s[98:99], vcc
    v_cmp_eq_u32 vcc, v110, v54
    s_nop 0
    s_or_b64 s[98:99], s[98:99], vcc
    v_cmp_eq_u32 vcc, v110, v55
    s_nop 0
    s_or_b64 s[98:99], s[98:99], vcc
    s_cmp_eq_u64 s[98:99], 0
    s_cbranch_scc1 L_rdone_135
    s_branch L_ra_133
L_slowsm_131:
    s_waitcnt lgkmcnt(0)
    ds_read_b128 v[72:75], v15 offset:0
    ds_read_b128 v[88:91], v15 offset:4096
    ds_read_b128 v[76:79], v15 offset:1024
    ds_read_b128 v[92:95], v15 offset:5120
    ds_read_b128 v[80:83], v15 offset:2048
    ds_read_b128 v[96:99], v15 offset:6144
    ds_read_b128 v[84:87], v15 offset:3072
    ds_read_b128 v[100:103], v15 offset:7168
    s_waitcnt lgkmcnt(0)
    v_mfma_f32_16x16x32_bf16 v[16:19], v[72:75], v[56:59], 0
    v_mfma_f32_16x16x32_bf16 v[16:19], v[76:79], v[60:63], v[16:19]
    v_mfma_f32_16x16x32_bf16 v[16:19], v[80:83], v[64:67], v[16:19]
    v_mfma_f32_16x16x32_bf16 v[16:19], v[84:87], v[68:71], v[16:19]
    v_mfma_f32_16x16x32_bf16 v[20:23], v[88:91], v[56:59], 0
    v_mfma_f32_16x16x32_bf16 v[20:23], v[92:95], v[60:63], v[20:23]
    v_mfma_f32_16x16x32_bf16 v[20:23], v[96:99], v[64:67], v[20:23]
    v_mfma_f32_16x16x32_bf16 v[20:23], v[100:103], v[68:71], v[20:23]
    ds_read_b128 v[72:75], v5 offset:0
    ds_read_b128 v[76:79], v5 offset:64
    ds_read_b128 v[80:83], v5 offset:128
    ds_read_b128 v[84:87], v5 offset:192
    ds_read_b128 v[88:91], v15 offset:12288
    ds_read_b128 v[92:95], v15 offset:13312
    ds_read_b128 v[100:103], v12 offset:0
    s_waitcnt lgkmcnt(0)
    v_mfma_f32_16x16x32_bf16 v[96:99], v[72:75], v[56:59], 0
    v_mfma_f32_16x16x32_bf16 v[96:99], v[76:79], v[60:63], v[96:99]
    v_mfma_f32_16x16x32_bf16 v[96:99], v[80:83], v[64:67], v[96:99]
    v_mfma_f32_16x16x32_bf16 v[96:99], v[84:87], v[68:71], v[96:99]
    v_max3_f32 v110, v16, v17, v18
    v_max3_f32 v110, v110, v19, v20
    v_max3_f32 v110, v110, v21, v22
    v_max_f32 v110, v110, v23
    s_nop 2
    v_max3_f32 v110, v110, v96, v97
    v_mov_b32 v98, v110
    s_nop 1
    v_permlane16_swap_b32 v110, v98
    v_max_f32 v110, v110, v98
    v_mov_b32 v98, v110
    s_nop 1
    v_permlane32_swap_b32 v110, v98
    v_max_f32 v110, v110, v98
    v_sub_f32 v16, v16, v110
    v_exp_f32 v16, v16
    v_sub_f32 v17, v17, v110
    v_exp_f32 v17, v17
    v_sub_f32 v18, v18, v110
    v_exp_f32 v18, v18
    v_sub_f32 v19, v19, v110
    v_exp_f32 v19, v19
    v_sub_f32 v20, v20, v110
    v_exp_f32 v20, v20
    v_sub_f32 v21, v21, v110
    v_exp_f32 v21, v21
    v_sub_f32 v22, v22, v110
    v_exp_f32 v22, v22
    v_sub_f32 v23, v23, v110
    v_exp_f32 v23, v23
    v_sub_f32 v96, v96, v110
    v_exp_f32 v96, v96
    v_sub_f32 v97, v97, v110
    v_exp_f32 v97, v97
    v_cvt_pk_bf16_f32 v16, v16, v17
    v_cvt_pk_bf16_f32 v17, v18, v19
    v_cvt_pk_bf16_f32 v18, v20, v21
    v_cvt_pk_bf16_f32 v19, v22, v23
    v_cvt_pk_bf16_f32 v104, v96, v97
    v_cvt_pk_bf16_f32 v109, v96, v97
    v_mfma_f32_16x16x32_bf16 v[20:23], v[100:103], v[16:19], 0
    v_mfma_f32_16x16x32_bf16 v[24:27], v[88:91], v[16:19], 0
    v_mfma_f32_16x16x32_bf16 v[28:31], v[92:95], v[16:19], 0
    v_mfma_f32_16x16x16_bf16 v[20:23], v[100:101], v[104:105], v[20:23]
    v_mfma_f32_16x16x16_bf16 v[24:27], v[106:107], v[104:105], v[24:27]
    v_mfma_f32_16x16x16_bf16 v[28:31], v[106:107], v[108:109], v[28:31]
    ds_read_b128 v[72:75], v8 offset:0
    ds_read_b128 v[76:79], v8 offset:1024
    ds_read_b128 v[80:83], v8 offset:4096
    ds_read_b128 v[84:87], v8 offset:5120
    ds_read_b128 v[88:91], v8 offset:2048
    ds_read_b128 v[92:95], v8 offset:3072
    ds_read_b128 v[96:99], v8 offset:6144
    ds_read_b128 v[100:103], v8 offset:7168
    v_rcp_f32 v110, v20
    s_waitcnt lgkmcnt(0)
    s_mov_b64 vcc, 0
    s_nop 7
    s_branch L_smback_132
L_last_s2:
    buffer_store_dwordx2 v[106:107], v0, s[68:71], s29 offen sc1
    ds_read_b128 v[16:19], v5 offset:128
    s_waitcnt vmcnt(1)
    ds_read_b128 v[88:91], v7 offset:32768
    ds_read_b128 v[92:95], v7 offset:33792
    ds_read_b128 v[96:99], v7 offset:34816
    ds_read_b128 v[100:103], v7 offset:35840
    ds_read_b128 v[24:27], v12 offset:256
    ds_read_b128 v[28:31], v12 offset:256
    s_waitcnt lgkmcnt(0)
    buffer_store_dwordx4 v[16:19], v1, s[68:71], s28 offen sc1
    s_barrier
    v_smfmac_f32_16x16x64_bf16 v[24:27], v[40:43], a[128:135], v2
    v_smfmac_f32_16x16x64_bf16 v[28:31], v[40:43], a[192:199], v2
    v_smfmac_f32_16x16x64_bf16 v[32:35], v[40:43], v[128:135], v2
    v_smfmac_f32_16x16x64_bf16 v[36:39], v[40:43], v[136:143], v2
    ds_read_b128 v[40:43], v13 offset:8192
    v_smfmac_f32_16x16x64_bf16 v[24:27], v[44:47], a[136:143], v2
    v_smfmac_f32_16x16x64_bf16 v[28:31], v[44:47], a[200:207], v2
    v_smfmac_f32_16x16x64_bf16 v[32:35], v[44:47], v[144:151], v2
    v_smfmac_f32_16x16x64_bf16 v[36:39], v[44:47], v[152:159], v2
    ds_read_b128 v[44:47], v13 offset:9216
    v_smfmac_f32_16x16x64_bf16 v[24:27], v[48:51], a[144:151], v2
    v_smfmac_f32_16x16x64_bf16 v[28:31], v[48:51], a[208:215], v2
    v_smfmac_f32_16x16x64_bf16 v[32:35], v[48:51], v[160:167], v2
    v_smfmac_f32_16x16x64_bf16 v[36:39], v[48:51], v[168:175], v2
    ds_read_b128 v[48:51], v13 offset:10240
    v_smfmac_f32_16x16x64_bf16 v[24:27], v[52:55], a[152:159], v2
    v_smfmac_f32_16x16x64_bf16 v[28:31], v[52:55], a[216:223], v2
    v_smfmac_f32_16x16x64_bf16 v[32:35], v[52:55], v[176:183], v2
    v_smfmac_f32_16x16x64_bf16 v[36:39], v[52:55], v[184:191], v2
    ds_read_b128 v[52:55], v13 offset:11264
    s_waitcnt lgkmcnt(3)
    v_smfmac_f32_16x16x64_bf16 v[24:27], v[40:43], a[160:167], v2
    v_smfmac_f32_16x16x64_bf16 v[28:31], v[40:43], a[224:231], v2
    v_smfmac_f32_16x16x64_bf16 v[32:35], v[40:43], v[56:63], v2
    v_smfmac_f32_16x16x64_bf16 v[36:39], v[40:43], v[64:71], v2
    ds_read_b128 v[56:59], v7 offset:36864
    ds_read_b128 v[60:63], v7 offset:37888
    ds_read_b128 v[64:67], v7 offset:38912
    ds_read_b128 v[68:71], v7 offset:39936
    s_waitcnt lgkmcnt(6)
    v_smfmac_f32_16x16x64_bf16 v[24:27], v[44:47], a[168:175], v2
    v_smfmac_f32_16x16x64_bf16 v[28:31], v[44:47], a[232:239], v2
    v_smfmac_f32_16x16x64_bf16 v[32:35], v[44:47], v[72:79], v2
    v_smfmac_f32_16x16x64_bf16 v[36:39], v[44:47], v[80:87], v2
    s_waitcnt lgkmcnt(5)
    v_smfmac_f32_16x16x64_bf16 v[24:27], v[48:51], a[176:183], v2
    v_smfmac_f32_16x16x64_bf16 v[28:31], v[48:51], a[240:247], v2
    v_smfmac_f32_16x16x64_bf16 v[32:35], v[48:51], v[88:95], v2
    v_smfmac_f32_16x16x64_bf16 v[36:39], v[48:51], v[96:103], v2
    s_waitcnt lgkmcnt(4)
    v_smfmac_f32_16x16x64_bf16 v[24:27], v[52:55], a[184:191], v2
    v_smfmac_f32_16x16x64_bf16 v[28:31], v[52:55], a[248:255], v2
    s_waitcnt lgkmcnt(2)
    v_smfmac_f32_16x16x64_bf16 v[32:35], v[52:55], v[56:63], v2
    s_waitcnt lgkmcnt(0)
    v_smfmac_f32_16x16x64_bf16 v[36:39], v[52:55], v[64:71], v2
    v_add_f32 v24, v24, v26
    v_add_f32 v28, v28, v30
    v_add_f32 v25, v25, v27
    v_add_f32 v29, v29, v31
    v_cvt_pk_bf16_f32 v24, v24, v28
    v_cvt_pk_bf16_f32 v25, v25, v29
    ds_write2_b32 v14, v24, v25 offset0:0 offset1:72
    v_add_f32 v32, v32, v34
    v_add_f32 v33, v33, v35
    v_cvt_pk_bf16_f32 v106, v32, v33
    v_add_f32 v36, v36, v38
    v_add_f32 v37, v37, v39
    v_cvt_pk_bf16_f32 v107, v36, v37
    buffer_store_dwordx2 v[106:107], v0, s[68:71], s19 offen sc1
    s_waitcnt lgkmcnt(0)
    s_barrier
    ds_read_b128 v[72:75], v5 offset:128
    s_waitcnt lgkmcnt(0)
    buffer_store_dwordx4 v[72:75], v1, s[68:71], s18 offen sc1
    s_waitcnt vmcnt(0)
    s_barrier
    s_endpgm
L_cl_7:
    ds_read_b128 v[56:59], v7 offset:0
    ds_read_b128 v[60:63], v7 offset:1024
    ds_read_b128 v[64:67], v7 offset:2048
    ds_read_b128 v[68:71], v7 offset:3072
    ds_read_b128 v[72:75], v7 offset:4096
    ds_read_b128 v[76:79], v7 offset:5120
    ds_read_b128 v[80:83], v7 offset:6144
    ds_read_b128 v[84:87], v7 offset:7168
    ds_read_b128 v[16:19], v12 offset:256
    ds_read_b128 v[20:23], v12 offset:256
    ds_read_b128 v[32:35], v12 offset:256
    ds_read_b128 v[36:39], v12 offset:256
    v_mov_b32 v104, 1
    s_mov_b32 m0, s91
    s_mov_b32 s15, 1048576
    buffer_load_dwordx4 v[24:27], v1, s[68:71], s17 offen offset:0 sc1
    buffer_load_dwordx4 v[28:31], v1, s[68:71], s17 offen offset:1024 sc1
L_chk_s3:
    buffer_load_dwordx4 v[88:91], v1, s[68:71], s17 offen offset:0 sc1
    buffer_load_dwordx4 v[92:95], v1, s[68:71], s17 offen offset:1024 sc1
    s_waitcnt vmcnt(2)
    ds_write_b128 v13, v[24:27] offset:10240
    ds_write_b128 v13, v[28:31] offset:11264
    v_max3_u32 v111, v24, v25, v26
    v_max3_u32 v110, v27, v28, v29
    v_max3_u32 v111, v111, v30, v31
    v_max_u32 v111, v111, v110
    v_cmp_eq_u32 vcc, -1, v111
    s_cbranch_vccz L_bar1_s3
    buffer_load_dwordx4 v[24:27], v1, s[68:71], s17 offen offset:0 sc1
    buffer_load_dwordx4 v[28:31], v1, s[68:71], s17 offen offset:1024 sc1
    s_waitcnt vmcnt(2)
    ds_write_b128 v13, v[88:91] offset:10240
    ds_write_b128 v13, v[92:95] offset:11264
    v_max3_u32 v111, v88, v89, v90
    v_max3_u32 v110, v91, v92, v93
    v_max3_u32 v111, v111, v94, v95
    v_max_u32 v111, v111, v110
    v_cmp_eq_u32 vcc, -1, v111
    s_cbranch_vccnz L_mre_138
L_bar1_s3:
    s_cmp_eq_u32 s14, 63
    s_waitcnt lgkmcnt(0)
    s_barrier
    ds_read_b128 v[40:43], v13 offset:0
    ds_read_b128 v[44:47], v13 offset:1024
    ds_read_b128 v[48:51], v13 offset:2048
    ds_read_b128 v[52:55], v13 offset:3072
    s_cbranch_scc1 L_last_s3
    buffer_store_dwordx2 v[106:107], v0, s[68:71], s29 offen sc1
    s_waitcnt lgkmcnt(3)
    v_smfmac_f32_16x16x64_bf16 v[16:19], v[40:43], a[0:7], v2
    v_smfmac_f32_16x16x64_bf16 v[20:23], v[40:43], a[64:71], v2
    s_mov_b64 exec, 1
    buffer_store_dword v104, off, s[68:71], s30 sc1
    s_mov_b64 exec, -1
    s_waitcnt lgkmcnt(2)
    v_smfmac_f32_16x16x64_bf16 v[16:19], v[44:47], a[8:15], v2
    ds_read_b128 v[40:43], v13 offset:8192
    v_smfmac_f32_16x16x64_bf16 v[20:23], v[44:47], a[72:79], v2
    buffer_load_dwordx4 v1, s[68:71], s26 offen offset:0 sc1 lds
    s_waitcnt lgkmcnt(2)
    v_smfmac_f32_16x16x64_bf16 v[16:19], v[48:51], a[16:23], v2
    ds_read_b128 v[44:47], v13 offset:9216
    v_smfmac_f32_16x16x64_bf16 v[20:23], v[48:51], a[80:87], v2
    ds_read_b128 v[48:51], v13 offset:10240
    s_waitcnt lgkmcnt(3)
    v_smfmac_f32_16x16x64_bf16 v[16:19], v[52:55], a[24:31], v2
    s_waitcnt vmcnt(3)
    s_nop 0
    ds_read_b128 v[24:27], v5 offset:192
    v_smfmac_f32_16x16x64_bf16 v[20:23], v[52:55], a[88:95], v2
    buffer_load_dwordx4 v1, s[68:71], s26 offen offset:1024 sc1 lds
    s_waitcnt lgkmcnt(3)
    v_smfmac_f32_16x16x64_bf16 v[16:19], v[40:43], a[32:39], v2
    ds_read_b128 v[28:31], v12 offset:512
    v_smfmac_f32_16x16x64_bf16 v[20:23], v[40:43], a[96:103], v2
    ds_read_b128 v[88:91], v7 offset:32768
    v_smfmac_f32_16x16x64_bf16 v[32:35], v[40:43], v[56:63], v2
    ds_read_b128 v[92:95], v7 offset:33792
    v_smfmac_f32_16x16x64_bf16 v[36:39], v[40:43], v[64:71], v2
    buffer_load_dwordx4 v1, s[68:71], s26 offen offset:2048 sc1 lds
    s_waitcnt lgkmcnt(2)
    buffer_store_dwordx4 v[28:31], v1, s[68:71], s84 offen sc1
    v_smfmac_f32_16x16x64_bf16 v[16:19], v[44:47], a[40:47], v2
    ds_read_b128 v[52:55], v13 offset:11264
    v_smfmac_f32_16x16x64_bf16 v[20:23], v[44:47], a[104:111], v2
    ds_read_b128 v[96:99], v7 offset:34816
    v_smfmac_f32_16x16x64_bf16 v[32:35], v[44:47], v[72:79], v2
    ds_read_b128 v[56:59], v7 offset:36864
    buffer_store_dwordx4 v[24:27], v1, s[68:71], s28 offen sc1
    v_smfmac_f32_16x16x64_bf16 v[36:39], v[44:47], v[80:87], v2
    buffer_load_dwordx4 v1, s[68:71], s26 offen offset:3072 sc1 lds
    ds_read_b128 v[100:103], v7 offset:35840
    ds_read_b128 v[24:27], v12 offset:256
    v_smfmac_f32_16x16x64_bf16 v[16:19], v[48:51], a[48:55], v2
    ds_read_b128 v[60:63], v7 offset:37888
    buffer_store_dwordx4 v[28:31], v1, s[68:71], s84 offen offset:1024 sc1
    s_nop 1
    ds_read_b128 v[28:31], v12 offset:256
    v_smfmac_f32_16x16x64_bf16 v[20:23], v[48:51], a[112:119], v2
    ds_read_b128 v[64:67], v7 offset:38912
    s_waitcnt lgkmcnt(7)
    v_smfmac_f32_16x16x64_bf16 v[16:19], v[52:55], a[56:63], v2
    ds_read_b128 v[68:71], v7 offset:39936
    v_smfmac_f32_16x16x64_bf16 v[20:23], v[52:55], a[120:127], v2
    ds_read_b128 v[72:75], v15 offset:0
    s_waitcnt lgkmcnt(3)
    v_smfmac_f32_16x16x64_bf16 v[24:27], v[40:43], a[160:167], v2
    ds_read_b128 v[76:79], v15 offset:1024
    v_smfmac_f32_16x16x64_bf16 v[28:31], v[40:43], a[224:231], v2
    ds_read_b128 v[40:43], v13 offset:0
    v_add_f32 v16, v16, v18
    v_smfmac_f32_16x16x64_bf16 v[24:27], v[44:47], a[168:175], v2
    ds_read_b128 v[80:83], v15 offset:2048
    v_add_f32 v20, v20, v22
    v_smfmac_f32_16x16x64_bf16 v[28:31], v[44:47], a[232:239], v2
    ds_read_b128 v[44:47], v13 offset:1024
    v_add_f32 v17, v17, v19
    v_smfmac_f32_16x16x64_bf16 v[24:27], v[48:51], a[176:183], v2
    ds_read_b128 v[84:87], v15 offset:3072
    v_add_f32 v21, v21, v23
    v_smfmac_f32_16x16x64_bf16 v[28:31], v[48:51], a[240:247], v2
    v_mul_f32 v16, s31, v16
    v_smfmac_f32_16x16x64_bf16 v[32:35], v[48:51], v[88:95], v2
    v_mul_f32 v20, s31, v20
    v_smfmac_f32_16x16x64_bf16 v[36:39], v[48:51], v[96:103], v2
    ds_read_b128 v[88:91], v15 offset:4096
    v_cvt_pk_bf16_f32 v16, v16, v20
    v_smfmac_f32_16x16x64_bf16 v[24:27], v[52:55], a[184:191], v2
    ds_read_b128 v[48:51], v13 offset:2048
    v_mul_f32 v17, s31, v17
    v_smfmac_f32_16x16x64_bf16 v[28:31], v[52:55], a[248:255], v2
    ds_read_b128 v[92:95], v15 offset:5120
    v_mul_f32 v21, s31, v21
    v_smfmac_f32_16x16x64_bf16 v[32:35], v[52:55], v[56:63], v2
    ds_read_b128 v[96:99], v15 offset:6144
    s_waitcnt lgkmcnt(4)
    v_cvt_pk_bf16_f32 v17, v17, v21
    v_smfmac_f32_16x16x64_bf16 v[36:39], v[52:55], v[64:71], v2
    ds_write2_b32 v3, v16, v17 offset0:0 offset1:72
    ds_read_b128 v[52:55], v13 offset:3072
    v_smfmac_f32_16x16x64_bf16 v[24:27], v[40:43], a[128:135], v2
    ds_read_b128 v[100:103], v15 offset:7168
    v_smfmac_f32_16x16x64_bf16 v[28:31], v[40:43], a[192:199], v2
    v_smfmac_f32_16x16x64_bf16 v[24:27], v[44:47], a[136:143], v2
    s_waitcnt lgkmcnt(2)
    s_barrier
    ds_read_b128 v[56:59], v4 offset:0
    v_smfmac_f32_16x16x64_bf16 v[28:31], v[44:47], a[200:207], v2
    ds_read_b128 v[60:63], v4 offset:64
    v_smfmac_f32_16x16x64_bf16 v[24:27], v[48:51], a[144:151], v2
    ds_read_b128 v[64:67], v4 offset:128
    v_smfmac_f32_16x16x64_bf16 v[28:31], v[48:51], a[208:215], v2
    ds_read_b128 v[68:71], v4 offset:192
    s_waitcnt lgkmcnt(5)
    v_smfmac_f32_16x16x64_bf16 v[24:27], v[52:55], a[152:159], v2
    v_smfmac_f32_16x16x64_bf16 v[28:31], v[52:55], a[216:223], v2
    v_smfmac_f32_16x16x64_bf16 v[32:35], v[40:43], v[128:135], v2
    s_waitcnt lgkmcnt(3)
    v_mfma_f32_16x16x32_bf16 v[16:19], v[72:75], v[56:59], 0
    s_waitcnt lgkmcnt(2)
    v_add_f32 v24, v24, v26
    v_add_f32 v28, v28, v30
    v_mfma_f32_16x16x32_bf16 v[16:19], v[76:79], v[60:63], v[16:19]
    s_waitcnt lgkmcnt(1)
    v_add_f32 v25, v25, v27
    v_add_f32 v29, v29, v31
    v_mfma_f32_16x16x32_bf16 v[16:19], v[80:83], v[64:67], v[16:19]
    s_waitcnt lgkmcnt(0)
    v_cvt_pk_bf16_f32 v24, v24, v28
    v_cvt_pk_bf16_f32 v25, v25, v29
    v_mfma_f32_16x16x32_bf16 v[16:19], v[84:87], v[68:71], v[16:19]
    ds_write2_b32 v14, v24, v25 offset0:0 offset1:72
    v_mfma_f32_16x16x32_bf16 v[20:23], v[88:91], v[56:59], 0
    v_mfma_f32_16x16x32_bf16 v[20:23], v[92:95], v[60:63], v[20:23]
    v_exp_f32 v16, v16
    v_mfma_f32_16x16x32_bf16 v[20:23], v[96:99], v[64:67], v[20:23]
    s_waitcnt lgkmcnt(0)
    s_barrier
    ds_read_b128 v[72:75], v5 offset:0
    ds_read_b128 v[76:79], v5 offset:64
    ds_read_b128 v[80:83], v5 offset:128
    ds_read_b128 v[84:87], v5 offset:192
    v_exp_f32 v17, v17
    v_mfma_f32_16x16x32_bf16 v[20:23], v[100:103], v[68:71], v[20:23]
    ds_read_b128 v[88:91], v15 offset:14336
    v_exp_f32 v18, v18
    v_smfmac_f32_16x16x64_bf16 v[36:39], v[40:43], v[136:143], v2
    ds_read_b128 v[92:95], v15 offset:15360
    v_exp_f32 v19, v19
    v_smfmac_f32_16x16x64_bf16 v[32:35], v[44:47], v[144:151], v2
    ds_read_b128 v[100:103], v12 offset:0
    v_exp_f32 v20, v20
    v_smfmac_f32_16x16x64_bf16 v[36:39], v[44:47], v[152:159], v2
    v_exp_f32 v21, v21
    v_smfmac_f32_16x16x64_bf16 v[32:35], v[48:51], v[160:167], v2
    v_exp_f32 v22, v22
    v_smfmac_f32_16x16x64_bf16 v[36:39], v[48:51], v[168:175], v2
    v_exp_f32 v23, v23
    v_smfmac_f32_16x16x64_bf16 v[32:35], v[52:55], v[176:183], v2
    v_cvt_pk_bf16_f32 v16, v16, v17
    v_smfmac_f32_16x16x64_bf16 v[36:39], v[52:55], v[184:191], v2
    ds_read_b128 v[40:43], v12 offset:256
    s_waitcnt lgkmcnt(1)
    v_cvt_pk_bf16_f32 v17, v18, v19
    v_mfma_f32_16x16x32_bf16 v[96:99], v[72:75], v[56:59], 0
    v_cvt_pk_bf16_f32 v18, v20, v21
    v_cvt_pk_bf16_f32 v19, v22, v23
    v_mfma_f32_16x16x32_bf16 v[96:99], v[76:79], v[60:63], v[96:99]
    v_add_f32 v32, v32, v34
    v_add_f32 v33, v33, v35
    v_mfma_f32_16x16x32_bf16 v[96:99], v[80:83], v[64:67], v[96:99]
    v_cvt_pk_bf16_f32 v106, v32, v33
    v_add_f32 v36, v36, v38
    v_mfma_f32_16x16x32_bf16 v[96:99], v[84:87], v[68:71], v[96:99]
    v_add_f32 v37, v37, v39
    v_cvt_pk_bf16_f32 v107, v36, v37
    v_mfma_f32_16x16x32_bf16 v[20:23], v[100:103], v[16:19], 0
    ds_read_b128 v[44:47], v12 offset:256
    v_mfma_f32_16x16x32_bf16 v[24:27], v[88:91], v[16:19], 0
    v_exp_f32 v96, v96
    v_exp_f32 v97, v97
    v_mfma_f32_16x16x32_bf16 v[28:31], v[92:95], v[16:19], 0
    ds_read_b128 v[48:51], v12 offset:256
    v_cvt_pk_bf16_f32 v104, v96, v97
    v_cvt_pk_bf16_f32 v109, v96, v97
    s_nop 0
    v_mfma_f32_16x16x16_bf16 v[20:23], v[100:101], v[104:105], v[20:23]
    ds_read_b128 v[52:55], v12 offset:256
    v_mfma_f32_16x16x16_bf16 v[24:27], v[106:107], v[104:105], v[24:27]
    ds_read_b128 v[72:75], v8 offset:0
    v_mfma_f32_16x16x16_bf16 v[28:31], v[106:107], v[108:109], v[28:31]
    ds_read_b128 v[76:79], v8 offset:1024
    v_rcp_f32 v110, v20
    s_nop 0
    v_max_f32 v21, v20, v110
    v_cmp_ngt_f32 vcc, s32, v21
L_smback_140:
    v_pk_mul_f32 v[24:25], v[24:25], v[110:111] op_sel_hi:[1,0]
    v_pk_mul_f32 v[26:27], v[26:27], v[110:111] op_sel_hi:[1,0]
    v_pk_mul_f32 v[28:29], v[28:29], v[110:111] op_sel_hi:[1,0]
    v_pk_mul_f32 v[30:31], v[30:31], v[110:111] op_sel_hi:[1,0]
    s_mov_b64 exec, s[88:89]
    v_cvt_pk_bf16_f32 v24, v24, v25
    v_cvt_pk_bf16_f32 v25, v26, v27
    v_cvt_pk_bf16_f32 v26, v28, v29
    v_cvt_pk_bf16_f32 v27, v30, v31
    ds_write_b128 v6, v[24:27]
    s_mov_b64 exec, -1
    s_cbranch_vccnz L_slowsm_139
    ds_read_b128 v[80:83], v8 offset:4096
    ds_read_b128 v[84:87], v8 offset:5120
    s_waitcnt lgkmcnt(2)
    s_barrier
    ds_read_b128 v[24:27], v13 offset:16384
    ds_read_b128 v[28:31], v13 offset:17408
    ds_read_b128 v[56:59], v12 offset:256
    ds_read_b128 v[60:63], v12 offset:256
    ds_read_b128 v[88:91], v8 offset:2048
    s_waitcnt lgkmcnt(4)
    v_smfmac_f32_16x16x64_bf16 v[40:43], v[24:27], v[192:199], v2
    ds_read_b128 v[92:95], v8 offset:3072
    v_smfmac_f32_16x16x64_bf16 v[44:47], v[24:27], v[208:215], v2
    ds_read_b128 v[96:99], v8 offset:6144
    s_waitcnt lgkmcnt(5)
    v_smfmac_f32_16x16x64_bf16 v[40:43], v[28:31], v[200:207], v2
    ds_read_b128 v[100:103], v8 offset:7168
    s_mov_b32 s11, s24
    v_smfmac_f32_16x16x64_bf16 v[44:47], v[28:31], v[216:223], v2
    ds_read_b128 v[64:67], v12 offset:256
    s_mov_b32 s12, s23
    v_smfmac_f32_16x16x64_bf16 v[48:51], v[24:27], v[224:231], v2
    ds_read_b128 v[68:71], v12 offset:256
    v_add_f32 v40, v40, v42
    v_add_f32 v41, v41, v43
    v_smfmac_f32_16x16x64_bf16 v[52:55], v[24:27], v[240:247], v2
    ds_read_b128 v[32:35], v8 offset:32768
    v_add_f32 v44, v44, v46
    v_smfmac_f32_16x16x64_bf16 v[48:51], v[28:31], v[232:239], v2
    ds_read_b128 v[36:39], v8 offset:33792
    v_add_f32 v45, v45, v47
    v_smfmac_f32_16x16x64_bf16 v[52:55], v[28:31], v[248:255], v2
    ds_read_b128 v[16:19], v8 offset:34816
    s_waitcnt lgkmcnt(9)
    v_cvt_pk_bf16_f32 v40, v40, v44
    v_smfmac_f32_16x16x64_bf16 v[56:59], v[24:27], v[72:79], v2
    ds_read_b128 v[20:23], v8 offset:35840
    v_cvt_pk_bf16_f32 v41, v41, v45
    v_add_f32 v48, v48, v50
    v_add_f32 v49, v49, v51
    v_smfmac_f32_16x16x64_bf16 v[60:63], v[24:27], v[80:87], v2
    s_waitcnt lgkmcnt(8)
    v_add_f32 v52, v52, v54
    v_add_f32 v53, v53, v55
    v_smfmac_f32_16x16x64_bf16 v[56:59], v[28:31], v[88:95], v2
    v_cvt_pk_bf16_f32 v42, v48, v52
    v_cvt_pk_bf16_f32 v43, v49, v53
    buffer_store_dwordx4 v[40:43], v9, s[68:71], s85 offen sc1
    s_waitcnt lgkmcnt(6)
    v_smfmac_f32_16x16x64_bf16 v[60:63], v[28:31], v[96:103], v2
    s_mov_b32 s13, s22
    s_mov_b32 s15, 1048576
    s_waitcnt lgkmcnt(4)
    v_smfmac_f32_16x16x64_bf16 v[64:67], v[24:27], v[112:119], v2
    s_waitcnt lgkmcnt(2)
    v_add_f32 v56, v56, v58
    v_add_f32 v57, v57, v59
    v_smfmac_f32_16x16x64_bf16 v[64:67], v[28:31], v[32:39], v2
    ds_read_b128 v[88:91], v13 offset:26880
    v_add_f32 v60, v60, v62
    v_smfmac_f32_16x16x64_bf16 v[68:71], v[24:27], v[120:127], v2
    s_mov_b32 s10, s27
    s_waitcnt lgkmcnt(1)
    v_add_f32 v61, v61, v63
    v_smfmac_f32_16x16x64_bf16 v[68:71], v[28:31], v[16:23], v2
    v_cvt_pk_bf16_f32 v56, v56, v60
    v_cvt_pk_bf16_f32 v57, v57, v61
    v_pk_add_f32 v[64:65], v[64:65], v[66:67]
    s_nop 2
    v_pk_add_f32 v[68:69], v[68:69], v[70:71]
    v_cvt_pk_bf16_f32 v58, v64, v68
    v_cvt_pk_bf16_f32 v59, v65, v69
    buffer_store_dwordx4 v[56:59], v9, s[68:71], s86 offen sc1
    s_nop 1
    ds_read_b128 v[56:59], v7 offset:0
    ds_read_b128 v[60:63], v7 offset:1024
    ds_read_b128 v[64:67], v7 offset:2048
    ds_read_b128 v[68:71], v7 offset:3072
    ds_read_b128 v[72:75], v7 offset:4096
    ds_read_b128 v[76:79], v7 offset:5120
    ds_read_b128 v[80:83], v7 offset:6144
    ds_read_b128 v[84:87], v7 offset:7168
    ds_read_b128 v[16:19], v12 offset:256
    ds_read_b128 v[20:23], v12 offset:256
    ds_read_b128 v[32:35], v12 offset:256
    ds_read_b128 v[36:39], v12 offset:256
    s_mov_b32 s7, s23
    s_mov_b32 s23, s24
    s_mov_b32 s24, s25
    s_mov_b32 s25, s7
    s_add_u32 s17, s23, s16
    s_add_u32 s21, s21, 1
    s_mov_b32 s87, 262144
    s_cmp_eq_u32 s21, 3
    s_cselect_b32 s87, 0xfff80000, s87
    s_cselect_b32 s21, 0, s21
    s_add_u32 s85, s85, s87
    s_add_u32 s86, s86, s87
    s_add_u32 s22, s22, s87
    s_add_u32 s84, s84, s90
    s_mov_b32 s90, s87
    s_add_u32 s14, s14, 1
    s_mov_b32 s28, s18
    s_mov_b32 s29, s19
    s_add_u32 s18, s18, 131072
    s_add_u32 s19, s19, 65536
    s_mov_b32 s30, s20
    s_mov_b32 s20, s33
    s_add_u32 s33, s33, 128
    v_mov_b32 v104, 1
    s_add_u32 s27, s27, 128
    s_xor_b32 s91, s91, 16384
    s_add_u32 s26, s26, 262144
    s_mov_b32 m0, s91
    buffer_load_dwordx4 v[40:43], v1, s[68:71], s13 offen sc1
    buffer_load_dwordx4 v[44:47], v1, s[68:71], s13 offen offset:1024 sc1
    s_nop 7
    s_nop 7
    v_xor_b32 v15, 0x4000, v15
    s_nop 7
    s_nop 7
    v_mov_b32 v111, -1
    s_waitcnt lgkmcnt(12)
L_ra_141:
    buffer_load_dwordx4 v[48:51], v1, s[68:71], s13 offen sc1
    buffer_load_dwordx4 v[52:55], v1, s[68:71], s13 offen offset:1024 sc1
    s_waitcnt vmcnt(3)
    v_mfma_f32_16x16x32_bf16 v[92:95], v[88:91], v[40:43], 0
    s_waitcnt vmcnt(2)
    v_mfma_f32_16x16x32_bf16 v[92:95], v[88:91], v[44:47], v[92:95]
    s_nop 7
    v_cmp_u_f32 vcc, v92, v93
    v_add_f32_dpp v92, v92, v92 row_ror:4 row_mask:0xf bank_mask:0xf
    v_add_f32_dpp v93, v93, v93 row_ror:4 row_mask:0xf bank_mask:0xf
    s_cbranch_vccz L_rdone_143
    buffer_load_dwordx4 v[40:43], v1, s[68:71], s13 offen sc1
    buffer_load_dwordx4 v[44:47], v1, s[68:71], s13 offen offset:1024 sc1
    s_waitcnt vmcnt(3)
    v_mfma_f32_16x16x32_bf16 v[92:95], v[88:91], v[48:51], 0
    s_waitcnt vmcnt(2)
    v_mfma_f32_16x16x32_bf16 v[92:95], v[88:91], v[52:55], v[92:95]
    s_nop 7
    v_cmp_u_f32 vcc, v92, v93
    v_add_f32_dpp v92, v92, v92 row_ror:4 row_mask:0xf bank_mask:0xf
    v_add_f32_dpp v93, v93, v93 row_ror:4 row_mask:0xf bank_mask:0xf
    s_cbranch_vccnz L_rslow_142
L_rdone_143:
    v_add_f32_dpp v92, v92, v92 row_ror:8 row_mask:0xf bank_mask:0xf
    v_add_f32_dpp v93, v93, v93 row_ror:8 row_mask:0xf bank_mask:0xf
    v_cvt_pk_bf16_f32 v110, v92, v93
    v_min_u32 v110, 0xfffffffe, v110
    buffer_store_dword v110, v10, s[68:71], s11 offen sc1
    buffer_store_dword v111, v10, s[68:71], s12 offen sc1
L_kvok_144:
    s_mov_b32 s15, 1048576
    s_nop 7
    s_nop 7
    s_nop 7
    s_nop 7
    s_nop 7
    s_nop 7
    buffer_load_dwordx4 v[24:27], v1, s[68:71], s17 offen offset:0 sc1
    buffer_load_dwordx4 v[28:31], v1, s[68:71], s17 offen offset:1024 sc1
    s_nop 7
    s_nop 7
    s_nop 7
    s_nop 7
    s_branch L_chk_s3
L_mre_138:
    s_sub_u32 s15, s15, 1
    s_cmp_lg_u32 s15, 0
    s_cbranch_scc1 L_chk_s3
    s_branch L_err_8
L_rslow_142:
    s_sub_u32 s15, s15, 1
    s_cmp_eq_u32 s15, 0
    s_cbranch_scc1 L_err_10
    s_and_b32 s7, s15, 3
    s_cmp_lg_u32 s7, 0
    s_cbranch_scc1 L_ra_141
    s_mov_b64 s[98:99], 0
    v_mov_b32 v110, 0xffbfffbf
    v_cmp_eq_u32 vcc, v110, v48
    s_nop 0
    s_or_b64 s[98:99], s[98:99], vcc
    v_cmp_eq_u32 vcc, v110, v49
    s_nop 0
    s_or_b64 s[98:99], s[98:99], vcc
    v_cmp_eq_u32 vcc, v110, v50
    s_nop 0
    s_or_b64 s[98:99], s[98:99], vcc
    v_cmp_eq_u32 vcc, v110, v51
    s_nop 0
    s_or_b64 s[98:99], s[98:99], vcc
    v_cmp_eq_u32 vcc, v110, v52
    s_nop 0
    s_or_b64 s[98:99], s[98:99], vcc
    v_cmp_eq_u32 vcc, v110, v53
    s_nop 0
    s_or_b64 s[98:99], s[98:99], vcc
    v_cmp_eq_u32 vcc, v110, v54
    s_nop 0
    s_or_b64 s[98:99], s[98:99], vcc
    v_cmp_eq_u32 vcc, v110, v55
    s_nop 0
    s_or_b64 s[98:99], s[98:99], vcc
    s_cmp_eq_u64 s[98:99], 0
    s_cbranch_scc1 L_rdone_143
    s_branch L_ra_141
L_slowsm_139:
    s_waitcnt lgkmcnt(0)
    ds_read_b128 v[72:75], v15 offset:0
    ds_read_b128 v[88:91], v15 offset:4096
    ds_read_b128 v[76:79], v15 offset:1024
    ds_read_b128 v[92:95], v15 offset:5120
    ds_read_b128 v[80:83], v15 offset:2048
    ds_read_b128 v[96:99], v15 offset:6144
    ds_read_b128 v[84:87], v15 offset:3072
    ds_read_b128 v[100:103], v15 offset:7168
    s_waitcnt lgkmcnt(0)
    v_mfma_f32_16x16x32_bf16 v[16:19], v[72:75], v[56:59], 0
    v_mfma_f32_16x16x32_bf16 v[16:19], v[76:79], v[60:63], v[16:19]
    v_mfma_f32_16x16x32_bf16 v[16:19], v[80:83], v[64:67], v[16:19]
    v_mfma_f32_16x16x32_bf16 v[16:19], v[84:87], v[68:71], v[16:19]
    v_mfma_f32_16x16x32_bf16 v[20:23], v[88:91], v[56:59], 0
    v_mfma_f32_16x16x32_bf16 v[20:23], v[92:95], v[60:63], v[20:23]
    v_mfma_f32_16x16x32_bf16 v[20:23], v[96:99], v[64:67], v[20:23]
    v_mfma_f32_16x16x32_bf16 v[20:23], v[100:103], v[68:71], v[20:23]
    ds_read_b128 v[72:75], v5 offset:0
    ds_read_b128 v[76:79], v5 offset:64
    ds_read_b128 v[80:83], v5 offset:128
    ds_read_b128 v[84:87], v5 offset:192
    ds_read_b128 v[88:91], v15 offset:14336
    ds_read_b128 v[92:95], v15 offset:15360
    ds_read_b128 v[100:103], v12 offset:0
    s_waitcnt lgkmcnt(0)
    v_mfma_f32_16x16x32_bf16 v[96:99], v[72:75], v[56:59], 0
    v_mfma_f32_16x16x32_bf16 v[96:99], v[76:79], v[60:63], v[96:99]
    v_mfma_f32_16x16x32_bf16 v[96:99], v[80:83], v[64:67], v[96:99]
    v_mfma_f32_16x16x32_bf16 v[96:99], v[84:87], v[68:71], v[96:99]
    v_max3_f32 v110, v16, v17, v18
    v_max3_f32 v110, v110, v19, v20
    v_max3_f32 v110, v110, v21, v22
    v_max_f32 v110, v110, v23
    s_nop 2
    v_max3_f32 v110, v110, v96, v97
    v_mov_b32 v98, v110
    s_nop 1
    v_permlane16_swap_b32 v110, v98
    v_max_f32 v110, v110, v98
    v_mov_b32 v98, v110
    s_nop 1
    v_permlane32_swap_b32 v110, v98
    v_max_f32 v110, v110, v98
    v_sub_f32 v16, v16, v110
    v_exp_f32 v16, v16
    v_sub_f32 v17, v17, v110
    v_exp_f32 v17, v17
    v_sub_f32 v18, v18, v110
    v_exp_f32 v18, v18
    v_sub_f32 v19, v19, v110
    v_exp_f32 v19, v19
    v_sub_f32 v20, v20, v110
    v_exp_f32 v20, v20
    v_sub_f32 v21, v21, v110
    v_exp_f32 v21, v21
    v_sub_f32 v22, v22, v110
    v_exp_f32 v22, v22
    v_sub_f32 v23, v23, v110
    v_exp_f32 v23, v23
    v_sub_f32 v96, v96, v110
    v_exp_f32 v96, v96
    v_sub_f32 v97, v97, v110
    v_exp_f32 v97, v97
    v_cvt_pk_bf16_f32 v16, v16, v17
    v_cvt_pk_bf16_f32 v17, v18, v19
    v_cvt_pk_bf16_f32 v18, v20, v21
    v_cvt_pk_bf16_f32 v19, v22, v23
    v_cvt_pk_bf16_f32 v104, v96, v97
    v_cvt_pk_bf16_f32 v109, v96, v97
    v_mfma_f32_16x16x32_bf16 v[20:23], v[100:103], v[16:19], 0
    v_mfma_f32_16x16x32_bf16 v[24:27], v[88:91], v[16:19], 0
    v_mfma_f32_16x16x32_bf16 v[28:31], v[92:95], v[16:19], 0
    v_mfma_f32_16x16x16_bf16 v[20:23], v[100:101], v[104:105], v[20:23]
    v_mfma_f32_16x16x16_bf16 v[24:27], v[106:107], v[104:105], v[24:27]
    v_mfma_f32_16x16x16_bf16 v[28:31], v[106:107], v[108:109], v[28:31]
    ds_read_b128 v[72:75], v8 offset:0
    ds_read_b128 v[76:79], v8 offset:1024
    ds_read_b128 v[80:83], v8 offset:4096
    ds_read_b128 v[84:87], v8 offset:5120
    ds_read_b128 v[88:91], v8 offset:2048
    ds_read_b128 v[92:95], v8 offset:3072
    ds_read_b128 v[96:99], v8 offset:6144
    ds_read_b128 v[100:103], v8 offset:7168
    v_rcp_f32 v110, v20
    s_waitcnt lgkmcnt(0)
    s_mov_b64 vcc, 0
    s_nop 7
    s_branch L_smback_140
L_last_s3:
    buffer_store_dwordx2 v[106:107], v0, s[68:71], s29 offen sc1
    s_mov_b64 exec, 1
    buffer_store_dword v104, off, s[68:71], s30 sc1
    s_mov_b64 exec, -1
    ds_read_b128 v[16:19], v5 offset:192
    s_waitcnt vmcnt(2)
    ds_read_b128 v[88:91], v7 offset:32768
    ds_read_b128 v[92:95], v7 offset:33792
    ds_read_b128 v[96:99], v7 offset:34816
    ds_read_b128 v[100:103], v7 offset:35840
    ds_read_b128 v[24:27], v12 offset:256
    ds_read_b128 v[28:31], v12 offset:256
    s_waitcnt lgkmcnt(0)
    buffer_store_dwordx4 v[16:19], v1, s[68:71], s28 offen sc1
    s_barrier
    v_smfmac_f32_16x16x64_bf16 v[24:27], v[40:43], a[128:135], v2
    v_smfmac_f32_16x16x64_bf16 v[28:31], v[40:43], a[192:199], v2
    v_smfmac_f32_16x16x64_bf16 v[32:35], v[40:43], v[128:135], v2
    v_smfmac_f32_16x16x64_bf16 v[36:39], v[40:43], v[136:143], v2
    ds_read_b128 v[40:43], v13 offset:8192
    v_smfmac_f32_16x16x64_bf16 v[24:27], v[44:47], a[136:143], v2
    v_smfmac_f32_16x16x64_bf16 v[28:31], v[44:47], a[200:207], v2
    v_smfmac_f32_16x16x64_bf16 v[32:35], v[44:47], v[144:151], v2
    v_smfmac_f32_16x16x64_bf16 v[36:39], v[44:47], v[152:159], v2
    ds_read_b128 v[44:47], v13 offset:9216
    v_smfmac_f32_16x16x64_bf16 v[24:27], v[48:51], a[144:151], v2
    v_smfmac_f32_16x16x64_bf16 v[28:31], v[48:51], a[208:215], v2
    v_smfmac_f32_16x16x64_bf16 v[32:35], v[48:51], v[160:167], v2
    v_smfmac_f32_16x16x64_bf16 v[36:39], v[48:51], v[168:175], v2
    ds_read_b128 v[48:51], v13 offset:10240
    v_smfmac_f32_16x16x64_bf16 v[24:27], v[52:55], a[152:159], v2
    v_smfmac_f32_16x16x64_bf16 v[28:31], v[52:55], a[216:223], v2
    v_smfmac_f32_16x16x64_bf16 v[32:35], v[52:55], v[176:183], v2
    v_smfmac_f32_16x16x64_bf16 v[36:39], v[52:55], v[184:191], v2
    ds_read_b128 v[52:55], v13 offset:11264
    s_waitcnt lgkmcnt(3)
    v_smfmac_f32_16x16x64_bf16 v[24:27], v[40:43], a[160:167], v2
    v_smfmac_f32_16x16x64_bf16 v[28:31], v[40:43], a[224:231], v2
    v_smfmac_f32_16x16x64_bf16 v[32:35], v[40:43], v[56:63], v2
    v_smfmac_f32_16x16x64_bf16 v[36:39], v[40:43], v[64:71], v2
    ds_read_b128 v[56:59], v7 offset:36864
    ds_read_b128 v[60:63], v7 offset:37888
    ds_read_b128 v[64:67], v7 offset:38912
    ds_read_b128 v[68:71], v7 offset:39936
    s_waitcnt lgkmcnt(6)
    v_smfmac_f32_16x16x64_bf16 v[24:27], v[44:47], a[168:175], v2
    v_smfmac_f32_16x16x64_bf16 v[28:31], v[44:47], a[232:239], v2
    v_smfmac_f32_16x16x64_bf16 v[32:35], v[44:47], v[72:79], v2
    v_smfmac_f32_16x16x64_bf16 v[36:39], v[44:47], v[80:87], v2
    s_waitcnt lgkmcnt(5)
    v_smfmac_f32_16x16x64_bf16 v[24:27], v[48:51], a[176:183], v2
    v_smfmac_f32_16x16x64_bf16 v[28:31], v[48:51], a[240:247], v2
    v_smfmac_f32_16x16x64_bf16 v[32:35], v[48:51], v[88:95], v2
    v_smfmac_f32_16x16x64_bf16 v[36:39], v[48:51], v[96:103], v2
    s_waitcnt lgkmcnt(4)
    v_smfmac_f32_16x16x64_bf16 v[24:27], v[52:55], a[184:191], v2
    v_smfmac_f32_16x16x64_bf16 v[28:31], v[52:55], a[248:255], v2
    s_waitcnt lgkmcnt(2)
    v_smfmac_f32_16x16x64_bf16 v[32:35], v[52:55], v[56:63], v2
    s_waitcnt lgkmcnt(0)
    v_smfmac_f32_16x16x64_bf16 v[36:39], v[52:55], v[64:71], v2
    v_add_f32 v24, v24, v26
    v_add_f32 v28, v28, v30
    v_add_f32 v25, v25, v27
    v_add_f32 v29, v29, v31
    v_cvt_pk_bf16_f32 v24, v24, v28
    v_cvt_pk_bf16_f32 v25, v25, v29
    ds_write2_b32 v14, v24, v25 offset0:0 offset1:72
    v_add_f32 v32, v32, v34
    v_add_f32 v33, v33, v35
    v_cvt_pk_bf16_f32 v106, v32, v33
    v_add_f32 v36, v36, v38
    v_add_f32 v37, v37, v39
    v_cvt_pk_bf16_f32 v107, v36, v37
    buffer_store_dwordx2 v[106:107], v0, s[68:71], s19 offen sc1
    s_waitcnt lgkmcnt(0)
    s_barrier
    ds_read_b128 v[72:75], v5 offset:192
    s_waitcnt lgkmcnt(0)
    buffer_store_dwordx4 v[72:75], v1, s[68:71], s18 offen sc1
    s_waitcnt vmcnt(0)
    s_barrier
    s_mov_b64 exec, 1
    v_mov_b32 v110, 1
    buffer_store_dword v110, off, s[68:71], s20 sc1
    buffer_store_dword v110, off, s[68:71], s33 sc1
    s_endpgm
L_err_1:
    s_mov_b64 exec, 1
    v_mov_b32 v0, 1
    buffer_store_dword v0, off, s[72:75], 0 offset:16 sc1
    s_endpgm
L_err_2:
    s_mov_b64 exec, 1
    v_mov_b32 v0, 2
    buffer_store_dword v0, off, s[72:75], 0 offset:16 sc1
    s_endpgm
L_err_3:
    s_mov_b64 exec, 1
    v_mov_b32 v0, 3
    buffer_store_dword v0, off, s[72:75], 0 offset:16 sc1
    s_endpgm
L_err_4:
    s_mov_b64 exec, 1
    v_mov_b32 v0, 4
    buffer_store_dword v0, off, s[72:75], 0 offset:16 sc1
    s_endpgm
L_err_5:
    s_mov_b64 exec, 1
    v_mov_b32 v0, 5
    buffer_store_dword v0, off, s[72:75], 0 offset:16 sc1
    s_endpgm
L_err_6:
    s_mov_b64 exec, 1
    v_mov_b32 v0, 6
    buffer_store_dword v0, off, s[72:75], 0 offset:16 sc1
    s_endpgm
L_err_7:
    s_mov_b64 exec, 1
    v_mov_b32 v0, 7
    buffer_store_dword v0, off, s[72:75], 0 offset:16 sc1
    s_endpgm
L_err_8:
    s_mov_b64 exec, 1
    v_mov_b32 v0, 8
    buffer_store_dword v0, off, s[72:75], 0 offset:16 sc1
    s_endpgm
L_err_9:
    s_mov_b64 exec, 1
    v_mov_b32 v0, 9
    buffer_store_dword v0, off, s[72:75], 0 offset:16 sc1
    s_endpgm
L_err_10:
    s_mov_b64 exec, 1
    v_mov_b32 v0, 10
    buffer_store_dword v0, off, s[72:75], 0 offset:16 sc1
    s_endpgm
L_err_12:
    s_mov_b64 exec, 1
    v_mov_b32 v0, 12
    buffer_store_dword v0, off, s[72:75], 0 offset:16 sc1
    s_endpgm
L_err_13:
    s_mov_b64 exec, 1
    v_mov_b32 v0, 13
    buffer_store_dword v0, off, s[72:75], 0 offset:16 sc1
    s_endpgm
L_end:
    s_endpgm
.section .rodata,"a"
.p2align 6
.amdhsa_kernel gated_mix__memory_aug_recurrent_mem_tr__dense_activation_silu__prompt_kernel
  .amdhsa_next_free_vgpr 512
  .amdhsa_next_free_sgpr 102
  .amdhsa_accum_offset 256
  .amdhsa_float_denorm_mode_32 3
  .amdhsa_group_segment_fixed_size 0
  .amdhsa_kernarg_size 112
  .amdhsa_user_sgpr_count 2
  .amdhsa_user_sgpr_kernarg_segment_ptr 1
  .amdhsa_system_sgpr_workgroup_id_x 1
.end_amdhsa_kernel
```
